```python
import torch

def _softmax(x, axis=-1):
    return torch.softmax(x, dim=axis)
def _gelu(x):
    return torch.nn.functional.gelu(x, approximate="tanh")
def _silu(x):
    return torch.nn.functional.silu(x)
def _sigmoid(x):
    return torch.sigmoid(x)
def _layernorm(x, axis=-1, eps=1e-5):
    m = x.mean(dim=axis, keepdim=True)
    v = x.var(dim=axis, keepdim=True, unbiased=False)
    return (x - m) / torch.sqrt(v + eps)
def _scatter_add(tgt, idx, src, axis=0):
    return tgt.clone().index_add_(axis, idx, src)
def _segment_sum(src, seg, n):
    out = torch.zeros((n,) + src.shape[1:], dtype=src.dtype)
    return out.index_add_(0, seg, src)
def _pad(x, pw):
    flat = tuple(v for pair in reversed(pw) for v in pair)
    return torch.nn.functional.pad(x, flat)

kernel_name = 'sequential_preLN__ssm_conv_s4d__mixer_s_mlp__prompt'

def setup_inputs():

    _w = (lambda a: (lambda t: t.to(torch.bfloat16) if t.is_floating_point() else t)(torch.as_tensor(a)))
    def _A_setup():
        Bsz, L, D, N = 1, 2048, 640, 192
        return {
            "u": _w((lambda *s: torch.randn(*s, dtype=torch.bfloat16) * 0.05)(Bsz, L, D)),
            "log_A_real": _w((lambda *s: torch.randn(*s, dtype=torch.bfloat16) * 6.4)(D, N) * 0.5),
            "A_imag": _w((lambda *s: torch.randn(*s, dtype=torch.bfloat16) * 0.05)(D, N) * 3.14),
            "C_real": _w((lambda *s: torch.randn(*s, dtype=torch.bfloat16) * 0.05)(D, N) / N ** 0.5),
            "C_imag": _w((lambda *s: torch.randn(*s, dtype=torch.bfloat16) * 0.05)(D, N) / N ** 0.5),
            "log_dt": _w((lambda *s: torch.randn(*s, dtype=torch.bfloat16) * 0.05)(D) * 0.5 - 4.0),
            "D_skip": _w((lambda *s: torch.randn(*s, dtype=torch.bfloat16) * 0.05)(D)),
        }
    _A_in = _A_setup()

    def _B_setup():
        B, S, D, F = 1, 2048, 640, 1536
        return {
            "x":  _w((lambda *s: torch.randn(*s, dtype=torch.bfloat16) * 0.05)(B, S, D)),
            "w1": _w((lambda *s: torch.randn(*s, dtype=torch.bfloat16) * 6.4)(D, D) * (D ** -0.5)),
            "w2": _w((lambda *s: torch.randn(*s, dtype=torch.bfloat16) * 6.4)(D, D) * (D ** -0.5)),
            "w3": _w((lambda *s: torch.randn(*s, dtype=torch.bfloat16) * 6.4)(D, F) * (D ** -0.5)),
            "w4": _w((lambda *s: torch.randn(*s, dtype=torch.bfloat16) * 3.2)(F, D) * (F ** -0.5)),
        }
    _B_in = _B_setup()

    return {
        "A_u": _A_in["u"],
        "A_log_A_real": _A_in["log_A_real"],
        "A_A_imag": _A_in["A_imag"],
        "A_C_real": _A_in["C_real"],
        "A_C_imag": _A_in["C_imag"],
        "A_log_dt": _A_in["log_dt"],
        "A_D_skip": _A_in["D_skip"],
        "B_x": _B_in["x"],
        "B_w1": _B_in["w1"],
        "B_w2": _B_in["w2"],
        "B_w3": _B_in["w3"],
        "B_w4": _B_in["w4"],
    }

def reference(A_u, A_log_A_real, A_A_imag, A_C_real, A_C_imag, A_log_dt, A_D_skip, B_x, B_w1, B_w2, B_w3, B_w4):
    def _A_ref(u, log_A_real, A_imag, C_real, C_imag, log_dt, D_skip):
        L = u.shape[1]
        dt = torch.exp(log_dt)
        A = -torch.exp(log_A_real) + 1j * A_imag
        C = (C_real + 1j * C_imag) * dt[:, None]
        pos = (lambda x, dt: x.to(dt))(torch.arange(L), log_dt.dtype)
        P = torch.exp((A * dt[:, None])[:, :, None] * pos[None, None, :])
        K = 2.0 * torch.einsum("dn,dnl->dl", C, P).real
        L2 = 2 * L
        u_t = (lambda x, *d: x.permute(*d))(u, 0, 2, 1)
        Kf = (lambda x, *a, **k: torch.fft.rfft(x.float(), *a, **k))(K, L2)
        Uf = (lambda x, *a, **k: torch.fft.rfft(x.float(), *a, **k))(u_t, L2)
        y = (lambda x, *a, **k: torch.fft.irfft(x, *a, **k).to(torch.bfloat16))(Uf * Kf[None, :, :], L2)[:, :, :L]
        y = (lambda x, *d: x.permute(*d))(y, 0, 2, 1)
        return y + u * D_skip[None, None, :]

    def _B_ref(x, w1, w2, w3, w4):
        B, S, D = x.shape
        h = _gelu(_layernorm(x, axis=-1) @ w1)
        c = D // 4
        g0 = _pad(h[:, :, 0*c:1*c], ((0, 0), (1, 0), (0, 0)))[:, :S, :]
        g1 = _pad(h[:, :, 1*c:2*c], ((0, 0), (0, 1), (0, 0)))[:, 1:, :]
        g2 = _pad(h[:, :, 2*c:3*c], ((0, 0), (2, 0), (0, 0)))[:, :S, :]
        g3 = _pad(h[:, :, 3*c:   ], ((0, 0), (0, 2), (0, 0)))[:, 2:, :]
        hs = torch.concatenate([g0, g1, g2, g3], axis=-1) @ w2
        x1 = x + hs
        h2 = _gelu(_layernorm(x1, axis=-1) @ w3) @ w4
        return x1 + h2

    x = A_u
    h = x + _A_ref(_layernorm(x, axis=-1), A_log_A_real, A_A_imag, A_C_real, A_C_imag, A_log_dt, A_D_skip)
    h2 = h + _B_ref(_layernorm(h, axis=-1), B_w1, B_w2, B_w3, B_w4)
    return h2
```

```asm
; @launch grid=(256,1,1) block=(320,1,1) lds=163840
.amdgcn_target "amdgcn-amd-amdhsa--gfx950"
.text
.globl sequential_preLN__ssm_conv_s4d__mixer_s_mlp__prompt_kernel
.p2align 8
.type sequential_preLN__ssm_conv_s4d__mixer_s_mlp__prompt_kernel,@function
sequential_preLN__ssm_conv_s4d__mixer_s_mlp__prompt_kernel:
  s_cmp_ge_u32 s2, 256
  s_cbranch_scc1 k_end
  s_load_dwordx16 s[64:79], s[0:1], 0
  s_load_dwordx8 s[80:87], s[0:1], 64
  s_load_dwordx4 s[88:91], s[0:1], 96
  s_load_dwordx2 s[92:93], s[0:1], 112
  v_lshrrev_b32 v1, 6, v0
  v_and_b32 v0, 63, v0
  v_readfirstlane_b32 s3, v1
  s_mov_b32 s6, 0x10000000
  s_mov_b32 s7, 0x20000
  s_waitcnt lgkmcnt(0)
  s_mov_b32 s4, s92
  s_mov_b32 s5, s93
  s_cmp_eq_u32 s3, 4
  s_cbranch_scc1 helper
  s_add_u32 s56, s92, 28901376
  s_addc_u32 s57, s93, 0
  s_load_dword s60, s[56:57], 0
  s_cmp_ge_u32 s2, 160
  s_cbranch_scc1 role_b
  s_and_b32 s50, s2, 7
  s_mul_i32 s50, s50, 20
  s_lshr_b32 s51, s2, 3
  s_add_u32 s50, s50, s51
  s_mov_b32 s8, s66
  s_mov_b32 s9, s67
  s_mov_b32 s10, 245760
  s_mov_b32 s11, 0x20000
  s_mov_b32 s12, s68
  s_mov_b32 s13, s69
  s_mov_b32 s14, 245760
  s_mov_b32 s15, 0x20000
  s_mov_b32 s16, s70
  s_mov_b32 s17, s71
  s_mov_b32 s18, 245760
  s_mov_b32 s19, 0x20000
  s_mov_b32 s20, s72
  s_mov_b32 s21, s73
  s_mov_b32 s22, 245760
  s_mov_b32 s23, 0x20000
  s_lshl_b32 s24, s50, 2
  s_add_u32 s24, s24, s3
  s_mul_i32 s25, s24, 384
  s_lshl_b32 s24, s24, 1
  v_lshlrev_b32 v1, 1, v0
  v_mov_b32 v2, 0
  v_mov_b32 v8, 0
  v_mov_b32 v9, 0
  v_mov_b32 v10, 0
  v_mov_b32 v11, 0
  v_mov_b32 v12, 0
  v_mov_b32 v13, 0
  v_mov_b32 v14, 0
  v_mov_b32 v15, 0
  v_mov_b32 v16, 0
  v_mov_b32 v17, 0
  v_mov_b32 v18, 0
  v_mov_b32 v19, 0
  v_mov_b32 v20, 0
  v_mov_b32 v21, 0
  buffer_load_short_d16_hi v8, v1, s[8:11], s25 offen offset:0
  buffer_load_short_d16_hi v9, v1, s[12:15], s25 offen offset:0
  buffer_load_short_d16_hi v10, v1, s[16:19], s25 offen offset:0
  buffer_load_short_d16_hi v11, v1, s[20:23], s25 offen offset:0
  s_mov_b32 s28, s74
  s_mov_b32 s29, s75
  s_mov_b32 s30, 1280
  s_mov_b32 s31, 0x20000
  s_mov_b32 s32, s76
  s_mov_b32 s33, s77
  s_mov_b32 s34, 1280
  s_mov_b32 s35, 0x20000
  buffer_load_short_d16_hi v20, v2, s[28:31], s24 offen
  buffer_load_short_d16_hi v21, v2, s[32:35], s24 offen
  buffer_load_short_d16_hi v12, v1, s[8:11], s25 offen offset:128
  buffer_load_short_d16_hi v13, v1, s[12:15], s25 offen offset:128
  buffer_load_short_d16_hi v14, v1, s[16:19], s25 offen offset:128
  buffer_load_short_d16_hi v15, v1, s[20:23], s25 offen offset:128
  buffer_load_short_d16_hi v16, v1, s[8:11], s25 offen offset:256
  buffer_load_short_d16_hi v17, v1, s[12:15], s25 offen offset:256
  buffer_load_short_d16_hi v18, v1, s[16:19], s25 offen offset:256
  buffer_load_short_d16_hi v19, v1, s[20:23], s25 offen offset:256
  s_cmp_ge_u32 s3, 1
  s_cbranch_scc1 pfw_end
  s_cmp_eq_u32 s3, 1
  s_cselect_b64 s[44:45], s[82:83], s[80:81]
  s_cmp_eq_u32 s3, 2
  s_cselect_b64 s[44:45], s[84:85], s[44:45]
  s_cmp_eq_u32 s3, 3
  s_cselect_b64 s[44:45], s[86:87], s[44:45]
  s_cmp_lt_u32 s3, 2
  s_cselect_b32 s43, 39, 31
  s_mov_b32 s47, 0x20000
  s_add_u32 s42, s43, 1
  s_mul_i32 s46, s42, 20480
  s_mul_i32 s42, s42, s2
  s_lshl_b32 s42, s42, 7
  v_min_u32 v252, s43, v0
  v_lshlrev_b32 v252, 7, v252
  buffer_load_dword v254, v252, s[44:47], s42 offen
pfw_end:
  s_barrier
  s_cmp_lg_u32 s3, 0
  s_cbranch_scc1 nozero
  v_lshrrev_b32 v5, 4, v0
  v_mul_u32_u24 v5, 8352, v5
  v_bfe_u32 v6, v0, 3, 1
  v_mul_u32_u24 v6, 4160, v6
  v_and_b32 v7, 7, v0
  v_lshl_add_u32 v5, v7, 2, v5
  v_add3_u32 v5, v5, v6, v2
  v_add_u32 v5, 69632, v5
  ds_write_b32 v5, v2
nozero:
  s_mul_i32 s26, s3, 17408
  s_mov_b32 m0, s26
  v_and_b32 v3, 31, v0
  v_mul_u32_u24 v3, 272, v3
  v_lshrrev_b32 v4, 5, v0
  v_lshl_add_u32 v3, v4, 4, v3
  v_add_u32 v3, s26, v3
  v_mov_b32 v4, 0x3f80
  ds_write_addtid_b32 v4
  s_mul_i32 s27, s3, 4608
  s_add_u32 s27, s27, 103040
  v_lshlrev_b32 v5, 3, v0
  v_add_u32 v5, s27, v5
  v_mov_b32 v6, 0
  v_mov_b32 v7, 0
  ds_write_b64 v5, v[6:7]
  s_mov_b32 s36, 0x3fb8aa3b
  s_mov_b32 s37, 0x3e22f983
  s_mov_b32 s38, 0x41000000
  s_mov_b32 s39, 0x43800000
  s_waitcnt vmcnt(9)
  v_mul_f32 v20, s36, v20
  v_exp_f32 v20, v20
  s_nop 0
  v_cvt_pk_bf16_f32 v20, v20, v20
  v_lshlrev_b32 v20, 16, v20
  v_add_f32 v22, v20, v20
  v_cmp_eq_u32 vcc, 0, v0
  s_waitcnt vmcnt(8)
  s_nop 0
  v_cndmask_b32 v21, 0, v21, vcc
  v_lshl_add_u32 v23, v0, 2, s26
  v_mul_f32 v8, s36, v8
  v_mul_f32 v9, v9, v20
  v_exp_f32 v8, v8
  v_mul_f32 v9, s37, v9
  v_cvt_pk_bf16_f32 v8, v8, v8
  v_mul_f32 v143, s38, v9
  v_lshlrev_b32 v8, 16, v8
  v_fract_f32 v143, v143
  v_mul_f32 v8, v8, v20
  v_cos_f32 v104, v143
  v_mul_f32 v8, -v8, s36
  v_sin_f32 v105, v143
  v_mul_f32 v142, s38, v8
  v_fract_f32 v146, v9
  v_exp_f32 v142, v142
  v_exp_f32 v145, v8
  v_mul_f32 v104, v104, v142
  v_mul_f32 v105, v105, v142
  v_cos_f32 v136, v146
  v_sin_f32 v137, v146
  v_pk_mul_f32 v[106:107], v[104:105], v[104:105] op_sel:[0,0] op_sel_hi:[0,1]
  v_mul_f32 v136, v136, v145
  v_pk_fma_f32 v[106:107], v[104:105], v[104:105], v[106:107] op_sel:[1,1,0] op_sel_hi:[1,0,1] neg_lo:[1,0,0]
  v_mul_f32 v137, v137, v145
  v_pk_mul_f32 v[110:111], v[106:107], v[106:107] op_sel:[0,0] op_sel_hi:[0,1]
  v_mul_f32 v140, v10, v22
  v_mul_f32 v141, v11, v22
  v_pk_mul_f32 v[164:165], v[136:137], v[136:137] op_sel:[0,0] op_sel_hi:[0,1]
  v_pk_mul_f32 v[108:109], v[104:105], v[106:107] op_sel:[0,0] op_sel_hi:[0,1]
  v_cvt_pk_bf16_f32 v240, v104, v105
  v_pk_fma_f32 v[110:111], v[106:107], v[106:107], v[110:111] op_sel:[1,1,0] op_sel_hi:[1,0,1] neg_lo:[1,0,0]
  v_cvt_pk_bf16_f32 v241, v140, -v141
  v_pk_fma_f32 v[164:165], v[136:137], v[136:137], v[164:165] op_sel:[1,1,0] op_sel_hi:[1,0,1] neg_lo:[1,0,0]
  v_pk_fma_f32 v[108:109], v[104:105], v[106:107], v[108:109] op_sel:[1,1,0] op_sel_hi:[1,0,1] neg_lo:[1,0,0]
  v_pk_mul_f32 v[168:169], v[140:141], v[136:137] op_sel:[0,0] op_sel_hi:[0,1]
  ds_write_addtid_b32 v240 offset:272
  v_cvt_pk_bf16_f32 v242, v106, v107
  v_pk_mul_f32 v[112:113], v[104:105], v[110:111] op_sel:[0,0] op_sel_hi:[0,1]
  ds_write_addtid_b32 v241 offset:8704
  v_cvt_pk_bf16_f32 v243, v108, v109
  v_pk_mul_f32 v[166:167], v[164:165], v[164:165] op_sel:[0,0] op_sel_hi:[0,1]
  v_pk_fma_f32 v[168:169], v[140:141], v[136:137], v[168:169] op_sel:[1,1,0] op_sel_hi:[1,0,1] neg_lo:[1,0,0]
  v_pk_mul_f32 v[170:171], v[140:141], v[164:165] op_sel:[0,0] op_sel_hi:[0,1]
  ds_write_addtid_b32 v242 offset:544
  v_cvt_pk_bf16_f32 v244, v110, v111
  v_pk_fma_f32 v[112:113], v[104:105], v[110:111], v[112:113] op_sel:[1,1,0] op_sel_hi:[1,0,1] neg_lo:[1,0,0]
  v_pk_mul_f32 v[114:115], v[106:107], v[110:111] op_sel:[0,0] op_sel_hi:[0,1]
  ds_write_addtid_b32 v243 offset:816
  v_pk_fma_f32 v[166:167], v[164:165], v[164:165], v[166:167] op_sel:[1,1,0] op_sel_hi:[1,0,1] neg_lo:[1,0,0]
  v_cvt_pk_bf16_f32 v245, v168, -v169
  v_pk_fma_f32 v[170:171], v[140:141], v[164:165], v[170:171] op_sel:[1,1,0] op_sel_hi:[1,0,1] neg_lo:[1,0,0]
  v_pk_mul_f32 v[172:173], v[168:169], v[164:165] op_sel:[0,0] op_sel_hi:[0,1]
  ds_write_addtid_b32 v244 offset:1088
  v_cvt_pk_bf16_f32 v246, v112, v113
  v_pk_fma_f32 v[114:115], v[106:107], v[110:111], v[114:115] op_sel:[1,1,0] op_sel_hi:[1,0,1] neg_lo:[1,0,0]
  v_pk_mul_f32 v[116:117], v[108:109], v[110:111] op_sel:[0,0] op_sel_hi:[0,1]
  v_pk_mul_f32 v[118:119], v[110:111], v[110:111] op_sel:[0,0] op_sel_hi:[0,1]
  v_mul_f32 v149, s39, v9
  ds_write_addtid_b32 v245 offset:8976
  v_cvt_pk_bf16_f32 v247, v170, -v171
  v_pk_fma_f32 v[172:173], v[168:169], v[164:165], v[172:173] op_sel:[1,1,0] op_sel_hi:[1,0,1] neg_lo:[1,0,0]
  v_pk_mul_f32 v[174:175], v[140:141], v[166:167] op_sel:[0,0] op_sel_hi:[0,1]
  ds_write_addtid_b32 v246 offset:1360
  v_cvt_pk_bf16_f32 v248, v114, v115
  v_pk_fma_f32 v[116:117], v[108:109], v[110:111], v[116:117] op_sel:[1,1,0] op_sel_hi:[1,0,1] neg_lo:[1,0,0]
  v_pk_fma_f32 v[118:119], v[110:111], v[110:111], v[118:119] op_sel:[1,1,0] op_sel_hi:[1,0,1] neg_lo:[1,0,0]
  v_mul_f32 v148, s39, v8
  v_fract_f32 v149, v149
  ds_write_addtid_b32 v247 offset:9248
  v_cvt_pk_bf16_f32 v249, v172, -v173
  v_pk_fma_f32 v[174:175], v[140:141], v[166:167], v[174:175] op_sel:[1,1,0] op_sel_hi:[1,0,1] neg_lo:[1,0,0]
  v_pk_mul_f32 v[152:153], v[168:169], v[166:167] op_sel:[0,0] op_sel_hi:[0,1]
  ds_write_addtid_b32 v248 offset:1632
  v_cvt_pk_bf16_f32 v250, v116, v117
  v_pk_mul_f32 v[120:121], v[104:105], v[118:119] op_sel:[0,0] op_sel_hi:[0,1]
  v_exp_f32 v148, v148
  v_cos_f32 v138, v149
  v_sin_f32 v139, v149
  ds_write_addtid_b32 v249 offset:9520
  v_cvt_pk_bf16_f32 v251, v174, -v175
  v_pk_fma_f32 v[152:153], v[168:169], v[166:167], v[152:153] op_sel:[1,1,0] op_sel_hi:[1,0,1] neg_lo:[1,0,0]
  v_pk_mul_f32 v[176:177], v[170:171], v[166:167] op_sel:[0,0] op_sel_hi:[0,1]
  ds_write_addtid_b32 v250 offset:1904
  v_cvt_pk_bf16_f32 v240, v118, v119
  v_pk_fma_f32 v[120:121], v[104:105], v[118:119], v[120:121] op_sel:[1,1,0] op_sel_hi:[1,0,1] neg_lo:[1,0,0]
  v_pk_mul_f32 v[122:123], v[106:107], v[118:119] op_sel:[0,0] op_sel_hi:[0,1]
  ds_write_addtid_b32 v251 offset:10880
  v_cvt_pk_bf16_f32 v241, v152, -v153
  v_pk_fma_f32 v[176:177], v[170:171], v[166:167], v[176:177] op_sel:[1,1,0] op_sel_hi:[1,0,1] neg_lo:[1,0,0]
  v_pk_mul_f32 v[154:155], v[172:173], v[166:167] op_sel:[0,0] op_sel_hi:[0,1]
  v_mul_f32 v138, v138, v148
  v_mul_f32 v139, v139, v148
  ds_write_addtid_b32 v240 offset:2176
  v_cvt_pk_bf16_f32 v242, v120, v121
  v_pk_fma_f32 v[122:123], v[106:107], v[118:119], v[122:123] op_sel:[1,1,0] op_sel_hi:[1,0,1] neg_lo:[1,0,0]
  v_pk_mul_f32 v[124:125], v[108:109], v[118:119] op_sel:[0,0] op_sel_hi:[0,1]
  ds_write_addtid_b32 v241 offset:11152
  v_cvt_pk_bf16_f32 v243, v176, -v177
  v_pk_fma_f32 v[154:155], v[172:173], v[166:167], v[154:155] op_sel:[1,1,0] op_sel_hi:[1,0,1] neg_lo:[1,0,0]
  v_pk_mul_f32 v[178:179], v[140:141], v[104:105] op_sel:[0,0] op_sel_hi:[0,1]
  v_pk_mul_f32 v[126:127], v[110:111], v[118:119] op_sel:[0,0] op_sel_hi:[0,1]
  ds_write_addtid_b32 v242 offset:2448
  v_cvt_pk_bf16_f32 v244, v122, v123
  v_pk_fma_f32 v[124:125], v[108:109], v[118:119], v[124:125] op_sel:[1,1,0] op_sel_hi:[1,0,1] neg_lo:[1,0,0]
  v_pk_mul_f32 v[180:181], v[140:141], v[138:139] op_sel:[0,0] op_sel_hi:[0,1]
  ds_write_addtid_b32 v243 offset:11424
  v_cvt_pk_bf16_f32 v245, v154, -v155
  v_pk_fma_f32 v[178:179], v[140:141], v[104:105], v[178:179] op_sel:[1,1,0] op_sel_hi:[1,0,1] neg_lo:[1,0,0]
  v_pk_fma_f32 v[126:127], v[110:111], v[118:119], v[126:127] op_sel:[1,1,0] op_sel_hi:[1,0,1] neg_lo:[1,0,0]
  ds_write_addtid_b32 v244 offset:2720
  v_cvt_pk_bf16_f32 v246, v124, v125
  v_pk_fma_f32 v[180:181], v[140:141], v[138:139], v[180:181] op_sel:[1,1,0] op_sel_hi:[1,0,1] neg_lo:[1,0,0]
  v_pk_mul_f32 v[128:129], v[112:113], v[118:119] op_sel:[0,0] op_sel_hi:[0,1]
  ds_write_addtid_b32 v245 offset:11696
  v_cvt_pk_bf16_f32 v247, v126, v127
  v_pk_mul_f32 v[182:183], v[178:179], v[138:139] op_sel:[0,0] op_sel_hi:[0,1]
  ds_write_addtid_b32 v246 offset:2992
  v_cvt_pk_bf16_f32 v248, v180, -v181
  v_pk_fma_f32 v[128:129], v[112:113], v[118:119], v[128:129] op_sel:[1,1,0] op_sel_hi:[1,0,1] neg_lo:[1,0,0]
  v_pk_mul_f32 v[130:131], v[114:115], v[118:119] op_sel:[0,0] op_sel_hi:[0,1]
  ds_write_addtid_b32 v247 offset:3264
  v_pk_fma_f32 v[182:183], v[178:179], v[138:139], v[182:183] op_sel:[1,1,0] op_sel_hi:[1,0,1] neg_lo:[1,0,0]
  v_pk_mul_f32 v[156:157], v[170:171], v[138:139] op_sel:[0,0] op_sel_hi:[0,1]
  ds_write_addtid_b32 v248 offset:9792
  v_cvt_pk_bf16_f32 v249, v128, v129
  v_pk_fma_f32 v[130:131], v[114:115], v[118:119], v[130:131] op_sel:[1,1,0] op_sel_hi:[1,0,1] neg_lo:[1,0,0]
  v_pk_mul_f32 v[132:133], v[116:117], v[118:119] op_sel:[0,0] op_sel_hi:[0,1]
  ds_write_addtid_b32 v248 offset:10064
  v_cvt_pk_bf16_f32 v250, v182, -v183
  v_pk_fma_f32 v[156:157], v[170:171], v[138:139], v[156:157] op_sel:[1,1,0] op_sel_hi:[1,0,1] neg_lo:[1,0,0]
  v_pk_mul_f32 v[184:185], v[174:175], v[138:139] op_sel:[0,0] op_sel_hi:[0,1]
  ds_write_addtid_b32 v249 offset:3536
  v_cvt_pk_bf16_f32 v251, v130, v131
  v_pk_fma_f32 v[132:133], v[116:117], v[118:119], v[132:133] op_sel:[1,1,0] op_sel_hi:[1,0,1] neg_lo:[1,0,0]
  v_pk_mul_f32 v[134:135], v[118:119], v[118:119] op_sel:[0,0] op_sel_hi:[0,1]
  ds_write_addtid_b32 v250 offset:12784
  v_cvt_pk_bf16_f32 v240, v156, -v157
  v_pk_fma_f32 v[184:185], v[174:175], v[138:139], v[184:185] op_sel:[1,1,0] op_sel_hi:[1,0,1] neg_lo:[1,0,0]
  ds_write_addtid_b32 v251 offset:3808
  v_cvt_pk_bf16_f32 v241, v132, v133
  v_pk_fma_f32 v[134:135], v[118:119], v[118:119], v[134:135] op_sel:[1,1,0] op_sel_hi:[1,0,1] neg_lo:[1,0,0]
  ds_write_addtid_b32 v240 offset:10336
  v_cvt_pk_bf16_f32 v242, v184, -v185
  v_pk_mul_f32 v[158:159], v[176:177], v[138:139] op_sel:[0,0] op_sel_hi:[0,1]
  ds_write_addtid_b32 v241 offset:4080
  v_pk_mul_f32 v[160:161], v[104:105], v[134:135] op_sel:[0,0] op_sel_hi:[0,1]
  ds_write_addtid_b32 v242 offset:10608
  v_pk_fma_f32 v[158:159], v[176:177], v[138:139], v[158:159] op_sel:[1,1,0] op_sel_hi:[1,0,1] neg_lo:[1,0,0]
  v_pk_mul_f32 v[186:187], v[180:181], v[138:139] op_sel:[0,0] op_sel_hi:[0,1]
  ds_write_addtid_b32 v242 offset:11968
  v_cvt_pk_bf16_f32 v243, v134, v135
  v_pk_fma_f32 v[160:161], v[104:105], v[134:135], v[160:161] op_sel:[1,1,0] op_sel_hi:[1,0,1] neg_lo:[1,0,0]
  v_pk_mul_f32 v[162:163], v[106:107], v[134:135] op_sel:[0,0] op_sel_hi:[0,1]
  ds_write_addtid_b32 v242 offset:12240
  v_cvt_pk_bf16_f32 v244, v158, -v159
  v_pk_fma_f32 v[186:187], v[180:181], v[138:139], v[186:187] op_sel:[1,1,0] op_sel_hi:[1,0,1] neg_lo:[1,0,0]
  v_pk_mul_f32 v[188:189], v[182:183], v[138:139] op_sel:[0,0] op_sel_hi:[0,1]
  ds_write_addtid_b32 v243 offset:4352
  v_cvt_pk_bf16_f32 v245, v160, v161
  v_pk_fma_f32 v[162:163], v[106:107], v[134:135], v[162:163] op_sel:[1,1,0] op_sel_hi:[1,0,1] neg_lo:[1,0,0]
  v_pk_mul_f32 v[152:153], v[108:109], v[134:135] op_sel:[0,0] op_sel_hi:[0,1]
  ds_write_addtid_b32 v244 offset:12512
  v_cvt_pk_bf16_f32 v246, v186, -v187
  v_pk_fma_f32 v[188:189], v[182:183], v[138:139], v[188:189] op_sel:[1,1,0] op_sel_hi:[1,0,1] neg_lo:[1,0,0]
  v_pk_mul_f32 v[190:191], v[184:185], v[138:139] op_sel:[0,0] op_sel_hi:[0,1]
  ds_write_addtid_b32 v245 offset:4624
  v_cvt_pk_bf16_f32 v247, v162, v163
  v_pk_fma_f32 v[152:153], v[108:109], v[134:135], v[152:153] op_sel:[1,1,0] op_sel_hi:[1,0,1] neg_lo:[1,0,0]
  v_pk_mul_f32 v[154:155], v[110:111], v[134:135] op_sel:[0,0] op_sel_hi:[0,1]
  ds_write_addtid_b32 v246 offset:15232
  v_cvt_pk_bf16_f32 v248, v188, -v189
  v_pk_fma_f32 v[190:191], v[184:185], v[138:139], v[190:191] op_sel:[1,1,0] op_sel_hi:[1,0,1] neg_lo:[1,0,0]
  v_pk_mul_f32 v[192:193], v[186:187], v[138:139] op_sel:[0,0] op_sel_hi:[0,1]
  ds_write_addtid_b32 v247 offset:4896
  v_cvt_pk_bf16_f32 v249, v152, v153
  v_pk_fma_f32 v[154:155], v[110:111], v[134:135], v[154:155] op_sel:[1,1,0] op_sel_hi:[1,0,1] neg_lo:[1,0,0]
  v_pk_mul_f32 v[156:157], v[112:113], v[134:135] op_sel:[0,0] op_sel_hi:[0,1]
  ds_write_addtid_b32 v248 offset:15776
  v_cvt_pk_bf16_f32 v250, v190, -v191
  v_pk_fma_f32 v[192:193], v[186:187], v[138:139], v[192:193] op_sel:[1,1,0] op_sel_hi:[1,0,1] neg_lo:[1,0,0]
  v_pk_mul_f32 v[194:195], v[188:189], v[138:139] op_sel:[0,0] op_sel_hi:[0,1]
  ds_write_addtid_b32 v249 offset:5168
  v_cvt_pk_bf16_f32 v251, v154, v155
  v_pk_fma_f32 v[156:157], v[112:113], v[134:135], v[156:157] op_sel:[1,1,0] op_sel_hi:[1,0,1] neg_lo:[1,0,0]
  v_pk_mul_f32 v[158:159], v[114:115], v[134:135] op_sel:[0,0] op_sel_hi:[0,1]
  ds_write_addtid_b32 v250 offset:15504
  v_cvt_pk_bf16_f32 v240, v192, -v193
  v_pk_fma_f32 v[194:195], v[188:189], v[138:139], v[194:195] op_sel:[1,1,0] op_sel_hi:[1,0,1] neg_lo:[1,0,0]
  v_pk_mul_f32 v[160:161], v[190:191], v[138:139] op_sel:[0,0] op_sel_hi:[0,1]
  ds_write_addtid_b32 v251 offset:5440
  v_cvt_pk_bf16_f32 v241, v156, v157
  v_pk_fma_f32 v[158:159], v[114:115], v[134:135], v[158:159] op_sel:[1,1,0] op_sel_hi:[1,0,1] neg_lo:[1,0,0]
  v_pk_mul_f32 v[162:163], v[116:117], v[134:135] op_sel:[0,0] op_sel_hi:[0,1]
  ds_write_addtid_b32 v240 offset:16320
  v_cvt_pk_bf16_f32 v242, v194, -v195
  v_pk_fma_f32 v[160:161], v[190:191], v[138:139], v[160:161] op_sel:[1,1,0] op_sel_hi:[1,0,1] neg_lo:[1,0,0]
  v_pk_mul_f32 v[196:197], v[192:193], v[138:139] op_sel:[0,0] op_sel_hi:[0,1]
  ds_write_addtid_b32 v241 offset:5712
  v_cvt_pk_bf16_f32 v243, v158, v159
  v_pk_fma_f32 v[162:163], v[116:117], v[134:135], v[162:163] op_sel:[1,1,0] op_sel_hi:[1,0,1] neg_lo:[1,0,0]
  v_pk_mul_f32 v[152:153], v[118:119], v[134:135] op_sel:[0,0] op_sel_hi:[0,1]
  ds_write_addtid_b32 v242 offset:16864
  v_cvt_pk_bf16_f32 v244, v160, -v161
  v_pk_fma_f32 v[196:197], v[192:193], v[138:139], v[196:197] op_sel:[1,1,0] op_sel_hi:[1,0,1] neg_lo:[1,0,0]
  v_pk_mul_f32 v[198:199], v[194:195], v[138:139] op_sel:[0,0] op_sel_hi:[0,1]
  ds_write_addtid_b32 v243 offset:5984
  v_cvt_pk_bf16_f32 v245, v162, v163
  v_pk_fma_f32 v[152:153], v[118:119], v[134:135], v[152:153] op_sel:[1,1,0] op_sel_hi:[1,0,1] neg_lo:[1,0,0]
  v_pk_mul_f32 v[154:155], v[120:121], v[134:135] op_sel:[0,0] op_sel_hi:[0,1]
  ds_write_addtid_b32 v244 offset:16592
  v_cvt_pk_bf16_f32 v246, v196, -v197
  v_pk_fma_f32 v[198:199], v[194:195], v[138:139], v[198:199] op_sel:[1,1,0] op_sel_hi:[1,0,1] neg_lo:[1,0,0]
  v_pk_mul_f32 v[200:201], v[196:197], v[138:139] op_sel:[0,0] op_sel_hi:[0,1]
  ds_write_addtid_b32 v245 offset:6256
  v_cvt_pk_bf16_f32 v247, v152, v153
  v_pk_fma_f32 v[154:155], v[120:121], v[134:135], v[154:155] op_sel:[1,1,0] op_sel_hi:[1,0,1] neg_lo:[1,0,0]
  v_pk_mul_f32 v[156:157], v[122:123], v[134:135] op_sel:[0,0] op_sel_hi:[0,1]
  ds_write_addtid_b32 v246 offset:13056
  v_cvt_pk_bf16_f32 v248, v198, -v199
  v_pk_fma_f32 v[200:201], v[196:197], v[138:139], v[200:201] op_sel:[1,1,0] op_sel_hi:[1,0,1] neg_lo:[1,0,0]
  v_pk_mul_f32 v[202:203], v[198:199], v[138:139] op_sel:[0,0] op_sel_hi:[0,1]
  ds_write_addtid_b32 v247 offset:6528
  v_cvt_pk_bf16_f32 v249, v154, v155
  v_pk_fma_f32 v[156:157], v[122:123], v[134:135], v[156:157] op_sel:[1,1,0] op_sel_hi:[1,0,1] neg_lo:[1,0,0]
  v_pk_mul_f32 v[158:159], v[124:125], v[134:135] op_sel:[0,0] op_sel_hi:[0,1]
  ds_write_addtid_b32 v248 offset:13328
  v_cvt_pk_bf16_f32 v250, v200, -v201
  v_pk_fma_f32 v[202:203], v[198:199], v[138:139], v[202:203] op_sel:[1,1,0] op_sel_hi:[1,0,1] neg_lo:[1,0,0]
  v_pk_mul_f32 v[204:205], v[200:201], v[138:139] op_sel:[0,0] op_sel_hi:[0,1]
  ds_write_addtid_b32 v249 offset:6800
  v_cvt_pk_bf16_f32 v251, v156, v157
  v_pk_fma_f32 v[158:159], v[124:125], v[134:135], v[158:159] op_sel:[1,1,0] op_sel_hi:[1,0,1] neg_lo:[1,0,0]
  v_pk_mul_f32 v[160:161], v[126:127], v[134:135] op_sel:[0,0] op_sel_hi:[0,1]
  ds_write_addtid_b32 v250 offset:13600
  v_cvt_pk_bf16_f32 v240, v202, -v203
  v_pk_fma_f32 v[204:205], v[200:201], v[138:139], v[204:205] op_sel:[1,1,0] op_sel_hi:[1,0,1] neg_lo:[1,0,0]
  v_pk_mul_f32 v[206:207], v[202:203], v[138:139] op_sel:[0,0] op_sel_hi:[0,1]
  s_waitcnt vmcnt(7)
  v_mul_f32 v12, s36, v12
  ds_write_addtid_b32 v251 offset:7072
  v_cvt_pk_bf16_f32 v241, v158, v159
  v_pk_fma_f32 v[160:161], v[126:127], v[134:135], v[160:161] op_sel:[1,1,0] op_sel_hi:[1,0,1] neg_lo:[1,0,0]
  v_pk_mul_f32 v[162:163], v[128:129], v[134:135] op_sel:[0,0] op_sel_hi:[0,1]
  ds_write_addtid_b32 v240 offset:13872
  v_cvt_pk_bf16_f32 v242, v204, -v205
  v_pk_fma_f32 v[206:207], v[202:203], v[138:139], v[206:207] op_sel:[1,1,0] op_sel_hi:[1,0,1] neg_lo:[1,0,0]
  v_pk_mul_f32 v[152:153], v[204:205], v[138:139] op_sel:[0,0] op_sel_hi:[0,1]
  v_exp_f32 v12, v12
  ds_write_addtid_b32 v241 offset:7344
  v_cvt_pk_bf16_f32 v243, v160, v161
  v_pk_fma_f32 v[162:163], v[128:129], v[134:135], v[162:163] op_sel:[1,1,0] op_sel_hi:[1,0,1] neg_lo:[1,0,0]
  v_pk_mul_f32 v[154:155], v[130:131], v[134:135] op_sel:[0,0] op_sel_hi:[0,1]
  ds_write_addtid_b32 v242 offset:14144
  v_cvt_pk_bf16_f32 v244, v206, -v207
  v_pk_fma_f32 v[152:153], v[204:205], v[138:139], v[152:153] op_sel:[1,1,0] op_sel_hi:[1,0,1] neg_lo:[1,0,0]
  v_pk_mul_f32 v[156:157], v[206:207], v[138:139] op_sel:[0,0] op_sel_hi:[0,1]
  ds_write_addtid_b32 v243 offset:7616
  v_cvt_pk_bf16_f32 v245, v162, v163
  v_pk_fma_f32 v[154:155], v[130:131], v[134:135], v[154:155] op_sel:[1,1,0] op_sel_hi:[1,0,1] neg_lo:[1,0,0]
  v_pk_mul_f32 v[158:159], v[132:133], v[134:135] op_sel:[0,0] op_sel_hi:[0,1]
  v_cvt_pk_bf16_f32 v12, v12, v12
  ds_write_addtid_b32 v244 offset:14416
  v_cvt_pk_bf16_f32 v246, v152, -v153
  v_pk_fma_f32 v[156:157], v[206:207], v[138:139], v[156:157] op_sel:[1,1,0] op_sel_hi:[1,0,1] neg_lo:[1,0,0]
  ds_write_addtid_b32 v245 offset:7888
  v_cvt_pk_bf16_f32 v247, v154, v155
  v_pk_fma_f32 v[158:159], v[132:133], v[134:135], v[158:159] op_sel:[1,1,0] op_sel_hi:[1,0,1] neg_lo:[1,0,0]
  v_lshlrev_b32 v12, 16, v12
  s_waitcnt vmcnt(6)
  v_mul_f32 v13, v13, v20
  ds_write_addtid_b32 v246 offset:14688
  v_cvt_pk_bf16_f32 v248, v156, -v157
  ds_write_addtid_b32 v247 offset:8160
  v_cvt_pk_bf16_f32 v249, v158, v159
  v_mul_f32 v12, v12, v20
  v_mul_f32 v13, s37, v13
  ds_write_addtid_b32 v248 offset:14960
  ds_write_addtid_b32 v249 offset:8432
  v_mul_f32 v12, -v12, s36
  v_mul_f32 v143, s38, v13
  ds_read_b128 v[40:43], v3 offset:8704
  ds_read_b128 v[72:75], v3 offset:0
  v_mul_f32 v142, s38, v12
  v_fract_f32 v143, v143
  ds_read_b128 v[44:47], v3 offset:8736
  ds_read_b128 v[76:79], v3 offset:32
  v_exp_f32 v142, v142
  v_cos_f32 v104, v143
  v_sin_f32 v105, v143
  ds_read_b128 v[48:51], v3 offset:8768
  ds_read_b128 v[80:83], v3 offset:64
  ds_read_b128 v[52:55], v3 offset:8800
  v_mul_f32 v104, v104, v142
  v_mul_f32 v105, v105, v142
  v_fract_f32 v146, v13
  ds_read_b128 v[84:87], v3 offset:96
  ds_read_b128 v[56:59], v3 offset:8832
  v_exp_f32 v145, v12
  v_cos_f32 v136, v146
  v_sin_f32 v137, v146
  v_pk_mul_f32 v[106:107], v[104:105], v[104:105] op_sel:[0,0] op_sel_hi:[0,1]
  ds_read_b128 v[88:91], v3 offset:128
  ds_read_b128 v[60:63], v3 offset:8864
  v_pk_fma_f32 v[106:107], v[104:105], v[104:105], v[106:107] op_sel:[1,1,0] op_sel_hi:[1,0,1] neg_lo:[1,0,0]
  ds_read_b128 v[92:95], v3 offset:160
  v_mul_f32 v136, v136, v145
  v_mul_f32 v137, v137, v145
  ds_read_b128 v[64:67], v3 offset:8896
  v_pk_mul_f32 v[110:111], v[106:107], v[106:107] op_sel:[0,0] op_sel_hi:[0,1]
  ds_read_b128 v[96:99], v3 offset:192
  s_waitcnt vmcnt(5)
  v_mul_f32 v140, v14, v22
  s_waitcnt vmcnt(4)
  v_mul_f32 v141, v15, v22
  v_pk_mul_f32 v[164:165], v[136:137], v[136:137] op_sel:[0,0] op_sel_hi:[0,1]
  v_pk_mul_f32 v[108:109], v[104:105], v[106:107] op_sel:[0,0] op_sel_hi:[0,1]
  ds_read_b128 v[68:71], v3 offset:8928
  v_cvt_pk_bf16_f32 v250, v104, v105
  v_pk_fma_f32 v[110:111], v[106:107], v[106:107], v[110:111] op_sel:[1,1,0] op_sel_hi:[1,0,1] neg_lo:[1,0,0]
  ds_read_b128 v[100:103], v3 offset:224
  v_cvt_pk_bf16_f32 v251, v140, -v141
  v_pk_fma_f32 v[164:165], v[136:137], v[136:137], v[164:165] op_sel:[1,1,0] op_sel_hi:[1,0,1] neg_lo:[1,0,0]
  v_pk_fma_f32 v[108:109], v[104:105], v[106:107], v[108:109] op_sel:[1,1,0] op_sel_hi:[1,0,1] neg_lo:[1,0,0]
  v_pk_mul_f32 v[168:169], v[140:141], v[136:137] op_sel:[0,0] op_sel_hi:[0,1]
  ds_write_addtid_b32 v250 offset:272
  v_cvt_pk_bf16_f32 v240, v106, v107
  v_pk_mul_f32 v[112:113], v[104:105], v[110:111] op_sel:[0,0] op_sel_hi:[0,1]
  ds_write_addtid_b32 v251 offset:8704
  v_cvt_pk_bf16_f32 v241, v108, v109
  v_pk_mul_f32 v[166:167], v[164:165], v[164:165] op_sel:[0,0] op_sel_hi:[0,1]
  v_pk_fma_f32 v[168:169], v[140:141], v[136:137], v[168:169] op_sel:[1,1,0] op_sel_hi:[1,0,1] neg_lo:[1,0,0]
  v_pk_mul_f32 v[170:171], v[140:141], v[164:165] op_sel:[0,0] op_sel_hi:[0,1]
  ds_write_addtid_b32 v240 offset:544
  v_cvt_pk_bf16_f32 v242, v110, v111
  v_pk_fma_f32 v[112:113], v[104:105], v[110:111], v[112:113] op_sel:[1,1,0] op_sel_hi:[1,0,1] neg_lo:[1,0,0]
  v_pk_mul_f32 v[114:115], v[106:107], v[110:111] op_sel:[0,0] op_sel_hi:[0,1]
  ds_write_addtid_b32 v241 offset:816
  v_pk_fma_f32 v[166:167], v[164:165], v[164:165], v[166:167] op_sel:[1,1,0] op_sel_hi:[1,0,1] neg_lo:[1,0,0]
  v_cvt_pk_bf16_f32 v243, v168, -v169
  v_pk_fma_f32 v[170:171], v[140:141], v[164:165], v[170:171] op_sel:[1,1,0] op_sel_hi:[1,0,1] neg_lo:[1,0,0]
  v_pk_mul_f32 v[172:173], v[168:169], v[164:165] op_sel:[0,0] op_sel_hi:[0,1]
  ds_write_addtid_b32 v242 offset:1088
  v_cvt_pk_bf16_f32 v244, v112, v113
  v_pk_fma_f32 v[114:115], v[106:107], v[110:111], v[114:115] op_sel:[1,1,0] op_sel_hi:[1,0,1] neg_lo:[1,0,0]
  v_pk_mul_f32 v[116:117], v[108:109], v[110:111] op_sel:[0,0] op_sel_hi:[0,1]
  v_pk_mul_f32 v[118:119], v[110:111], v[110:111] op_sel:[0,0] op_sel_hi:[0,1]
  v_mul_f32 v149, s39, v13
  ds_write_addtid_b32 v243 offset:8976
  v_cvt_pk_bf16_f32 v245, v170, -v171
  v_pk_fma_f32 v[172:173], v[168:169], v[164:165], v[172:173] op_sel:[1,1,0] op_sel_hi:[1,0,1] neg_lo:[1,0,0]
  v_pk_mul_f32 v[174:175], v[140:141], v[166:167] op_sel:[0,0] op_sel_hi:[0,1]
  ds_write_addtid_b32 v244 offset:1360
  v_cvt_pk_bf16_f32 v246, v114, v115
  v_pk_fma_f32 v[116:117], v[108:109], v[110:111], v[116:117] op_sel:[1,1,0] op_sel_hi:[1,0,1] neg_lo:[1,0,0]
  v_pk_fma_f32 v[118:119], v[110:111], v[110:111], v[118:119] op_sel:[1,1,0] op_sel_hi:[1,0,1] neg_lo:[1,0,0]
  v_mul_f32 v148, s39, v12
  v_fract_f32 v149, v149
  ds_write_addtid_b32 v245 offset:9248
  v_cvt_pk_bf16_f32 v247, v172, -v173
  v_pk_fma_f32 v[174:175], v[140:141], v[166:167], v[174:175] op_sel:[1,1,0] op_sel_hi:[1,0,1] neg_lo:[1,0,0]
  v_pk_mul_f32 v[152:153], v[168:169], v[166:167] op_sel:[0,0] op_sel_hi:[0,1]
  ds_write_addtid_b32 v246 offset:1632
  v_cvt_pk_bf16_f32 v248, v116, v117
  v_pk_mul_f32 v[120:121], v[104:105], v[118:119] op_sel:[0,0] op_sel_hi:[0,1]
  v_exp_f32 v148, v148
  v_cos_f32 v138, v149
  v_sin_f32 v139, v149
  ds_write_addtid_b32 v247 offset:9520
  v_cvt_pk_bf16_f32 v249, v174, -v175
  v_pk_fma_f32 v[152:153], v[168:169], v[166:167], v[152:153] op_sel:[1,1,0] op_sel_hi:[1,0,1] neg_lo:[1,0,0]
  v_pk_mul_f32 v[176:177], v[170:171], v[166:167] op_sel:[0,0] op_sel_hi:[0,1]
  ds_write_addtid_b32 v248 offset:1904
  v_cvt_pk_bf16_f32 v250, v118, v119
  v_pk_fma_f32 v[120:121], v[104:105], v[118:119], v[120:121] op_sel:[1,1,0] op_sel_hi:[1,0,1] neg_lo:[1,0,0]
  v_pk_mul_f32 v[122:123], v[106:107], v[118:119] op_sel:[0,0] op_sel_hi:[0,1]
  ds_write_addtid_b32 v249 offset:10880
  v_cvt_pk_bf16_f32 v251, v152, -v153
  v_pk_fma_f32 v[176:177], v[170:171], v[166:167], v[176:177] op_sel:[1,1,0] op_sel_hi:[1,0,1] neg_lo:[1,0,0]
  v_pk_mul_f32 v[154:155], v[172:173], v[166:167] op_sel:[0,0] op_sel_hi:[0,1]
  v_mul_f32 v138, v138, v148
  v_mul_f32 v139, v139, v148
  ds_write_addtid_b32 v250 offset:2176
  v_cvt_pk_bf16_f32 v240, v120, v121
  v_pk_fma_f32 v[122:123], v[106:107], v[118:119], v[122:123] op_sel:[1,1,0] op_sel_hi:[1,0,1] neg_lo:[1,0,0]
  v_pk_mul_f32 v[124:125], v[108:109], v[118:119] op_sel:[0,0] op_sel_hi:[0,1]
  ds_write_addtid_b32 v251 offset:11152
  v_cvt_pk_bf16_f32 v241, v176, -v177
  v_pk_fma_f32 v[154:155], v[172:173], v[166:167], v[154:155] op_sel:[1,1,0] op_sel_hi:[1,0,1] neg_lo:[1,0,0]
  v_pk_mul_f32 v[178:179], v[140:141], v[104:105] op_sel:[0,0] op_sel_hi:[0,1]
  v_pk_mul_f32 v[126:127], v[110:111], v[118:119] op_sel:[0,0] op_sel_hi:[0,1]
  ds_write_addtid_b32 v240 offset:2448
  v_cvt_pk_bf16_f32 v242, v122, v123
  v_pk_fma_f32 v[124:125], v[108:109], v[118:119], v[124:125] op_sel:[1,1,0] op_sel_hi:[1,0,1] neg_lo:[1,0,0]
  v_pk_mul_f32 v[180:181], v[140:141], v[138:139] op_sel:[0,0] op_sel_hi:[0,1]
  ds_write_addtid_b32 v241 offset:11424
  v_cvt_pk_bf16_f32 v243, v154, -v155
  v_pk_fma_f32 v[178:179], v[140:141], v[104:105], v[178:179] op_sel:[1,1,0] op_sel_hi:[1,0,1] neg_lo:[1,0,0]
  v_pk_fma_f32 v[126:127], v[110:111], v[118:119], v[126:127] op_sel:[1,1,0] op_sel_hi:[1,0,1] neg_lo:[1,0,0]
  ds_write_addtid_b32 v242 offset:2720
  v_cvt_pk_bf16_f32 v244, v124, v125
  v_pk_fma_f32 v[180:181], v[140:141], v[138:139], v[180:181] op_sel:[1,1,0] op_sel_hi:[1,0,1] neg_lo:[1,0,0]
  v_pk_mul_f32 v[128:129], v[112:113], v[118:119] op_sel:[0,0] op_sel_hi:[0,1]
  ds_write_addtid_b32 v243 offset:11696
  v_cvt_pk_bf16_f32 v245, v126, v127
  v_pk_mul_f32 v[182:183], v[178:179], v[138:139] op_sel:[0,0] op_sel_hi:[0,1]
  ds_write_addtid_b32 v244 offset:2992
  v_cvt_pk_bf16_f32 v246, v180, -v181
  v_pk_fma_f32 v[128:129], v[112:113], v[118:119], v[128:129] op_sel:[1,1,0] op_sel_hi:[1,0,1] neg_lo:[1,0,0]
  v_pk_mul_f32 v[130:131], v[114:115], v[118:119] op_sel:[0,0] op_sel_hi:[0,1]
  ds_write_addtid_b32 v245 offset:3264
  v_pk_fma_f32 v[182:183], v[178:179], v[138:139], v[182:183] op_sel:[1,1,0] op_sel_hi:[1,0,1] neg_lo:[1,0,0]
  v_pk_mul_f32 v[156:157], v[170:171], v[138:139] op_sel:[0,0] op_sel_hi:[0,1]
  ds_write_addtid_b32 v246 offset:9792
  v_cvt_pk_bf16_f32 v247, v128, v129
  v_pk_fma_f32 v[130:131], v[114:115], v[118:119], v[130:131] op_sel:[1,1,0] op_sel_hi:[1,0,1] neg_lo:[1,0,0]
  v_pk_mul_f32 v[132:133], v[116:117], v[118:119] op_sel:[0,0] op_sel_hi:[0,1]
  ds_write_addtid_b32 v246 offset:10064
  v_cvt_pk_bf16_f32 v248, v182, -v183
  v_pk_fma_f32 v[156:157], v[170:171], v[138:139], v[156:157] op_sel:[1,1,0] op_sel_hi:[1,0,1] neg_lo:[1,0,0]
  v_pk_mul_f32 v[184:185], v[174:175], v[138:139] op_sel:[0,0] op_sel_hi:[0,1]
  ds_write_addtid_b32 v247 offset:3536
  v_cvt_pk_bf16_f32 v249, v130, v131
  v_pk_fma_f32 v[132:133], v[116:117], v[118:119], v[132:133] op_sel:[1,1,0] op_sel_hi:[1,0,1] neg_lo:[1,0,0]
  v_pk_mul_f32 v[134:135], v[118:119], v[118:119] op_sel:[0,0] op_sel_hi:[0,1]
  ds_write_addtid_b32 v248 offset:12784
  v_cvt_pk_bf16_f32 v250, v156, -v157
  v_pk_fma_f32 v[184:185], v[174:175], v[138:139], v[184:185] op_sel:[1,1,0] op_sel_hi:[1,0,1] neg_lo:[1,0,0]
  ds_write_addtid_b32 v249 offset:3808
  v_cvt_pk_bf16_f32 v251, v132, v133
  v_pk_fma_f32 v[134:135], v[118:119], v[118:119], v[134:135] op_sel:[1,1,0] op_sel_hi:[1,0,1] neg_lo:[1,0,0]
  ds_write_addtid_b32 v250 offset:10336
  v_cvt_pk_bf16_f32 v240, v184, -v185
  v_pk_mul_f32 v[158:159], v[176:177], v[138:139] op_sel:[0,0] op_sel_hi:[0,1]
  ds_write_addtid_b32 v251 offset:4080
  v_pk_mul_f32 v[160:161], v[104:105], v[134:135] op_sel:[0,0] op_sel_hi:[0,1]
  ds_write_addtid_b32 v240 offset:10608
  v_pk_fma_f32 v[158:159], v[176:177], v[138:139], v[158:159] op_sel:[1,1,0] op_sel_hi:[1,0,1] neg_lo:[1,0,0]
  v_pk_mul_f32 v[186:187], v[180:181], v[138:139] op_sel:[0,0] op_sel_hi:[0,1]
  ds_write_addtid_b32 v240 offset:11968
  v_cvt_pk_bf16_f32 v241, v134, v135
  v_pk_fma_f32 v[160:161], v[104:105], v[134:135], v[160:161] op_sel:[1,1,0] op_sel_hi:[1,0,1] neg_lo:[1,0,0]
  v_pk_mul_f32 v[162:163], v[106:107], v[134:135] op_sel:[0,0] op_sel_hi:[0,1]
  ds_write_addtid_b32 v240 offset:12240
  v_cvt_pk_bf16_f32 v242, v158, -v159
  v_pk_fma_f32 v[186:187], v[180:181], v[138:139], v[186:187] op_sel:[1,1,0] op_sel_hi:[1,0,1] neg_lo:[1,0,0]
  v_pk_mul_f32 v[188:189], v[182:183], v[138:139] op_sel:[0,0] op_sel_hi:[0,1]
  ds_write_addtid_b32 v241 offset:4352
  v_cvt_pk_bf16_f32 v243, v160, v161
  v_pk_fma_f32 v[162:163], v[106:107], v[134:135], v[162:163] op_sel:[1,1,0] op_sel_hi:[1,0,1] neg_lo:[1,0,0]
  v_pk_mul_f32 v[152:153], v[108:109], v[134:135] op_sel:[0,0] op_sel_hi:[0,1]
  ds_write_addtid_b32 v242 offset:12512
  v_cvt_pk_bf16_f32 v244, v186, -v187
  v_pk_fma_f32 v[188:189], v[182:183], v[138:139], v[188:189] op_sel:[1,1,0] op_sel_hi:[1,0,1] neg_lo:[1,0,0]
  v_pk_mul_f32 v[190:191], v[184:185], v[138:139] op_sel:[0,0] op_sel_hi:[0,1]
  ds_write_addtid_b32 v243 offset:4624
  v_cvt_pk_bf16_f32 v245, v162, v163
  v_pk_fma_f32 v[152:153], v[108:109], v[134:135], v[152:153] op_sel:[1,1,0] op_sel_hi:[1,0,1] neg_lo:[1,0,0]
  v_pk_mul_f32 v[154:155], v[110:111], v[134:135] op_sel:[0,0] op_sel_hi:[0,1]
  ds_write_addtid_b32 v244 offset:15232
  v_cvt_pk_bf16_f32 v246, v188, -v189
  v_pk_fma_f32 v[190:191], v[184:185], v[138:139], v[190:191] op_sel:[1,1,0] op_sel_hi:[1,0,1] neg_lo:[1,0,0]
  v_pk_mul_f32 v[192:193], v[186:187], v[138:139] op_sel:[0,0] op_sel_hi:[0,1]
  ds_write_addtid_b32 v245 offset:4896
  v_cvt_pk_bf16_f32 v247, v152, v153
  v_pk_fma_f32 v[154:155], v[110:111], v[134:135], v[154:155] op_sel:[1,1,0] op_sel_hi:[1,0,1] neg_lo:[1,0,0]
  v_pk_mul_f32 v[156:157], v[112:113], v[134:135] op_sel:[0,0] op_sel_hi:[0,1]
  ds_write_addtid_b32 v246 offset:15776
  v_cvt_pk_bf16_f32 v248, v190, -v191
  v_pk_fma_f32 v[192:193], v[186:187], v[138:139], v[192:193] op_sel:[1,1,0] op_sel_hi:[1,0,1] neg_lo:[1,0,0]
  v_pk_mul_f32 v[194:195], v[188:189], v[138:139] op_sel:[0,0] op_sel_hi:[0,1]
  ds_write_addtid_b32 v247 offset:5168
  v_cvt_pk_bf16_f32 v249, v154, v155
  v_pk_fma_f32 v[156:157], v[112:113], v[134:135], v[156:157] op_sel:[1,1,0] op_sel_hi:[1,0,1] neg_lo:[1,0,0]
  v_pk_mul_f32 v[158:159], v[114:115], v[134:135] op_sel:[0,0] op_sel_hi:[0,1]
  ds_write_addtid_b32 v248 offset:15504
  v_cvt_pk_bf16_f32 v250, v192, -v193
  v_pk_fma_f32 v[194:195], v[188:189], v[138:139], v[194:195] op_sel:[1,1,0] op_sel_hi:[1,0,1] neg_lo:[1,0,0]
  v_pk_mul_f32 v[160:161], v[190:191], v[138:139] op_sel:[0,0] op_sel_hi:[0,1]
  ds_write_addtid_b32 v249 offset:5440
  v_cvt_pk_bf16_f32 v251, v156, v157
  v_pk_fma_f32 v[158:159], v[114:115], v[134:135], v[158:159] op_sel:[1,1,0] op_sel_hi:[1,0,1] neg_lo:[1,0,0]
  v_pk_mul_f32 v[162:163], v[116:117], v[134:135] op_sel:[0,0] op_sel_hi:[0,1]
  ds_write_addtid_b32 v250 offset:16320
  v_cvt_pk_bf16_f32 v240, v194, -v195
  v_pk_fma_f32 v[160:161], v[190:191], v[138:139], v[160:161] op_sel:[1,1,0] op_sel_hi:[1,0,1] neg_lo:[1,0,0]
  v_pk_mul_f32 v[196:197], v[192:193], v[138:139] op_sel:[0,0] op_sel_hi:[0,1]
  ds_write_addtid_b32 v251 offset:5712
  v_cvt_pk_bf16_f32 v241, v158, v159
  v_pk_fma_f32 v[162:163], v[116:117], v[134:135], v[162:163] op_sel:[1,1,0] op_sel_hi:[1,0,1] neg_lo:[1,0,0]
  v_pk_mul_f32 v[152:153], v[118:119], v[134:135] op_sel:[0,0] op_sel_hi:[0,1]
  ds_write_addtid_b32 v240 offset:16864
  v_cvt_pk_bf16_f32 v242, v160, -v161
  v_pk_fma_f32 v[196:197], v[192:193], v[138:139], v[196:197] op_sel:[1,1,0] op_sel_hi:[1,0,1] neg_lo:[1,0,0]
  v_pk_mul_f32 v[198:199], v[194:195], v[138:139] op_sel:[0,0] op_sel_hi:[0,1]
  ds_write_addtid_b32 v241 offset:5984
  v_cvt_pk_bf16_f32 v243, v162, v163
  v_pk_fma_f32 v[152:153], v[118:119], v[134:135], v[152:153] op_sel:[1,1,0] op_sel_hi:[1,0,1] neg_lo:[1,0,0]
  v_pk_mul_f32 v[154:155], v[120:121], v[134:135] op_sel:[0,0] op_sel_hi:[0,1]
  ds_write_addtid_b32 v242 offset:16592
  v_cvt_pk_bf16_f32 v244, v196, -v197
  v_pk_fma_f32 v[198:199], v[194:195], v[138:139], v[198:199] op_sel:[1,1,0] op_sel_hi:[1,0,1] neg_lo:[1,0,0]
  v_pk_mul_f32 v[200:201], v[196:197], v[138:139] op_sel:[0,0] op_sel_hi:[0,1]
  ds_write_addtid_b32 v243 offset:6256
  v_cvt_pk_bf16_f32 v245, v152, v153
  v_pk_fma_f32 v[154:155], v[120:121], v[134:135], v[154:155] op_sel:[1,1,0] op_sel_hi:[1,0,1] neg_lo:[1,0,0]
  v_pk_mul_f32 v[156:157], v[122:123], v[134:135] op_sel:[0,0] op_sel_hi:[0,1]
  ds_write_addtid_b32 v244 offset:13056
  v_cvt_pk_bf16_f32 v246, v198, -v199
  v_pk_fma_f32 v[200:201], v[196:197], v[138:139], v[200:201] op_sel:[1,1,0] op_sel_hi:[1,0,1] neg_lo:[1,0,0]
  v_pk_mul_f32 v[202:203], v[198:199], v[138:139] op_sel:[0,0] op_sel_hi:[0,1]
  ds_write_addtid_b32 v245 offset:6528
  v_cvt_pk_bf16_f32 v247, v154, v155
  v_pk_fma_f32 v[156:157], v[122:123], v[134:135], v[156:157] op_sel:[1,1,0] op_sel_hi:[1,0,1] neg_lo:[1,0,0]
  v_pk_mul_f32 v[158:159], v[124:125], v[134:135] op_sel:[0,0] op_sel_hi:[0,1]
  ds_write_addtid_b32 v246 offset:13328
  v_cvt_pk_bf16_f32 v248, v200, -v201
  v_pk_fma_f32 v[202:203], v[198:199], v[138:139], v[202:203] op_sel:[1,1,0] op_sel_hi:[1,0,1] neg_lo:[1,0,0]
  v_pk_mul_f32 v[204:205], v[200:201], v[138:139] op_sel:[0,0] op_sel_hi:[0,1]
  ds_write_addtid_b32 v247 offset:6800
  v_cvt_pk_bf16_f32 v249, v156, v157
  v_pk_fma_f32 v[158:159], v[124:125], v[134:135], v[158:159] op_sel:[1,1,0] op_sel_hi:[1,0,1] neg_lo:[1,0,0]
  v_pk_mul_f32 v[160:161], v[126:127], v[134:135] op_sel:[0,0] op_sel_hi:[0,1]
  ds_write_addtid_b32 v248 offset:13600
  v_cvt_pk_bf16_f32 v250, v202, -v203
  v_pk_fma_f32 v[204:205], v[200:201], v[138:139], v[204:205] op_sel:[1,1,0] op_sel_hi:[1,0,1] neg_lo:[1,0,0]
  v_pk_mul_f32 v[206:207], v[202:203], v[138:139] op_sel:[0,0] op_sel_hi:[0,1]
  s_waitcnt vmcnt(3)
  v_mul_f32 v16, s36, v16
  ds_write_addtid_b32 v249 offset:7072
  v_cvt_pk_bf16_f32 v251, v158, v159
  v_pk_fma_f32 v[160:161], v[126:127], v[134:135], v[160:161] op_sel:[1,1,0] op_sel_hi:[1,0,1] neg_lo:[1,0,0]
  v_pk_mul_f32 v[162:163], v[128:129], v[134:135] op_sel:[0,0] op_sel_hi:[0,1]
  ds_write_addtid_b32 v250 offset:13872
  v_cvt_pk_bf16_f32 v240, v204, -v205
  v_pk_fma_f32 v[206:207], v[202:203], v[138:139], v[206:207] op_sel:[1,1,0] op_sel_hi:[1,0,1] neg_lo:[1,0,0]
  v_pk_mul_f32 v[152:153], v[204:205], v[138:139] op_sel:[0,0] op_sel_hi:[0,1]
  v_exp_f32 v16, v16
  ds_write_addtid_b32 v251 offset:7344
  v_cvt_pk_bf16_f32 v241, v160, v161
  v_pk_fma_f32 v[162:163], v[128:129], v[134:135], v[162:163] op_sel:[1,1,0] op_sel_hi:[1,0,1] neg_lo:[1,0,0]
  v_pk_mul_f32 v[154:155], v[130:131], v[134:135] op_sel:[0,0] op_sel_hi:[0,1]
  ds_write_addtid_b32 v240 offset:14144
  v_cvt_pk_bf16_f32 v242, v206, -v207
  v_pk_fma_f32 v[152:153], v[204:205], v[138:139], v[152:153] op_sel:[1,1,0] op_sel_hi:[1,0,1] neg_lo:[1,0,0]
  v_pk_mul_f32 v[156:157], v[206:207], v[138:139] op_sel:[0,0] op_sel_hi:[0,1]
  ds_write_addtid_b32 v241 offset:7616
  v_cvt_pk_bf16_f32 v243, v162, v163
  v_pk_fma_f32 v[154:155], v[130:131], v[134:135], v[154:155] op_sel:[1,1,0] op_sel_hi:[1,0,1] neg_lo:[1,0,0]
  v_pk_mul_f32 v[158:159], v[132:133], v[134:135] op_sel:[0,0] op_sel_hi:[0,1]
  v_cvt_pk_bf16_f32 v16, v16, v16
  ds_write_addtid_b32 v242 offset:14416
  v_cvt_pk_bf16_f32 v244, v152, -v153
  v_pk_fma_f32 v[156:157], v[206:207], v[138:139], v[156:157] op_sel:[1,1,0] op_sel_hi:[1,0,1] neg_lo:[1,0,0]
  ds_write_addtid_b32 v243 offset:7888
  v_cvt_pk_bf16_f32 v245, v154, v155
  v_pk_fma_f32 v[158:159], v[132:133], v[134:135], v[158:159] op_sel:[1,1,0] op_sel_hi:[1,0,1] neg_lo:[1,0,0]
  v_lshlrev_b32 v16, 16, v16
  s_waitcnt vmcnt(2)
  v_mul_f32 v17, v17, v20
  ds_write_addtid_b32 v244 offset:14688
  v_cvt_pk_bf16_f32 v246, v156, -v157
  ds_write_addtid_b32 v245 offset:8160
  v_cvt_pk_bf16_f32 v247, v158, v159
  v_mul_f32 v16, v16, v20
  v_mul_f32 v17, s37, v17
  ds_write_addtid_b32 v246 offset:14960
  s_waitcnt lgkmcnt(0)
  v_mfma_f32_32x32x16_bf16 v[24:39], v[40:43], v[72:75], 0
  ds_write_addtid_b32 v247 offset:8432
  v_mul_f32 v16, -v16, s36
  v_mul_f32 v143, s38, v17
  ds_read_b128 v[40:43], v3 offset:8704
  v_mfma_f32_32x32x16_bf16 v[24:39], v[44:47], v[76:79], v[24:39]
  ds_read_b128 v[72:75], v3 offset:0
  v_mul_f32 v142, s38, v16
  v_fract_f32 v143, v143
  ds_read_b128 v[44:47], v3 offset:8736
  v_mfma_f32_32x32x16_bf16 v[24:39], v[48:51], v[80:83], v[24:39]
  ds_read_b128 v[76:79], v3 offset:32
  v_exp_f32 v142, v142
  v_cos_f32 v104, v143
  v_sin_f32 v105, v143
  ds_read_b128 v[48:51], v3 offset:8768
  v_mfma_f32_32x32x16_bf16 v[24:39], v[52:55], v[84:87], v[24:39]
  ds_read_b128 v[80:83], v3 offset:64
  ds_read_b128 v[52:55], v3 offset:8800
  v_mul_f32 v104, v104, v142
  v_mul_f32 v105, v105, v142
  v_fract_f32 v146, v17
  v_mfma_f32_32x32x16_bf16 v[24:39], v[56:59], v[88:91], v[24:39]
  ds_read_b128 v[84:87], v3 offset:96
  ds_read_b128 v[56:59], v3 offset:8832
  v_exp_f32 v145, v16
  v_cos_f32 v136, v146
  v_sin_f32 v137, v146
  v_pk_mul_f32 v[106:107], v[104:105], v[104:105] op_sel:[0,0] op_sel_hi:[0,1]
  v_mfma_f32_32x32x16_bf16 v[24:39], v[60:63], v[92:95], v[24:39]
  ds_read_b128 v[88:91], v3 offset:128
  ds_read_b128 v[60:63], v3 offset:8864
  v_pk_fma_f32 v[106:107], v[104:105], v[104:105], v[106:107] op_sel:[1,1,0] op_sel_hi:[1,0,1] neg_lo:[1,0,0]
  v_mfma_f32_32x32x16_bf16 v[24:39], v[64:67], v[96:99], v[24:39]
  ds_read_b128 v[92:95], v3 offset:160
  v_mul_f32 v136, v136, v145
  v_mul_f32 v137, v137, v145
  ds_read_b128 v[64:67], v3 offset:8896
  v_pk_mul_f32 v[110:111], v[106:107], v[106:107] op_sel:[0,0] op_sel_hi:[0,1]
  v_mfma_f32_32x32x16_bf16 v[24:39], v[68:71], v[100:103], v[24:39]
  ds_read_b128 v[96:99], v3 offset:192
  s_waitcnt vmcnt(1)
  v_mul_f32 v140, v18, v22
  s_waitcnt vmcnt(0)
  v_mul_f32 v141, v19, v22
  v_pk_mul_f32 v[164:165], v[136:137], v[136:137] op_sel:[0,0] op_sel_hi:[0,1]
  v_pk_mul_f32 v[108:109], v[104:105], v[106:107] op_sel:[0,0] op_sel_hi:[0,1]
  ds_read_b128 v[68:71], v3 offset:8928
  v_cvt_pk_bf16_f32 v248, v104, v105
  v_pk_fma_f32 v[110:111], v[106:107], v[106:107], v[110:111] op_sel:[1,1,0] op_sel_hi:[1,0,1] neg_lo:[1,0,0]
  ds_read_b128 v[100:103], v3 offset:224
  v_cvt_pk_bf16_f32 v249, v140, -v141
  v_pk_fma_f32 v[164:165], v[136:137], v[136:137], v[164:165] op_sel:[1,1,0] op_sel_hi:[1,0,1] neg_lo:[1,0,0]
  v_pk_fma_f32 v[108:109], v[104:105], v[106:107], v[108:109] op_sel:[1,1,0] op_sel_hi:[1,0,1] neg_lo:[1,0,0]
  v_pk_mul_f32 v[168:169], v[140:141], v[136:137] op_sel:[0,0] op_sel_hi:[0,1]
  ds_write_addtid_b32 v248 offset:272
  v_cvt_pk_bf16_f32 v250, v106, v107
  v_pk_mul_f32 v[112:113], v[104:105], v[110:111] op_sel:[0,0] op_sel_hi:[0,1]
  ds_write_addtid_b32 v249 offset:8704
  v_cvt_pk_bf16_f32 v251, v108, v109
  v_pk_mul_f32 v[166:167], v[164:165], v[164:165] op_sel:[0,0] op_sel_hi:[0,1]
  v_pk_fma_f32 v[168:169], v[140:141], v[136:137], v[168:169] op_sel:[1,1,0] op_sel_hi:[1,0,1] neg_lo:[1,0,0]
  v_pk_mul_f32 v[170:171], v[140:141], v[164:165] op_sel:[0,0] op_sel_hi:[0,1]
  ds_write_addtid_b32 v250 offset:544
  v_cvt_pk_bf16_f32 v240, v110, v111
  v_pk_fma_f32 v[112:113], v[104:105], v[110:111], v[112:113] op_sel:[1,1,0] op_sel_hi:[1,0,1] neg_lo:[1,0,0]
  v_pk_mul_f32 v[114:115], v[106:107], v[110:111] op_sel:[0,0] op_sel_hi:[0,1]
  ds_write_addtid_b32 v251 offset:816
  v_pk_fma_f32 v[166:167], v[164:165], v[164:165], v[166:167] op_sel:[1,1,0] op_sel_hi:[1,0,1] neg_lo:[1,0,0]
  v_cvt_pk_bf16_f32 v241, v168, -v169
  v_pk_fma_f32 v[170:171], v[140:141], v[164:165], v[170:171] op_sel:[1,1,0] op_sel_hi:[1,0,1] neg_lo:[1,0,0]
  v_pk_mul_f32 v[172:173], v[168:169], v[164:165] op_sel:[0,0] op_sel_hi:[0,1]
  ds_write_addtid_b32 v240 offset:1088
  v_cvt_pk_bf16_f32 v242, v112, v113
  v_pk_fma_f32 v[114:115], v[106:107], v[110:111], v[114:115] op_sel:[1,1,0] op_sel_hi:[1,0,1] neg_lo:[1,0,0]
  v_pk_mul_f32 v[116:117], v[108:109], v[110:111] op_sel:[0,0] op_sel_hi:[0,1]
  v_pk_mul_f32 v[118:119], v[110:111], v[110:111] op_sel:[0,0] op_sel_hi:[0,1]
  v_mul_f32 v149, s39, v17
  ds_write_addtid_b32 v241 offset:8976
  v_cvt_pk_bf16_f32 v243, v170, -v171
  v_pk_fma_f32 v[172:173], v[168:169], v[164:165], v[172:173] op_sel:[1,1,0] op_sel_hi:[1,0,1] neg_lo:[1,0,0]
  v_pk_mul_f32 v[174:175], v[140:141], v[166:167] op_sel:[0,0] op_sel_hi:[0,1]
  ds_write_addtid_b32 v242 offset:1360
  v_cvt_pk_bf16_f32 v244, v114, v115
  v_pk_fma_f32 v[116:117], v[108:109], v[110:111], v[116:117] op_sel:[1,1,0] op_sel_hi:[1,0,1] neg_lo:[1,0,0]
  v_pk_fma_f32 v[118:119], v[110:111], v[110:111], v[118:119] op_sel:[1,1,0] op_sel_hi:[1,0,1] neg_lo:[1,0,0]
  v_mul_f32 v148, s39, v16
  v_fract_f32 v149, v149
  ds_write_addtid_b32 v243 offset:9248
  v_cvt_pk_bf16_f32 v245, v172, -v173
  v_pk_fma_f32 v[174:175], v[140:141], v[166:167], v[174:175] op_sel:[1,1,0] op_sel_hi:[1,0,1] neg_lo:[1,0,0]
  v_pk_mul_f32 v[152:153], v[168:169], v[166:167] op_sel:[0,0] op_sel_hi:[0,1]
  ds_write_addtid_b32 v244 offset:1632
  v_cvt_pk_bf16_f32 v246, v116, v117
  v_pk_mul_f32 v[120:121], v[104:105], v[118:119] op_sel:[0,0] op_sel_hi:[0,1]
  v_exp_f32 v148, v148
  v_cos_f32 v138, v149
  v_sin_f32 v139, v149
  ds_write_addtid_b32 v245 offset:9520
  v_cvt_pk_bf16_f32 v247, v174, -v175
  v_pk_fma_f32 v[152:153], v[168:169], v[166:167], v[152:153] op_sel:[1,1,0] op_sel_hi:[1,0,1] neg_lo:[1,0,0]
  v_pk_mul_f32 v[176:177], v[170:171], v[166:167] op_sel:[0,0] op_sel_hi:[0,1]
  ds_write_addtid_b32 v246 offset:1904
  v_cvt_pk_bf16_f32 v248, v118, v119
  v_pk_fma_f32 v[120:121], v[104:105], v[118:119], v[120:121] op_sel:[1,1,0] op_sel_hi:[1,0,1] neg_lo:[1,0,0]
  v_pk_mul_f32 v[122:123], v[106:107], v[118:119] op_sel:[0,0] op_sel_hi:[0,1]
  ds_write_addtid_b32 v247 offset:10880
  v_cvt_pk_bf16_f32 v249, v152, -v153
  v_pk_fma_f32 v[176:177], v[170:171], v[166:167], v[176:177] op_sel:[1,1,0] op_sel_hi:[1,0,1] neg_lo:[1,0,0]
  v_pk_mul_f32 v[154:155], v[172:173], v[166:167] op_sel:[0,0] op_sel_hi:[0,1]
  v_mul_f32 v138, v138, v148
  v_mul_f32 v139, v139, v148
  ds_write_addtid_b32 v248 offset:2176
  v_cvt_pk_bf16_f32 v250, v120, v121
  v_pk_fma_f32 v[122:123], v[106:107], v[118:119], v[122:123] op_sel:[1,1,0] op_sel_hi:[1,0,1] neg_lo:[1,0,0]
  v_pk_mul_f32 v[124:125], v[108:109], v[118:119] op_sel:[0,0] op_sel_hi:[0,1]
  ds_write_addtid_b32 v249 offset:11152
  v_cvt_pk_bf16_f32 v251, v176, -v177
  v_pk_fma_f32 v[154:155], v[172:173], v[166:167], v[154:155] op_sel:[1,1,0] op_sel_hi:[1,0,1] neg_lo:[1,0,0]
  v_pk_mul_f32 v[178:179], v[140:141], v[104:105] op_sel:[0,0] op_sel_hi:[0,1]
  v_pk_mul_f32 v[126:127], v[110:111], v[118:119] op_sel:[0,0] op_sel_hi:[0,1]
  ds_write_addtid_b32 v250 offset:2448
  v_cvt_pk_bf16_f32 v240, v122, v123
  v_pk_fma_f32 v[124:125], v[108:109], v[118:119], v[124:125] op_sel:[1,1,0] op_sel_hi:[1,0,1] neg_lo:[1,0,0]
  v_pk_mul_f32 v[180:181], v[140:141], v[138:139] op_sel:[0,0] op_sel_hi:[0,1]
  ds_write_addtid_b32 v251 offset:11424
  v_cvt_pk_bf16_f32 v241, v154, -v155
  v_pk_fma_f32 v[178:179], v[140:141], v[104:105], v[178:179] op_sel:[1,1,0] op_sel_hi:[1,0,1] neg_lo:[1,0,0]
  v_pk_fma_f32 v[126:127], v[110:111], v[118:119], v[126:127] op_sel:[1,1,0] op_sel_hi:[1,0,1] neg_lo:[1,0,0]
  ds_write_addtid_b32 v240 offset:2720
  v_cvt_pk_bf16_f32 v242, v124, v125
  v_pk_fma_f32 v[180:181], v[140:141], v[138:139], v[180:181] op_sel:[1,1,0] op_sel_hi:[1,0,1] neg_lo:[1,0,0]
  v_pk_mul_f32 v[128:129], v[112:113], v[118:119] op_sel:[0,0] op_sel_hi:[0,1]
  ds_write_addtid_b32 v241 offset:11696
  v_cvt_pk_bf16_f32 v243, v126, v127
  v_pk_mul_f32 v[182:183], v[178:179], v[138:139] op_sel:[0,0] op_sel_hi:[0,1]
  ds_write_addtid_b32 v242 offset:2992
  v_cvt_pk_bf16_f32 v244, v180, -v181
  v_pk_fma_f32 v[128:129], v[112:113], v[118:119], v[128:129] op_sel:[1,1,0] op_sel_hi:[1,0,1] neg_lo:[1,0,0]
  v_pk_mul_f32 v[130:131], v[114:115], v[118:119] op_sel:[0,0] op_sel_hi:[0,1]
  ds_write_addtid_b32 v243 offset:3264
  v_pk_fma_f32 v[182:183], v[178:179], v[138:139], v[182:183] op_sel:[1,1,0] op_sel_hi:[1,0,1] neg_lo:[1,0,0]
  v_pk_mul_f32 v[156:157], v[170:171], v[138:139] op_sel:[0,0] op_sel_hi:[0,1]
  ds_write_addtid_b32 v244 offset:9792
  v_cvt_pk_bf16_f32 v245, v128, v129
  v_pk_fma_f32 v[130:131], v[114:115], v[118:119], v[130:131] op_sel:[1,1,0] op_sel_hi:[1,0,1] neg_lo:[1,0,0]
  v_pk_mul_f32 v[132:133], v[116:117], v[118:119] op_sel:[0,0] op_sel_hi:[0,1]
  ds_write_addtid_b32 v244 offset:10064
  v_cvt_pk_bf16_f32 v246, v182, -v183
  v_pk_fma_f32 v[156:157], v[170:171], v[138:139], v[156:157] op_sel:[1,1,0] op_sel_hi:[1,0,1] neg_lo:[1,0,0]
  v_pk_mul_f32 v[184:185], v[174:175], v[138:139] op_sel:[0,0] op_sel_hi:[0,1]
  ds_write_addtid_b32 v245 offset:3536
  v_cvt_pk_bf16_f32 v247, v130, v131
  v_pk_fma_f32 v[132:133], v[116:117], v[118:119], v[132:133] op_sel:[1,1,0] op_sel_hi:[1,0,1] neg_lo:[1,0,0]
  v_pk_mul_f32 v[134:135], v[118:119], v[118:119] op_sel:[0,0] op_sel_hi:[0,1]
  ds_write_addtid_b32 v246 offset:12784
  v_cvt_pk_bf16_f32 v248, v156, -v157
  v_pk_fma_f32 v[184:185], v[174:175], v[138:139], v[184:185] op_sel:[1,1,0] op_sel_hi:[1,0,1] neg_lo:[1,0,0]
  ds_write_addtid_b32 v247 offset:3808
  v_cvt_pk_bf16_f32 v249, v132, v133
  v_pk_fma_f32 v[134:135], v[118:119], v[118:119], v[134:135] op_sel:[1,1,0] op_sel_hi:[1,0,1] neg_lo:[1,0,0]
  ds_write_addtid_b32 v248 offset:10336
  v_cvt_pk_bf16_f32 v250, v184, -v185
  v_pk_mul_f32 v[158:159], v[176:177], v[138:139] op_sel:[0,0] op_sel_hi:[0,1]
  ds_write_addtid_b32 v249 offset:4080
  v_pk_mul_f32 v[160:161], v[104:105], v[134:135] op_sel:[0,0] op_sel_hi:[0,1]
  ds_write_addtid_b32 v250 offset:10608
  v_pk_fma_f32 v[158:159], v[176:177], v[138:139], v[158:159] op_sel:[1,1,0] op_sel_hi:[1,0,1] neg_lo:[1,0,0]
  v_pk_mul_f32 v[186:187], v[180:181], v[138:139] op_sel:[0,0] op_sel_hi:[0,1]
  ds_write_addtid_b32 v250 offset:11968
  v_cvt_pk_bf16_f32 v251, v134, v135
  v_pk_fma_f32 v[160:161], v[104:105], v[134:135], v[160:161] op_sel:[1,1,0] op_sel_hi:[1,0,1] neg_lo:[1,0,0]
  v_pk_mul_f32 v[162:163], v[106:107], v[134:135] op_sel:[0,0] op_sel_hi:[0,1]
  ds_write_addtid_b32 v250 offset:12240
  v_cvt_pk_bf16_f32 v240, v158, -v159
  v_pk_fma_f32 v[186:187], v[180:181], v[138:139], v[186:187] op_sel:[1,1,0] op_sel_hi:[1,0,1] neg_lo:[1,0,0]
  v_pk_mul_f32 v[188:189], v[182:183], v[138:139] op_sel:[0,0] op_sel_hi:[0,1]
  ds_write_addtid_b32 v251 offset:4352
  v_cvt_pk_bf16_f32 v241, v160, v161
  v_pk_fma_f32 v[162:163], v[106:107], v[134:135], v[162:163] op_sel:[1,1,0] op_sel_hi:[1,0,1] neg_lo:[1,0,0]
  v_pk_mul_f32 v[152:153], v[108:109], v[134:135] op_sel:[0,0] op_sel_hi:[0,1]
  ds_write_addtid_b32 v240 offset:12512
  v_cvt_pk_bf16_f32 v242, v186, -v187
  v_pk_fma_f32 v[188:189], v[182:183], v[138:139], v[188:189] op_sel:[1,1,0] op_sel_hi:[1,0,1] neg_lo:[1,0,0]
  v_pk_mul_f32 v[190:191], v[184:185], v[138:139] op_sel:[0,0] op_sel_hi:[0,1]
  ds_write_addtid_b32 v241 offset:4624
  v_cvt_pk_bf16_f32 v243, v162, v163
  v_pk_fma_f32 v[152:153], v[108:109], v[134:135], v[152:153] op_sel:[1,1,0] op_sel_hi:[1,0,1] neg_lo:[1,0,0]
  v_pk_mul_f32 v[154:155], v[110:111], v[134:135] op_sel:[0,0] op_sel_hi:[0,1]
  ds_write_addtid_b32 v242 offset:15232
  v_cvt_pk_bf16_f32 v244, v188, -v189
  v_pk_fma_f32 v[190:191], v[184:185], v[138:139], v[190:191] op_sel:[1,1,0] op_sel_hi:[1,0,1] neg_lo:[1,0,0]
  v_pk_mul_f32 v[192:193], v[186:187], v[138:139] op_sel:[0,0] op_sel_hi:[0,1]
  ds_write_addtid_b32 v243 offset:4896
  v_cvt_pk_bf16_f32 v245, v152, v153
  v_pk_fma_f32 v[154:155], v[110:111], v[134:135], v[154:155] op_sel:[1,1,0] op_sel_hi:[1,0,1] neg_lo:[1,0,0]
  v_pk_mul_f32 v[156:157], v[112:113], v[134:135] op_sel:[0,0] op_sel_hi:[0,1]
  ds_write_addtid_b32 v244 offset:15776
  v_cvt_pk_bf16_f32 v246, v190, -v191
  v_pk_fma_f32 v[192:193], v[186:187], v[138:139], v[192:193] op_sel:[1,1,0] op_sel_hi:[1,0,1] neg_lo:[1,0,0]
  v_pk_mul_f32 v[194:195], v[188:189], v[138:139] op_sel:[0,0] op_sel_hi:[0,1]
  ds_write_addtid_b32 v245 offset:5168
  v_cvt_pk_bf16_f32 v247, v154, v155
  v_pk_fma_f32 v[156:157], v[112:113], v[134:135], v[156:157] op_sel:[1,1,0] op_sel_hi:[1,0,1] neg_lo:[1,0,0]
  v_pk_mul_f32 v[158:159], v[114:115], v[134:135] op_sel:[0,0] op_sel_hi:[0,1]
  ds_write_addtid_b32 v246 offset:15504
  v_cvt_pk_bf16_f32 v248, v192, -v193
  v_pk_fma_f32 v[194:195], v[188:189], v[138:139], v[194:195] op_sel:[1,1,0] op_sel_hi:[1,0,1] neg_lo:[1,0,0]
  v_pk_mul_f32 v[160:161], v[190:191], v[138:139] op_sel:[0,0] op_sel_hi:[0,1]
  ds_write_addtid_b32 v247 offset:5440
  v_cvt_pk_bf16_f32 v249, v156, v157
  v_pk_fma_f32 v[158:159], v[114:115], v[134:135], v[158:159] op_sel:[1,1,0] op_sel_hi:[1,0,1] neg_lo:[1,0,0]
  v_pk_mul_f32 v[162:163], v[116:117], v[134:135] op_sel:[0,0] op_sel_hi:[0,1]
  ds_write_addtid_b32 v248 offset:16320
  v_cvt_pk_bf16_f32 v250, v194, -v195
  v_pk_fma_f32 v[160:161], v[190:191], v[138:139], v[160:161] op_sel:[1,1,0] op_sel_hi:[1,0,1] neg_lo:[1,0,0]
  v_pk_mul_f32 v[196:197], v[192:193], v[138:139] op_sel:[0,0] op_sel_hi:[0,1]
  ds_write_addtid_b32 v249 offset:5712
  v_cvt_pk_bf16_f32 v251, v158, v159
  v_pk_fma_f32 v[162:163], v[116:117], v[134:135], v[162:163] op_sel:[1,1,0] op_sel_hi:[1,0,1] neg_lo:[1,0,0]
  v_pk_mul_f32 v[152:153], v[118:119], v[134:135] op_sel:[0,0] op_sel_hi:[0,1]
  ds_write_addtid_b32 v250 offset:16864
  v_cvt_pk_bf16_f32 v240, v160, -v161
  v_pk_fma_f32 v[196:197], v[192:193], v[138:139], v[196:197] op_sel:[1,1,0] op_sel_hi:[1,0,1] neg_lo:[1,0,0]
  v_pk_mul_f32 v[198:199], v[194:195], v[138:139] op_sel:[0,0] op_sel_hi:[0,1]
  ds_write_addtid_b32 v251 offset:5984
  v_cvt_pk_bf16_f32 v241, v162, v163
  v_pk_fma_f32 v[152:153], v[118:119], v[134:135], v[152:153] op_sel:[1,1,0] op_sel_hi:[1,0,1] neg_lo:[1,0,0]
  v_pk_mul_f32 v[154:155], v[120:121], v[134:135] op_sel:[0,0] op_sel_hi:[0,1]
  ds_write_addtid_b32 v240 offset:16592
  v_cvt_pk_bf16_f32 v242, v196, -v197
  v_pk_fma_f32 v[198:199], v[194:195], v[138:139], v[198:199] op_sel:[1,1,0] op_sel_hi:[1,0,1] neg_lo:[1,0,0]
  v_pk_mul_f32 v[200:201], v[196:197], v[138:139] op_sel:[0,0] op_sel_hi:[0,1]
  ds_write_addtid_b32 v241 offset:6256
  v_cvt_pk_bf16_f32 v243, v152, v153
  v_pk_fma_f32 v[154:155], v[120:121], v[134:135], v[154:155] op_sel:[1,1,0] op_sel_hi:[1,0,1] neg_lo:[1,0,0]
  v_pk_mul_f32 v[156:157], v[122:123], v[134:135] op_sel:[0,0] op_sel_hi:[0,1]
  ds_write_addtid_b32 v242 offset:13056
  v_cvt_pk_bf16_f32 v244, v198, -v199
  v_pk_fma_f32 v[200:201], v[196:197], v[138:139], v[200:201] op_sel:[1,1,0] op_sel_hi:[1,0,1] neg_lo:[1,0,0]
  v_pk_mul_f32 v[202:203], v[198:199], v[138:139] op_sel:[0,0] op_sel_hi:[0,1]
  ds_write_addtid_b32 v243 offset:6528
  v_cvt_pk_bf16_f32 v245, v154, v155
  v_pk_fma_f32 v[156:157], v[122:123], v[134:135], v[156:157] op_sel:[1,1,0] op_sel_hi:[1,0,1] neg_lo:[1,0,0]
  v_pk_mul_f32 v[158:159], v[124:125], v[134:135] op_sel:[0,0] op_sel_hi:[0,1]
  ds_write_addtid_b32 v244 offset:13328
  v_cvt_pk_bf16_f32 v246, v200, -v201
  v_pk_fma_f32 v[202:203], v[198:199], v[138:139], v[202:203] op_sel:[1,1,0] op_sel_hi:[1,0,1] neg_lo:[1,0,0]
  v_pk_mul_f32 v[204:205], v[200:201], v[138:139] op_sel:[0,0] op_sel_hi:[0,1]
  ds_write_addtid_b32 v245 offset:6800
  v_cvt_pk_bf16_f32 v247, v156, v157
  v_pk_fma_f32 v[158:159], v[124:125], v[134:135], v[158:159] op_sel:[1,1,0] op_sel_hi:[1,0,1] neg_lo:[1,0,0]
  v_pk_mul_f32 v[160:161], v[126:127], v[134:135] op_sel:[0,0] op_sel_hi:[0,1]
  ds_write_addtid_b32 v246 offset:13600
  v_cvt_pk_bf16_f32 v248, v202, -v203
  v_pk_fma_f32 v[204:205], v[200:201], v[138:139], v[204:205] op_sel:[1,1,0] op_sel_hi:[1,0,1] neg_lo:[1,0,0]
  v_pk_mul_f32 v[206:207], v[202:203], v[138:139] op_sel:[0,0] op_sel_hi:[0,1]
  ds_write_addtid_b32 v247 offset:7072
  v_cvt_pk_bf16_f32 v249, v158, v159
  v_pk_fma_f32 v[160:161], v[126:127], v[134:135], v[160:161] op_sel:[1,1,0] op_sel_hi:[1,0,1] neg_lo:[1,0,0]
  v_pk_mul_f32 v[162:163], v[128:129], v[134:135] op_sel:[0,0] op_sel_hi:[0,1]
  ds_write_addtid_b32 v248 offset:13872
  v_cvt_pk_bf16_f32 v250, v204, -v205
  v_pk_fma_f32 v[206:207], v[202:203], v[138:139], v[206:207] op_sel:[1,1,0] op_sel_hi:[1,0,1] neg_lo:[1,0,0]
  v_pk_mul_f32 v[152:153], v[204:205], v[138:139] op_sel:[0,0] op_sel_hi:[0,1]
  ds_write_addtid_b32 v249 offset:7344
  v_cvt_pk_bf16_f32 v251, v160, v161
  v_pk_fma_f32 v[162:163], v[128:129], v[134:135], v[162:163] op_sel:[1,1,0] op_sel_hi:[1,0,1] neg_lo:[1,0,0]
  v_pk_mul_f32 v[154:155], v[130:131], v[134:135] op_sel:[0,0] op_sel_hi:[0,1]
  ds_write_addtid_b32 v250 offset:14144
  v_cvt_pk_bf16_f32 v240, v206, -v207
  v_pk_fma_f32 v[152:153], v[204:205], v[138:139], v[152:153] op_sel:[1,1,0] op_sel_hi:[1,0,1] neg_lo:[1,0,0]
  v_pk_mul_f32 v[156:157], v[206:207], v[138:139] op_sel:[0,0] op_sel_hi:[0,1]
  ds_write_addtid_b32 v251 offset:7616
  v_cvt_pk_bf16_f32 v241, v162, v163
  v_pk_fma_f32 v[154:155], v[130:131], v[134:135], v[154:155] op_sel:[1,1,0] op_sel_hi:[1,0,1] neg_lo:[1,0,0]
  v_pk_mul_f32 v[158:159], v[132:133], v[134:135] op_sel:[0,0] op_sel_hi:[0,1]
  ds_write_addtid_b32 v240 offset:14416
  v_cvt_pk_bf16_f32 v242, v152, -v153
  v_pk_fma_f32 v[156:157], v[206:207], v[138:139], v[156:157] op_sel:[1,1,0] op_sel_hi:[1,0,1] neg_lo:[1,0,0]
  ds_write_addtid_b32 v241 offset:7888
  v_cvt_pk_bf16_f32 v243, v154, v155
  v_pk_fma_f32 v[158:159], v[132:133], v[134:135], v[158:159] op_sel:[1,1,0] op_sel_hi:[1,0,1] neg_lo:[1,0,0]
  ds_write_addtid_b32 v242 offset:14688
  v_cvt_pk_bf16_f32 v244, v156, -v157
  ds_write_addtid_b32 v243 offset:8160
  v_cvt_pk_bf16_f32 v245, v158, v159
  ds_write_addtid_b32 v244 offset:14960
  s_waitcnt lgkmcnt(15)
  v_mfma_f32_32x32x16_bf16 v[24:39], v[40:43], v[72:75], v[24:39]
  ds_write_addtid_b32 v245 offset:8432
  ds_read_b128 v[40:43], v3 offset:8704
  v_mfma_f32_32x32x16_bf16 v[24:39], v[44:47], v[76:79], v[24:39]
  ds_read_b128 v[72:75], v3 offset:0
  ds_read_b128 v[44:47], v3 offset:8736
  v_mfma_f32_32x32x16_bf16 v[24:39], v[48:51], v[80:83], v[24:39]
  ds_read_b128 v[76:79], v3 offset:32
  ds_read_b128 v[48:51], v3 offset:8768
  v_mfma_f32_32x32x16_bf16 v[24:39], v[52:55], v[84:87], v[24:39]
  ds_read_b128 v[80:83], v3 offset:64
  ds_read_b128 v[52:55], v3 offset:8800
  v_mfma_f32_32x32x16_bf16 v[24:39], v[56:59], v[88:91], v[24:39]
  ds_read_b128 v[84:87], v3 offset:96
  ds_read_b128 v[56:59], v3 offset:8832
  v_mfma_f32_32x32x16_bf16 v[24:39], v[60:63], v[92:95], v[24:39]
  ds_read_b128 v[88:91], v3 offset:128
  ds_read_b128 v[60:63], v3 offset:8864
  v_mfma_f32_32x32x16_bf16 v[24:39], v[64:67], v[96:99], v[24:39]
  ds_read_b128 v[92:95], v3 offset:160
  ds_read_b128 v[64:67], v3 offset:8896
  v_mfma_f32_32x32x16_bf16 v[24:39], v[68:71], v[100:103], v[24:39]
  ds_read_b128 v[96:99], v3 offset:192
  ds_read_b128 v[68:71], v3 offset:8928
  ds_read_b128 v[100:103], v3 offset:224
  s_waitcnt lgkmcnt(14)
  v_mfma_f32_32x32x16_bf16 v[24:39], v[40:43], v[72:75], v[24:39]
  s_waitcnt lgkmcnt(12)
  v_mfma_f32_32x32x16_bf16 v[24:39], v[44:47], v[76:79], v[24:39]
  s_waitcnt lgkmcnt(10)
  v_mfma_f32_32x32x16_bf16 v[24:39], v[48:51], v[80:83], v[24:39]
  s_waitcnt lgkmcnt(8)
  v_mfma_f32_32x32x16_bf16 v[24:39], v[52:55], v[84:87], v[24:39]
  s_waitcnt lgkmcnt(6)
  v_mfma_f32_32x32x16_bf16 v[24:39], v[56:59], v[88:91], v[24:39]
  s_waitcnt lgkmcnt(4)
  v_mfma_f32_32x32x16_bf16 v[24:39], v[60:63], v[92:95], v[24:39]
  s_waitcnt lgkmcnt(2)
  v_mfma_f32_32x32x16_bf16 v[24:39], v[64:67], v[96:99], v[24:39]
  s_waitcnt lgkmcnt(0)
  v_mfma_f32_32x32x16_bf16 v[24:39], v[68:71], v[100:103], v[24:39]
  v_lshlrev_b32 v5, 4, v0
  v_add_u32 v5, s27, v5
  v_lshrrev_b32 v6, 5, v0
  v_lshl_add_u32 v6, v6, 9, v5
  s_mov_b32 s40, 0xaaaaaaaa
  s_mov_b32 s41, 0xaaaaaaaa
  s_nop 5
  v_add_f32 v24, v24, v21
  v_cvt_pk_bf16_f32 v40, v31, v30
  v_cvt_pk_bf16_f32 v41, v29, v28
  v_cvt_pk_bf16_f32 v42, v27, v26
  v_cvt_pk_bf16_f32 v43, v25, v24
  ds_write_b128 v5, v[40:43] offset:512
  v_cvt_pk_bf16_f32 v44, v38, v38
  v_cvt_pk_bf16_f32 v45, v37, v37
  v_cvt_pk_bf16_f32 v46, v37, v36
  v_cvt_pk_bf16_f32 v47, v36, v36
  ds_write_b128 v5, v[44:47] offset:1536
  v_cndmask_b32 v7, v32, v33, s[40:41]
  v_cvt_pk_bf16_f32 v48, v33, v33
  v_cvt_pk_bf16_f32 v49, v33, v7
  v_cvt_pk_bf16_f32 v50, v32, v32
  v_mov_b32 v51, v50
  ds_write_b128 v6, v[48:51] offset:2560
  v_cndmask_b32 v7, v34, v35, s[40:41]
  v_cvt_pk_bf16_f32 v52, v35, v35
  v_cvt_pk_bf16_f32 v53, v35, v7
  v_cvt_pk_bf16_f32 v54, v34, v34
  v_mov_b32 v55, v54
  ds_write_b128 v6, v[52:55] offset:3072
  s_mul_i32 s60, s60, 0x9e3779b1
  s_add_u32 s60, s60, 0x7f4a7c15
  s_lshr_b32 s28, s2, 3
  s_and_b32 s29, s2, 7
  s_and_b32 s25, s28, 7
  s_lshr_b32 s24, s28, 3
  s_lshl_b32 s30, s29, 2
  s_add_u32 s24, s24, s30
  s_lshl_b32 s62, s24, 3
  s_add_u32 s62, s62, s25
  s_lshl_b32 s24, s24, 2
  s_add_u32 s24, s24, s3
  s_and_b32 s53, s28, 15
  s_lshr_b32 s52, s28, 4
  s_lshl_b32 s30, s29, 1
  s_add_u32 s52, s52, s30
  s_lshl_b32 s63, s52, 4
  s_add_u32 s63, s63, s53
  s_lshl_b32 s52, s52, 2
  s_add_u32 s52, s52, s3
  s_lshl_b32 s52, s52, 1
  s_and_b32 s51, s3, 1
  v_lshlrev_b32 v1, 4, v0
  s_lshl_b32 s46, s3, 12
  s_add_u32 s46, s46, 122880
  v_add_u32 v8, s46, v1
  s_barrier
  ds_read_b128 v[224:227], v8 offset:16384
  ds_read_b128 v[208:211], v8 offset:0
  ds_read_b128 v[228:231], v8 offset:17408
  ds_read_b128 v[212:215], v8 offset:1024
  ds_read_b128 v[232:235], v8 offset:18432
  ds_read_b128 v[216:219], v8 offset:2048
  ds_read_b128 v[236:239], v8 offset:19456
  ds_read_b128 v[220:223], v8 offset:3072
  s_lshl_b32 s46, s3, 10
  s_add_u32 m0, s46, 40960
  s_add_u32 s46, s46, 73822
  v_lshl_add_u32 v8, v0, 2, s46
  v_subrev_u32 v9, 4158, v8
  s_mov_b32 s48, 0xffff0000
  s_waitcnt lgkmcnt(7)
  v_and_b32 v80, s48, v224
  v_and_b32 v82, s48, v226
  v_rcp_f32 v80, v80
  v_rcp_f32 v82, v82
  v_lshlrev_b32 v224, 16, v224
  v_lshlrev_b32 v226, 16, v226
  v_mul_f32 v81, -v224, v80
  s_waitcnt lgkmcnt(6)
  v_lshlrev_b32 v64, 16, v208
  v_and_b32 v65, s48, v208
  v_mul_f32 v83, -v226, v82
  v_lshlrev_b32 v68, 16, v210
  v_and_b32 v69, s48, v210
  v_pk_fma_f32 v[64:65], v[64:65], v[80:81], v[80:81] op_sel:[0,0,1] op_sel_hi:[1,0,1]
  v_pk_fma_f32 v[68:69], v[68:69], v[82:83], v[82:83] op_sel:[0,0,1] op_sel_hi:[1,0,1]
  v_lshlrev_b32 v66, 16, v209
  v_cvt_pk_bf16_f32 v72, v64, v68
  v_and_b32 v67, s48, v209
  v_lshlrev_b32 v70, 16, v211
  v_and_b32 v71, s48, v211
  ds_write_addtid_b32 v72 offset:28704
  ds_write_b16 v8, v72 offset:0
  v_cvt_pk_bf16_f32 v73, v65, v69
  s_waitcnt lgkmcnt(7)
  v_and_b32 v112, s48, v228
  v_and_b32 v114, s48, v230
  v_pk_fma_f32 v[66:67], v[66:67], v[80:81], v[80:81] op_sel:[0,0,1] op_sel_hi:[1,0,1]
  v_pk_fma_f32 v[70:71], v[70:71], v[82:83], v[82:83] op_sel:[0,0,1] op_sel_hi:[1,0,1]
  ds_write_b16_d16_hi v8, v72 offset:2
  ds_write_addtid_b32 v73 offset:37056
  v_rcp_f32 v112, v112
  v_rcp_f32 v114, v114
  ds_write_b16 v8, v73 offset:8352
  v_cvt_pk_bf16_f32 v74, v66, v70
  v_lshlrev_b32 v228, 16, v228
  v_lshlrev_b32 v230, 16, v230
  ds_write_b16_d16_hi v8, v73 offset:8354
  ds_write_addtid_b32 v74 offset:45408
  v_mul_f32 v113, -v228, v112
  s_waitcnt lgkmcnt(11)
  v_lshlrev_b32 v96, 16, v212
  v_and_b32 v97, s48, v212
  v_mul_f32 v115, -v230, v114
  v_lshlrev_b32 v100, 16, v214
  v_and_b32 v101, s48, v214
  ds_write_b16 v8, v74 offset:16704
  v_cvt_pk_bf16_f32 v75, v67, v71
  ds_write_b16_d16_hi v8, v74 offset:16706
  v_pk_fma_f32 v[96:97], v[96:97], v[112:113], v[112:113] op_sel:[0,0,1] op_sel_hi:[1,0,1]
  v_pk_fma_f32 v[100:101], v[100:101], v[114:115], v[114:115] op_sel:[0,0,1] op_sel_hi:[1,0,1]
  ds_write_addtid_b32 v75 offset:53760
  ds_write_b16 v8, v75 offset:25056
  v_cvt_pk_bf16_f32 v104, v96, v100
  ds_write_b16_d16_hi v8, v75 offset:25058
  v_lshlrev_b32 v98, 16, v213
  v_and_b32 v99, s48, v213
  v_lshlrev_b32 v102, 16, v215
  v_and_b32 v103, s48, v215
  ds_write_addtid_b32 v104 offset:28960
  ds_write_b16 v8, v104 offset:256
  v_cvt_pk_bf16_f32 v105, v97, v101
  s_waitcnt lgkmcnt(15)
  v_and_b32 v80, s48, v232
  v_and_b32 v82, s48, v234
  v_pk_fma_f32 v[98:99], v[98:99], v[112:113], v[112:113] op_sel:[0,0,1] op_sel_hi:[1,0,1]
  v_pk_fma_f32 v[102:103], v[102:103], v[114:115], v[114:115] op_sel:[0,0,1] op_sel_hi:[1,0,1]
  ds_write_b16_d16_hi v8, v104 offset:258
  ds_write_addtid_b32 v105 offset:37312
  v_rcp_f32 v80, v80
  v_rcp_f32 v82, v82
  ds_write_b16 v8, v105 offset:8608
  v_cvt_pk_bf16_f32 v106, v98, v102
  v_lshlrev_b32 v232, 16, v232
  v_lshlrev_b32 v234, 16, v234
  ds_write_b16_d16_hi v8, v105 offset:8610
  ds_write_addtid_b32 v106 offset:45664
  v_mul_f32 v81, -v232, v80
  v_lshlrev_b32 v64, 16, v216
  v_and_b32 v65, s48, v216
  v_mul_f32 v83, -v234, v82
  v_lshlrev_b32 v68, 16, v218
  v_and_b32 v69, s48, v218
  ds_write_b16 v8, v106 offset:16960
  v_cvt_pk_bf16_f32 v107, v99, v103
  ds_write_b16_d16_hi v8, v106 offset:16962
  v_pk_fma_f32 v[64:65], v[64:65], v[80:81], v[80:81] op_sel:[0,0,1] op_sel_hi:[1,0,1]
  v_pk_fma_f32 v[68:69], v[68:69], v[82:83], v[82:83] op_sel:[0,0,1] op_sel_hi:[1,0,1]
  ds_write_addtid_b32 v107 offset:54016
  ds_write_b16 v8, v107 offset:25312
  v_cvt_pk_bf16_f32 v72, v64, v68
  ds_write_b16_d16_hi v8, v107 offset:25314
  v_lshlrev_b32 v66, 16, v217
  v_and_b32 v67, s48, v217
  v_lshlrev_b32 v70, 16, v219
  v_and_b32 v71, s48, v219
  ds_write_addtid_b32 v72 offset:29216
  ds_write_b16 v8, v72 offset:512
  v_cvt_pk_bf16_f32 v73, v65, v69
  v_and_b32 v112, s48, v236
  v_and_b32 v114, s48, v238
  v_pk_fma_f32 v[66:67], v[66:67], v[80:81], v[80:81] op_sel:[0,0,1] op_sel_hi:[1,0,1]
  v_pk_fma_f32 v[70:71], v[70:71], v[82:83], v[82:83] op_sel:[0,0,1] op_sel_hi:[1,0,1]
  ds_write_b16_d16_hi v8, v72 offset:514
  ds_write_addtid_b32 v73 offset:37568
  v_rcp_f32 v112, v112
  v_rcp_f32 v114, v114
  ds_write_b16 v8, v73 offset:8864
  v_cvt_pk_bf16_f32 v74, v66, v70
  v_lshlrev_b32 v236, 16, v236
  v_lshlrev_b32 v238, 16, v238
  ds_write_b16_d16_hi v8, v73 offset:8866
  ds_write_addtid_b32 v74 offset:45920
  v_mul_f32 v113, -v236, v112
  s_waitcnt lgkmcnt(15)
  v_lshlrev_b32 v96, 16, v220
  v_and_b32 v97, s48, v220
  v_mul_f32 v115, -v238, v114
  v_lshlrev_b32 v100, 16, v222
  v_and_b32 v101, s48, v222
  ds_write_b16 v8, v74 offset:17216
  v_cvt_pk_bf16_f32 v75, v67, v71
  ds_write_b16_d16_hi v8, v74 offset:17218
  v_pk_fma_f32 v[96:97], v[96:97], v[112:113], v[112:113] op_sel:[0,0,1] op_sel_hi:[1,0,1]
  v_pk_fma_f32 v[100:101], v[100:101], v[114:115], v[114:115] op_sel:[0,0,1] op_sel_hi:[1,0,1]
  ds_write_addtid_b32 v75 offset:54272
  ds_write_b16 v8, v75 offset:25568
  v_cvt_pk_bf16_f32 v104, v96, v100
  ds_write_b16_d16_hi v8, v75 offset:25570
  v_lshlrev_b32 v98, 16, v221
  v_and_b32 v99, s48, v221
  v_lshlrev_b32 v102, 16, v223
  v_and_b32 v103, s48, v223
  ds_write_addtid_b32 v104 offset:29472
  ds_write_b16 v8, v104 offset:768
  v_cvt_pk_bf16_f32 v105, v97, v101
  v_pk_fma_f32 v[98:99], v[98:99], v[112:113], v[112:113] op_sel:[0,0,1] op_sel_hi:[1,0,1]
  v_pk_fma_f32 v[102:103], v[102:103], v[114:115], v[114:115] op_sel:[0,0,1] op_sel_hi:[1,0,1]
  ds_write_b16_d16_hi v8, v104 offset:770
  ds_write_addtid_b32 v105 offset:37824
  ds_write_b16 v8, v105 offset:9120
  v_cvt_pk_bf16_f32 v106, v98, v102
  ds_write_b16_d16_hi v8, v105 offset:9122
  ds_write_addtid_b32 v106 offset:46176
  ds_write_b16 v8, v106 offset:17472
  v_cvt_pk_bf16_f32 v107, v99, v103
  ds_write_b16_d16_hi v8, v106 offset:17474
  ds_write_addtid_b32 v107 offset:54528
  ds_write_b16 v8, v107 offset:25824
  ds_write_b16_d16_hi v8, v107 offset:25826
  s_mul_i32 s56, s25, 5
  s_lshr_b32 s56, s56, 1
  s_lshl_b32 s56, s56, 7
  s_add_u32 s56, s56, 28573696
  v_min_u32 v253, 2, v0
  v_lshlrev_b32 v253, 7, v253
  s_mov_b64 s[58:59], 7
  s_mov_b32 s49, s56
  v_and_b32 v8, 15, v0
  v_lshrrev_b32 v9, 4, v0
  v_and_b32 v10, 1, v0
  v_mul_u32_u24 v10, 4158, v10
  v_lshlrev_b32 v11, 1, v8
  v_sub_u32 v11, v11, v10
  v_lshl_add_u32 v11, v9, 4, v11
  s_mul_i32 s46, s3, 8352
  s_add_u32 s47, s46, 73792
  v_add_u32 v11, s47, v11
  v_add_u32 v12, 1024, v11
  v_add_u32 v13, 2048, v11
  v_add_u32 v14, 3072, v11
  v_lshlrev_b32 v15, 5, v8
  v_lshlrev_b32 v16, 4, v9
  v_sub_u32 v15, v15, v16
  s_mul_i32 s47, s3, 4608
  s_add_u32 s47, s47, 103120
  v_add_u32 v15, s47, v15
  s_waitcnt lgkmcnt(0)
  s_barrier
  ds_read_b128 v[56:59], v15 offset:448
  ds_read2_b32 v[120:121], v11 offset0:0 offset1:1
  ds_read2_b32 v[122:123], v11 offset0:2 offset1:3
  ds_read2_b32 v[124:125], v11 offset0:128 offset1:129
  ds_read2_b32 v[126:127], v11 offset0:130 offset1:131
  ds_read2_b32 v[128:129], v12 offset0:0 offset1:1
  ds_read2_b32 v[130:131], v12 offset0:2 offset1:3
  ds_read2_b32 v[132:133], v12 offset0:128 offset1:129
  ds_read2_b32 v[134:135], v12 offset0:130 offset1:131
  ds_read2_b32 v[136:137], v13 offset0:0 offset1:1
  ds_read2_b32 v[138:139], v13 offset0:2 offset1:3
  ds_read2_b32 v[140:141], v13 offset0:128 offset1:129
  ds_read2_b32 v[142:143], v13 offset0:130 offset1:131
  ds_read2_b32 v[144:145], v14 offset0:0 offset1:1
  ds_read2_b32 v[146:147], v14 offset0:2 offset1:3
  ds_read2_b32 v[148:149], v14 offset0:128 offset1:129
  ds_read2_b32 v[150:151], v14 offset0:130 offset1:131
  ds_read_b128 v[60:63], v15 offset:960
  ds_read_b128 v[64:67], v15 offset:1472
  ds_read_b128 v[68:71], v15 offset:1984
  ds_read_b128 v[72:75], v15 offset:2496
  ds_read_b128 v[76:79], v15 offset:3008
  ds_read_b128 v[80:83], v15 offset:3520
  ds_read_b128 v[84:87], v15 offset:4032
  v_lshlrev_b32 v16, 2, v9
  v_lshl_add_u32 v16, v8, 4, v16
  s_mul_i32 s47, s3, 8512
  s_add_u32 s47, s47, 69632
  v_add_u32 v16, s47, v16
  v_bfe_u32 v17, v0, 2, 2
  v_mul_u32_u24 v17, 8512, v17
  v_and_b32 v18, 3, v0
  v_lshl_add_u32 v17, v18, 3, v17
  v_lshl_add_u32 v17, v9, 5, v17
  s_lshl_b32 s47, s3, 10
  s_add_u32 s47, s47, 69632
  v_add_u32 v17, s47, v17
  v_mul_u32_u24 v18, 40960, v9
  v_lshl_add_u32 v18, v8, 4, v18
  s_mul_i32 s44, s3, 655360
  s_lshl_b32 s45, s50, 8
  s_add_u32 s44, s44, s45
  s_add_u32 s44, s44, 5242880
  s_waitcnt lgkmcnt(15)
  v_mfma_f32_16x16x32_bf16 v[24:27], v[120:123], v[56:59], 0
  ds_read_b128 v[88:91], v15 offset:384
  v_mfma_f32_16x16x32_bf16 v[28:31], v[124:127], v[56:59], 0
  ds_read2_b32 v[152:153], v11 offset0:16 offset1:17
  v_mfma_f32_16x16x32_bf16 v[32:35], v[128:131], v[56:59], 0
  ds_read2_b32 v[154:155], v11 offset0:18 offset1:19
  v_mfma_f32_16x16x32_bf16 v[36:39], v[132:135], v[56:59], 0
  ds_read2_b32 v[156:157], v11 offset0:144 offset1:145
  s_waitcnt lgkmcnt(15)
  v_mfma_f32_16x16x32_bf16 v[40:43], v[136:139], v[56:59], 0
  ds_read2_b32 v[158:159], v11 offset0:146 offset1:147
  v_mfma_f32_16x16x32_bf16 v[44:47], v[140:143], v[56:59], 0
  ds_read2_b32 v[160:161], v12 offset0:16 offset1:17
  s_waitcnt lgkmcnt(15)
  v_mfma_f32_16x16x32_bf16 v[48:51], v[144:147], v[56:59], 0
  ds_read2_b32 v[162:163], v12 offset0:18 offset1:19
  s_waitcnt lgkmcnt(14)
  v_mfma_f32_16x16x32_bf16 v[52:55], v[148:151], v[56:59], 0
  ds_read2_b32 v[164:165], v12 offset0:144 offset1:145
  s_waitcnt lgkmcnt(14)
  v_mfma_f32_16x16x32_bf16 v[28:31], v[120:123], v[60:63], v[28:31]
  ds_read2_b32 v[166:167], v12 offset0:146 offset1:147
  v_mfma_f32_16x16x32_bf16 v[32:35], v[124:127], v[60:63], v[32:35]
  ds_read2_b32 v[168:169], v13 offset0:16 offset1:17
  v_mfma_f32_16x16x32_bf16 v[36:39], v[128:131], v[60:63], v[36:39]
  ds_read2_b32 v[170:171], v13 offset0:18 offset1:19
  v_mfma_f32_16x16x32_bf16 v[40:43], v[132:135], v[60:63], v[40:43]
  ds_read2_b32 v[172:173], v13 offset0:144 offset1:145
  v_mfma_f32_16x16x32_bf16 v[44:47], v[136:139], v[60:63], v[44:47]
  ds_read2_b32 v[174:175], v13 offset0:146 offset1:147
  v_mfma_f32_16x16x32_bf16 v[48:51], v[140:143], v[60:63], v[48:51]
  ds_read2_b32 v[176:177], v14 offset0:16 offset1:17
  v_mfma_f32_16x16x32_bf16 v[52:55], v[144:147], v[60:63], v[52:55]
  ds_read2_b32 v[178:179], v14 offset0:18 offset1:19
  s_waitcnt lgkmcnt(15)
  v_mfma_f32_16x16x32_bf16 v[32:35], v[120:123], v[64:67], v[32:35]
  ds_read2_b32 v[180:181], v14 offset0:144 offset1:145
  v_mfma_f32_16x16x32_bf16 v[36:39], v[124:127], v[64:67], v[36:39]
  ds_read2_b32 v[182:183], v14 offset0:146 offset1:147
  v_mfma_f32_16x16x32_bf16 v[40:43], v[128:131], v[64:67], v[40:43]
  ds_read_b128 v[92:95], v15 offset:896
  v_mfma_f32_16x16x32_bf16 v[44:47], v[132:135], v[64:67], v[44:47]
  ds_read_b128 v[96:99], v15 offset:1408
  v_mfma_f32_16x16x32_bf16 v[48:51], v[136:139], v[64:67], v[48:51]
  ds_read_b128 v[100:103], v15 offset:1920
  v_mfma_f32_16x16x32_bf16 v[52:55], v[140:143], v[64:67], v[52:55]
  ds_read_b128 v[104:107], v15 offset:2432
  v_mfma_f32_16x16x32_bf16 v[36:39], v[120:123], v[68:71], v[36:39]
  ds_read_b128 v[108:111], v15 offset:2944
  v_mfma_f32_16x16x32_bf16 v[40:43], v[124:127], v[68:71], v[40:43]
  ds_read_b128 v[112:115], v15 offset:3456
  v_mfma_f32_16x16x32_bf16 v[44:47], v[128:131], v[68:71], v[44:47]
  ds_read_b128 v[116:119], v15 offset:3968
  v_mfma_f32_16x16x32_bf16 v[48:51], v[132:135], v[68:71], v[48:51]
  v_mfma_f32_16x16x32_bf16 v[52:55], v[136:139], v[68:71], v[52:55]
  v_mfma_f32_16x16x32_bf16 v[40:43], v[120:123], v[72:75], v[40:43]
  v_mfma_f32_16x16x32_bf16 v[44:47], v[124:127], v[72:75], v[44:47]
  v_mfma_f32_16x16x32_bf16 v[48:51], v[128:131], v[72:75], v[48:51]
  v_mfma_f32_16x16x32_bf16 v[52:55], v[132:135], v[72:75], v[52:55]
  v_mfma_f32_16x16x32_bf16 v[52:55], v[128:131], v[76:79], v[52:55]
  v_mfma_f32_16x16x32_bf16 v[44:47], v[120:123], v[76:79], v[44:47]
  v_mfma_f32_16x16x32_bf16 v[48:51], v[124:127], v[76:79], v[48:51]
  v_mfma_f32_16x16x32_bf16 v[52:55], v[124:127], v[80:83], v[52:55]
  v_mfma_f32_16x16x32_bf16 v[48:51], v[120:123], v[80:83], v[48:51]
  v_mfma_f32_16x16x32_bf16 v[52:55], v[120:123], v[84:87], v[52:55]
  s_waitcnt lgkmcnt(0)
  v_mfma_f32_16x16x32_bf16 v[24:27], v[152:155], v[88:91], v[24:27]
  ds_read_b128 v[56:59], v15 offset:320
  v_mfma_f32_16x16x32_bf16 v[28:31], v[156:159], v[88:91], v[28:31]
  ds_read2_b32 v[120:121], v11 offset0:32 offset1:33
  v_mfma_f32_16x16x32_bf16 v[32:35], v[160:163], v[88:91], v[32:35]
  ds_read2_b32 v[122:123], v11 offset0:34 offset1:35
  v_mfma_f32_16x16x32_bf16 v[36:39], v[164:167], v[88:91], v[36:39]
  ds_read2_b32 v[124:125], v11 offset0:160 offset1:161
  v_mfma_f32_16x16x32_bf16 v[40:43], v[168:171], v[88:91], v[40:43]
  ds_read2_b32 v[126:127], v11 offset0:162 offset1:163
  v_mfma_f32_16x16x32_bf16 v[44:47], v[172:175], v[88:91], v[44:47]
  ds_read2_b32 v[128:129], v12 offset0:32 offset1:33
  v_mfma_f32_16x16x32_bf16 v[48:51], v[176:179], v[88:91], v[48:51]
  ds_read2_b32 v[130:131], v12 offset0:34 offset1:35
  v_mfma_f32_16x16x32_bf16 v[52:55], v[180:183], v[88:91], v[52:55]
  ds_read2_b32 v[132:133], v12 offset0:160 offset1:161
  v_mfma_f32_16x16x32_bf16 v[28:31], v[152:155], v[92:95], v[28:31]
  ds_read2_b32 v[134:135], v12 offset0:162 offset1:163
  v_mfma_f32_16x16x32_bf16 v[32:35], v[156:159], v[92:95], v[32:35]
  ds_read2_b32 v[136:137], v13 offset0:32 offset1:33
  v_mfma_f32_16x16x32_bf16 v[36:39], v[160:163], v[92:95], v[36:39]
  ds_read2_b32 v[138:139], v13 offset0:34 offset1:35
  v_mfma_f32_16x16x32_bf16 v[40:43], v[164:167], v[92:95], v[40:43]
  ds_read2_b32 v[140:141], v13 offset0:160 offset1:161
  v_mfma_f32_16x16x32_bf16 v[44:47], v[168:171], v[92:95], v[44:47]
  ds_read2_b32 v[142:143], v13 offset0:162 offset1:163
  v_mfma_f32_16x16x32_bf16 v[48:51], v[172:175], v[92:95], v[48:51]
  ds_read2_b32 v[144:145], v14 offset0:32 offset1:33
  v_mfma_f32_16x16x32_bf16 v[52:55], v[176:179], v[92:95], v[52:55]
  ds_read2_b32 v[146:147], v14 offset0:34 offset1:35
  v_mfma_f32_16x16x32_bf16 v[32:35], v[152:155], v[96:99], v[32:35]
  ds_read2_b32 v[148:149], v14 offset0:160 offset1:161
  v_mfma_f32_16x16x32_bf16 v[36:39], v[156:159], v[96:99], v[36:39]
  ds_read2_b32 v[150:151], v14 offset0:162 offset1:163
  v_mfma_f32_16x16x32_bf16 v[40:43], v[160:163], v[96:99], v[40:43]
  ds_read_b128 v[60:63], v15 offset:832
  v_mfma_f32_16x16x32_bf16 v[44:47], v[164:167], v[96:99], v[44:47]
  ds_read_b128 v[64:67], v15 offset:1344
  v_mfma_f32_16x16x32_bf16 v[48:51], v[168:171], v[96:99], v[48:51]
  ds_read_b128 v[68:71], v15 offset:1856
  v_mfma_f32_16x16x32_bf16 v[52:55], v[172:175], v[96:99], v[52:55]
  ds_read_b128 v[72:75], v15 offset:2368
  v_mfma_f32_16x16x32_bf16 v[36:39], v[152:155], v[100:103], v[36:39]
  ds_read_b128 v[76:79], v15 offset:2880
  v_mfma_f32_16x16x32_bf16 v[40:43], v[156:159], v[100:103], v[40:43]
  ds_read_b128 v[80:83], v15 offset:3392
  v_mfma_f32_16x16x32_bf16 v[44:47], v[160:163], v[100:103], v[44:47]
  ds_read_b128 v[84:87], v15 offset:3904
  v_mfma_f32_16x16x32_bf16 v[48:51], v[164:167], v[100:103], v[48:51]
  v_mfma_f32_16x16x32_bf16 v[52:55], v[168:171], v[100:103], v[52:55]
  v_mfma_f32_16x16x32_bf16 v[40:43], v[152:155], v[104:107], v[40:43]
  v_mfma_f32_16x16x32_bf16 v[44:47], v[156:159], v[104:107], v[44:47]
  v_mfma_f32_16x16x32_bf16 v[48:51], v[160:163], v[104:107], v[48:51]
  v_mfma_f32_16x16x32_bf16 v[52:55], v[164:167], v[104:107], v[52:55]
  v_mfma_f32_16x16x32_bf16 v[52:55], v[160:163], v[108:111], v[52:55]
  v_mfma_f32_16x16x32_bf16 v[44:47], v[152:155], v[108:111], v[44:47]
  v_mfma_f32_16x16x32_bf16 v[48:51], v[156:159], v[108:111], v[48:51]
  v_mfma_f32_16x16x32_bf16 v[52:55], v[156:159], v[112:115], v[52:55]
  v_mfma_f32_16x16x32_bf16 v[48:51], v[152:155], v[112:115], v[48:51]
  v_mfma_f32_16x16x32_bf16 v[52:55], v[152:155], v[116:119], v[52:55]
  s_waitcnt lgkmcnt(0)
  v_mfma_f32_16x16x32_bf16 v[24:27], v[120:123], v[56:59], v[24:27]
  ds_read_b128 v[88:91], v15 offset:256
  v_mfma_f32_16x16x32_bf16 v[28:31], v[124:127], v[56:59], v[28:31]
  ds_read2_b32 v[152:153], v11 offset0:48 offset1:49
  v_mfma_f32_16x16x32_bf16 v[32:35], v[128:131], v[56:59], v[32:35]
  ds_read2_b32 v[154:155], v11 offset0:50 offset1:51
  v_mfma_f32_16x16x32_bf16 v[36:39], v[132:135], v[56:59], v[36:39]
  ds_read2_b32 v[156:157], v11 offset0:176 offset1:177
  v_mfma_f32_16x16x32_bf16 v[40:43], v[136:139], v[56:59], v[40:43]
  ds_read2_b32 v[158:159], v11 offset0:178 offset1:179
  v_mfma_f32_16x16x32_bf16 v[44:47], v[140:143], v[56:59], v[44:47]
  ds_read2_b32 v[160:161], v12 offset0:48 offset1:49
  v_mfma_f32_16x16x32_bf16 v[48:51], v[144:147], v[56:59], v[48:51]
  ds_read2_b32 v[162:163], v12 offset0:50 offset1:51
  v_mfma_f32_16x16x32_bf16 v[52:55], v[148:151], v[56:59], v[52:55]
  ds_read2_b32 v[164:165], v12 offset0:176 offset1:177
  v_mfma_f32_16x16x32_bf16 v[28:31], v[120:123], v[60:63], v[28:31]
  ds_read2_b32 v[166:167], v12 offset0:178 offset1:179
  v_mfma_f32_16x16x32_bf16 v[32:35], v[124:127], v[60:63], v[32:35]
  ds_read2_b32 v[168:169], v13 offset0:48 offset1:49
  v_mfma_f32_16x16x32_bf16 v[36:39], v[128:131], v[60:63], v[36:39]
  ds_read2_b32 v[170:171], v13 offset0:50 offset1:51
  v_mfma_f32_16x16x32_bf16 v[40:43], v[132:135], v[60:63], v[40:43]
  ds_read2_b32 v[172:173], v13 offset0:176 offset1:177
  v_mfma_f32_16x16x32_bf16 v[44:47], v[136:139], v[60:63], v[44:47]
  ds_read2_b32 v[174:175], v13 offset0:178 offset1:179
  v_mfma_f32_16x16x32_bf16 v[48:51], v[140:143], v[60:63], v[48:51]
  ds_read2_b32 v[176:177], v14 offset0:48 offset1:49
  v_mfma_f32_16x16x32_bf16 v[52:55], v[144:147], v[60:63], v[52:55]
  ds_read2_b32 v[178:179], v14 offset0:50 offset1:51
  v_mfma_f32_16x16x32_bf16 v[32:35], v[120:123], v[64:67], v[32:35]
  ds_read2_b32 v[180:181], v14 offset0:176 offset1:177
  v_mfma_f32_16x16x32_bf16 v[36:39], v[124:127], v[64:67], v[36:39]
  ds_read2_b32 v[182:183], v14 offset0:178 offset1:179
  v_mfma_f32_16x16x32_bf16 v[40:43], v[128:131], v[64:67], v[40:43]
  ds_read_b128 v[92:95], v15 offset:768
  v_mfma_f32_16x16x32_bf16 v[44:47], v[132:135], v[64:67], v[44:47]
  ds_read_b128 v[96:99], v15 offset:1280
  v_mfma_f32_16x16x32_bf16 v[48:51], v[136:139], v[64:67], v[48:51]
  ds_read_b128 v[100:103], v15 offset:1792
  v_mfma_f32_16x16x32_bf16 v[52:55], v[140:143], v[64:67], v[52:55]
  ds_read_b128 v[104:107], v15 offset:2304
  v_mfma_f32_16x16x32_bf16 v[36:39], v[120:123], v[68:71], v[36:39]
  ds_read_b128 v[108:111], v15 offset:2816
  v_mfma_f32_16x16x32_bf16 v[40:43], v[124:127], v[68:71], v[40:43]
  ds_read_b128 v[112:115], v15 offset:3328
  v_mfma_f32_16x16x32_bf16 v[44:47], v[128:131], v[68:71], v[44:47]
  ds_read_b128 v[116:119], v15 offset:3840
  v_mfma_f32_16x16x32_bf16 v[48:51], v[132:135], v[68:71], v[48:51]
  v_mfma_f32_16x16x32_bf16 v[52:55], v[136:139], v[68:71], v[52:55]
  v_mfma_f32_16x16x32_bf16 v[40:43], v[120:123], v[72:75], v[40:43]
  v_mfma_f32_16x16x32_bf16 v[44:47], v[124:127], v[72:75], v[44:47]
  v_mfma_f32_16x16x32_bf16 v[48:51], v[128:131], v[72:75], v[48:51]
  v_mfma_f32_16x16x32_bf16 v[52:55], v[132:135], v[72:75], v[52:55]
  v_mfma_f32_16x16x32_bf16 v[52:55], v[128:131], v[76:79], v[52:55]
  v_mfma_f32_16x16x32_bf16 v[44:47], v[120:123], v[76:79], v[44:47]
  v_mfma_f32_16x16x32_bf16 v[48:51], v[124:127], v[76:79], v[48:51]
  v_mfma_f32_16x16x32_bf16 v[52:55], v[124:127], v[80:83], v[52:55]
  v_mfma_f32_16x16x32_bf16 v[48:51], v[120:123], v[80:83], v[48:51]
  v_mfma_f32_16x16x32_bf16 v[52:55], v[120:123], v[84:87], v[52:55]
  s_waitcnt lgkmcnt(0)
  buffer_load_dword v253, v253, s[4:7], s49 offen sc1
  v_mfma_f32_16x16x32_bf16 v[24:27], v[152:155], v[88:91], v[24:27]
  ds_read_b128 v[56:59], v15 offset:192
  v_mfma_f32_16x16x32_bf16 v[28:31], v[156:159], v[88:91], v[28:31]
  ds_read2_b32 v[120:121], v11 offset0:64 offset1:65
  v_mfma_f32_16x16x32_bf16 v[32:35], v[160:163], v[88:91], v[32:35]
  ds_read2_b32 v[122:123], v11 offset0:66 offset1:67
  v_mfma_f32_16x16x32_bf16 v[36:39], v[164:167], v[88:91], v[36:39]
  ds_read2_b32 v[124:125], v11 offset0:192 offset1:193
  v_mfma_f32_16x16x32_bf16 v[40:43], v[168:171], v[88:91], v[40:43]
  ds_read2_b32 v[126:127], v11 offset0:194 offset1:195
  v_mfma_f32_16x16x32_bf16 v[44:47], v[172:175], v[88:91], v[44:47]
  ds_read2_b32 v[128:129], v12 offset0:64 offset1:65
  v_mfma_f32_16x16x32_bf16 v[48:51], v[176:179], v[88:91], v[48:51]
  ds_read2_b32 v[130:131], v12 offset0:66 offset1:67
  v_mfma_f32_16x16x32_bf16 v[52:55], v[180:183], v[88:91], v[52:55]
  ds_read2_b32 v[132:133], v12 offset0:192 offset1:193
  v_mfma_f32_16x16x32_bf16 v[28:31], v[152:155], v[92:95], v[28:31]
  ds_read2_b32 v[134:135], v12 offset0:194 offset1:195
  v_mfma_f32_16x16x32_bf16 v[32:35], v[156:159], v[92:95], v[32:35]
  ds_read2_b32 v[136:137], v13 offset0:64 offset1:65
  v_mfma_f32_16x16x32_bf16 v[36:39], v[160:163], v[92:95], v[36:39]
  ds_read2_b32 v[138:139], v13 offset0:66 offset1:67
  v_mfma_f32_16x16x32_bf16 v[40:43], v[164:167], v[92:95], v[40:43]
  ds_read2_b32 v[140:141], v13 offset0:192 offset1:193
  v_mfma_f32_16x16x32_bf16 v[44:47], v[168:171], v[92:95], v[44:47]
  ds_read2_b32 v[142:143], v13 offset0:194 offset1:195
  v_mfma_f32_16x16x32_bf16 v[48:51], v[172:175], v[92:95], v[48:51]
  ds_read2_b32 v[144:145], v14 offset0:64 offset1:65
  v_mfma_f32_16x16x32_bf16 v[52:55], v[176:179], v[92:95], v[52:55]
  ds_read2_b32 v[146:147], v14 offset0:66 offset1:67
  v_mfma_f32_16x16x32_bf16 v[32:35], v[152:155], v[96:99], v[32:35]
  ds_read2_b32 v[148:149], v14 offset0:192 offset1:193
  v_mfma_f32_16x16x32_bf16 v[36:39], v[156:159], v[96:99], v[36:39]
  ds_read2_b32 v[150:151], v14 offset0:194 offset1:195
  v_mfma_f32_16x16x32_bf16 v[40:43], v[160:163], v[96:99], v[40:43]
  ds_read_b128 v[60:63], v15 offset:704
  v_mfma_f32_16x16x32_bf16 v[44:47], v[164:167], v[96:99], v[44:47]
  ds_read_b128 v[64:67], v15 offset:1216
  v_mfma_f32_16x16x32_bf16 v[48:51], v[168:171], v[96:99], v[48:51]
  ds_read_b128 v[68:71], v15 offset:1728
  v_mfma_f32_16x16x32_bf16 v[52:55], v[172:175], v[96:99], v[52:55]
  ds_read_b128 v[72:75], v15 offset:2240
  v_mfma_f32_16x16x32_bf16 v[36:39], v[152:155], v[100:103], v[36:39]
  ds_read_b128 v[76:79], v15 offset:2752
  v_mfma_f32_16x16x32_bf16 v[40:43], v[156:159], v[100:103], v[40:43]
  ds_read_b128 v[80:83], v15 offset:3264
  v_mfma_f32_16x16x32_bf16 v[44:47], v[160:163], v[100:103], v[44:47]
  ds_read_b128 v[84:87], v15 offset:3776
  v_mfma_f32_16x16x32_bf16 v[48:51], v[164:167], v[100:103], v[48:51]
  v_mfma_f32_16x16x32_bf16 v[52:55], v[168:171], v[100:103], v[52:55]
  v_mfma_f32_16x16x32_bf16 v[40:43], v[152:155], v[104:107], v[40:43]
  v_mfma_f32_16x16x32_bf16 v[44:47], v[156:159], v[104:107], v[44:47]
  v_mfma_f32_16x16x32_bf16 v[48:51], v[160:163], v[104:107], v[48:51]
  v_mfma_f32_16x16x32_bf16 v[52:55], v[164:167], v[104:107], v[52:55]
  v_mfma_f32_16x16x32_bf16 v[52:55], v[160:163], v[108:111], v[52:55]
  v_mfma_f32_16x16x32_bf16 v[44:47], v[152:155], v[108:111], v[44:47]
  v_mfma_f32_16x16x32_bf16 v[48:51], v[156:159], v[108:111], v[48:51]
  v_mfma_f32_16x16x32_bf16 v[52:55], v[156:159], v[112:115], v[52:55]
  v_mfma_f32_16x16x32_bf16 v[48:51], v[152:155], v[112:115], v[48:51]
  v_mfma_f32_16x16x32_bf16 v[52:55], v[152:155], v[116:119], v[52:55]
  s_waitcnt lgkmcnt(0)
  s_waitcnt vmcnt(0)
  v_cmp_ne_u32 vcc, s60, v253
  s_mov_b32 s8, s4
  s_mov_b32 s9, s5
  s_mov_b32 s11, s7
  s_cmp_eq_u64 vcc, 0
  s_cselect_b32 s10, s6, 0
  v_mfma_f32_16x16x32_bf16 v[24:27], v[120:123], v[56:59], v[24:27]
  ds_read_b128 v[88:91], v15 offset:128
  v_mfma_f32_16x16x32_bf16 v[28:31], v[124:127], v[56:59], v[28:31]
  ds_read2_b32 v[152:153], v11 offset0:80 offset1:81
  v_mfma_f32_16x16x32_bf16 v[32:35], v[128:131], v[56:59], v[32:35]
  ds_read2_b32 v[154:155], v11 offset0:82 offset1:83
  v_mfma_f32_16x16x32_bf16 v[36:39], v[132:135], v[56:59], v[36:39]
  ds_read2_b32 v[156:157], v11 offset0:208 offset1:209
  v_mfma_f32_16x16x32_bf16 v[40:43], v[136:139], v[56:59], v[40:43]
  ds_read2_b32 v[158:159], v11 offset0:210 offset1:211
  v_mfma_f32_16x16x32_bf16 v[44:47], v[140:143], v[56:59], v[44:47]
  ds_read2_b32 v[160:161], v12 offset0:80 offset1:81
  v_mfma_f32_16x16x32_bf16 v[48:51], v[144:147], v[56:59], v[48:51]
  ds_read2_b32 v[162:163], v12 offset0:82 offset1:83
  v_mfma_f32_16x16x32_bf16 v[52:55], v[148:151], v[56:59], v[52:55]
  ds_read2_b32 v[164:165], v12 offset0:208 offset1:209
  v_mfma_f32_16x16x32_bf16 v[28:31], v[120:123], v[60:63], v[28:31]
  ds_read2_b32 v[166:167], v12 offset0:210 offset1:211
  v_mfma_f32_16x16x32_bf16 v[32:35], v[124:127], v[60:63], v[32:35]
  ds_read2_b32 v[168:169], v13 offset0:80 offset1:81
  v_mfma_f32_16x16x32_bf16 v[36:39], v[128:131], v[60:63], v[36:39]
  ds_read2_b32 v[170:171], v13 offset0:82 offset1:83
  v_mfma_f32_16x16x32_bf16 v[40:43], v[132:135], v[60:63], v[40:43]
  ds_read2_b32 v[172:173], v13 offset0:208 offset1:209
  v_mfma_f32_16x16x32_bf16 v[44:47], v[136:139], v[60:63], v[44:47]
  ds_read2_b32 v[174:175], v13 offset0:210 offset1:211
  v_mfma_f32_16x16x32_bf16 v[48:51], v[140:143], v[60:63], v[48:51]
  ds_read2_b32 v[176:177], v14 offset0:80 offset1:81
  v_mfma_f32_16x16x32_bf16 v[52:55], v[144:147], v[60:63], v[52:55]
  ds_read2_b32 v[178:179], v14 offset0:82 offset1:83
  v_mfma_f32_16x16x32_bf16 v[32:35], v[120:123], v[64:67], v[32:35]
  ds_read2_b32 v[180:181], v14 offset0:208 offset1:209
  v_mfma_f32_16x16x32_bf16 v[36:39], v[124:127], v[64:67], v[36:39]
  ds_read2_b32 v[182:183], v14 offset0:210 offset1:211
  v_mfma_f32_16x16x32_bf16 v[40:43], v[128:131], v[64:67], v[40:43]
  ds_read_b128 v[92:95], v15 offset:640
  v_mfma_f32_16x16x32_bf16 v[44:47], v[132:135], v[64:67], v[44:47]
  ds_read_b128 v[96:99], v15 offset:1152
  v_mfma_f32_16x16x32_bf16 v[48:51], v[136:139], v[64:67], v[48:51]
  ds_read_b128 v[100:103], v15 offset:1664
  v_mfma_f32_16x16x32_bf16 v[52:55], v[140:143], v[64:67], v[52:55]
  ds_read_b128 v[104:107], v15 offset:2176
  v_mfma_f32_16x16x32_bf16 v[36:39], v[120:123], v[68:71], v[36:39]
  ds_read_b128 v[108:111], v15 offset:2688
  v_mfma_f32_16x16x32_bf16 v[40:43], v[124:127], v[68:71], v[40:43]
  ds_read_b128 v[112:115], v15 offset:3200
  v_mfma_f32_16x16x32_bf16 v[44:47], v[128:131], v[68:71], v[44:47]
  ds_read_b128 v[116:119], v15 offset:3712
  v_mfma_f32_16x16x32_bf16 v[48:51], v[132:135], v[68:71], v[48:51]
  s_mul_i32 s54, s25, 100
  v_mfma_f32_16x16x32_bf16 v[52:55], v[136:139], v[68:71], v[52:55]
  s_mul_i32 s55, s3, 10
  v_mfma_f32_16x16x32_bf16 v[40:43], v[120:123], v[72:75], v[40:43]
  s_add_u32 s54, s54, s55
  v_mfma_f32_16x16x32_bf16 v[44:47], v[124:127], v[72:75], v[44:47]
  s_add_u32 s55, s55, 120
  v_mfma_f32_16x16x32_bf16 v[48:51], v[128:131], v[72:75], v[48:51]
  s_lshl_b32 s54, s54, 10
  v_mfma_f32_16x16x32_bf16 v[52:55], v[132:135], v[72:75], v[52:55]
  s_lshl_b32 m0, s55, 10
  v_mfma_f32_16x16x32_bf16 v[52:55], v[128:131], v[76:79], v[52:55]
  s_add_u32 s54, s54, 22020096
  v_mfma_f32_16x16x32_bf16 v[44:47], v[120:123], v[76:79], v[44:47]
  buffer_load_dwordx4 v1, s[8:11], s54 offen offset:0 sc1 lds
  v_mfma_f32_16x16x32_bf16 v[48:51], v[124:127], v[76:79], v[48:51]
  buffer_load_dwordx4 v1, s[8:11], s54 offen offset:1024 sc1 lds
  v_mfma_f32_16x16x32_bf16 v[52:55], v[124:127], v[80:83], v[52:55]
  buffer_load_dwordx4 v1, s[8:11], s54 offen offset:2048 sc1 lds
  v_mfma_f32_16x16x32_bf16 v[48:51], v[120:123], v[80:83], v[48:51]
  buffer_load_dwordx4 v1, s[8:11], s54 offen offset:3072 sc1 lds
  v_mfma_f32_16x16x32_bf16 v[52:55], v[120:123], v[84:87], v[52:55]
  s_add_u32 m0, m0, 4096
  s_waitcnt lgkmcnt(0)
  v_mfma_f32_16x16x32_bf16 v[24:27], v[152:155], v[88:91], v[24:27]
  ds_read_b128 v[56:59], v15 offset:64
  v_mfma_f32_16x16x32_bf16 v[28:31], v[156:159], v[88:91], v[28:31]
  ds_read2_b32 v[120:121], v11 offset0:96 offset1:97
  v_mfma_f32_16x16x32_bf16 v[32:35], v[160:163], v[88:91], v[32:35]
  ds_read2_b32 v[122:123], v11 offset0:98 offset1:99
  v_mfma_f32_16x16x32_bf16 v[36:39], v[164:167], v[88:91], v[36:39]
  ds_read2_b32 v[124:125], v11 offset0:224 offset1:225
  v_mfma_f32_16x16x32_bf16 v[40:43], v[168:171], v[88:91], v[40:43]
  ds_read2_b32 v[126:127], v11 offset0:226 offset1:227
  v_mfma_f32_16x16x32_bf16 v[44:47], v[172:175], v[88:91], v[44:47]
  ds_read2_b32 v[128:129], v12 offset0:96 offset1:97
  v_mfma_f32_16x16x32_bf16 v[48:51], v[176:179], v[88:91], v[48:51]
  ds_read2_b32 v[130:131], v12 offset0:98 offset1:99
  v_mfma_f32_16x16x32_bf16 v[52:55], v[180:183], v[88:91], v[52:55]
  ds_read2_b32 v[132:133], v12 offset0:224 offset1:225
  v_mfma_f32_16x16x32_bf16 v[28:31], v[152:155], v[92:95], v[28:31]
  ds_read2_b32 v[134:135], v12 offset0:226 offset1:227
  v_mfma_f32_16x16x32_bf16 v[32:35], v[156:159], v[92:95], v[32:35]
  ds_read2_b32 v[136:137], v13 offset0:96 offset1:97
  v_mfma_f32_16x16x32_bf16 v[36:39], v[160:163], v[92:95], v[36:39]
  ds_read2_b32 v[138:139], v13 offset0:98 offset1:99
  v_mfma_f32_16x16x32_bf16 v[40:43], v[164:167], v[92:95], v[40:43]
  ds_read2_b32 v[140:141], v13 offset0:224 offset1:225
  v_mfma_f32_16x16x32_bf16 v[44:47], v[168:171], v[92:95], v[44:47]
  ds_read2_b32 v[142:143], v13 offset0:226 offset1:227
  v_mfma_f32_16x16x32_bf16 v[48:51], v[172:175], v[92:95], v[48:51]
  ds_read2_b32 v[144:145], v14 offset0:96 offset1:97
  v_mfma_f32_16x16x32_bf16 v[52:55], v[176:179], v[92:95], v[52:55]
  ds_read2_b32 v[146:147], v14 offset0:98 offset1:99
  v_mfma_f32_16x16x32_bf16 v[32:35], v[152:155], v[96:99], v[32:35]
  ds_read2_b32 v[148:149], v14 offset0:224 offset1:225
  v_mfma_f32_16x16x32_bf16 v[36:39], v[156:159], v[96:99], v[36:39]
  ds_read2_b32 v[150:151], v14 offset0:226 offset1:227
  v_mfma_f32_16x16x32_bf16 v[40:43], v[160:163], v[96:99], v[40:43]
  ds_read_b128 v[60:63], v15 offset:576
  v_mfma_f32_16x16x32_bf16 v[44:47], v[164:167], v[96:99], v[44:47]
  ds_read_b128 v[64:67], v15 offset:1088
  v_mfma_f32_16x16x32_bf16 v[48:51], v[168:171], v[96:99], v[48:51]
  ds_read_b128 v[68:71], v15 offset:1600
  v_mfma_f32_16x16x32_bf16 v[52:55], v[172:175], v[96:99], v[52:55]
  ds_read_b128 v[72:75], v15 offset:2112
  v_mfma_f32_16x16x32_bf16 v[36:39], v[152:155], v[100:103], v[36:39]
  ds_read_b128 v[76:79], v15 offset:2624
  v_mfma_f32_16x16x32_bf16 v[40:43], v[156:159], v[100:103], v[40:43]
  ds_read_b128 v[80:83], v15 offset:3136
  v_mfma_f32_16x16x32_bf16 v[44:47], v[160:163], v[100:103], v[44:47]
  ds_read_b128 v[84:87], v15 offset:3648
  v_mfma_f32_16x16x32_bf16 v[48:51], v[164:167], v[100:103], v[48:51]
  s_add_u32 s54, s54, 4096
  v_mfma_f32_16x16x32_bf16 v[52:55], v[168:171], v[100:103], v[52:55]
  buffer_load_dwordx4 v1, s[8:11], s54 offen offset:0 sc1 lds
  v_mfma_f32_16x16x32_bf16 v[40:43], v[152:155], v[104:107], v[40:43]
  buffer_load_dwordx4 v1, s[8:11], s54 offen offset:1024 sc1 lds
  v_mfma_f32_16x16x32_bf16 v[44:47], v[156:159], v[104:107], v[44:47]
  buffer_load_dwordx4 v1, s[8:11], s54 offen offset:2048 sc1 lds
  v_mfma_f32_16x16x32_bf16 v[48:51], v[160:163], v[104:107], v[48:51]
  buffer_load_dwordx4 v1, s[8:11], s54 offen offset:3072 sc1 lds
  v_mfma_f32_16x16x32_bf16 v[52:55], v[164:167], v[104:107], v[52:55]
  s_add_u32 m0, m0, 4096
  v_mfma_f32_16x16x32_bf16 v[52:55], v[160:163], v[108:111], v[52:55]
  s_add_u32 s54, s54, 4096
  v_mfma_f32_16x16x32_bf16 v[44:47], v[152:155], v[108:111], v[44:47]
  buffer_load_dwordx4 v1, s[8:11], s54 offen offset:0 sc1 lds
  v_mfma_f32_16x16x32_bf16 v[48:51], v[156:159], v[108:111], v[48:51]
  buffer_load_dwordx4 v1, s[8:11], s54 offen offset:1024 sc1 lds
  v_mfma_f32_16x16x32_bf16 v[52:55], v[156:159], v[112:115], v[52:55]
  s_mul_i32 s54, s25, 100
  v_mfma_f32_16x16x32_bf16 v[48:51], v[152:155], v[112:115], v[48:51]
  s_mul_i32 s55, s3, 15
  v_mfma_f32_16x16x32_bf16 v[52:55], v[152:155], v[116:119], v[52:55]
  s_add_u32 s54, s54, s55
  s_waitcnt lgkmcnt(0)
  v_mfma_f32_16x16x32_bf16 v[24:27], v[120:123], v[56:59], v[24:27]
  ds_read_b128 v[88:91], v15 offset:0
  v_mfma_f32_16x16x32_bf16 v[28:31], v[124:127], v[56:59], v[28:31]
  ds_read2_b32 v[152:153], v11 offset0:112 offset1:113
  v_mfma_f32_16x16x32_bf16 v[32:35], v[128:131], v[56:59], v[32:35]
  ds_read2_b32 v[154:155], v11 offset0:114 offset1:115
  v_mfma_f32_16x16x32_bf16 v[36:39], v[132:135], v[56:59], v[36:39]
  ds_read2_b32 v[156:157], v11 offset0:240 offset1:241
  v_mfma_f32_16x16x32_bf16 v[40:43], v[136:139], v[56:59], v[40:43]
  ds_read2_b32 v[158:159], v11 offset0:242 offset1:243
  v_mfma_f32_16x16x32_bf16 v[44:47], v[140:143], v[56:59], v[44:47]
  ds_read2_b32 v[160:161], v12 offset0:112 offset1:113
  v_mfma_f32_16x16x32_bf16 v[48:51], v[144:147], v[56:59], v[48:51]
  ds_read2_b32 v[162:163], v12 offset0:114 offset1:115
  v_mfma_f32_16x16x32_bf16 v[52:55], v[148:151], v[56:59], v[52:55]
  ds_read2_b32 v[164:165], v12 offset0:240 offset1:241
  v_mfma_f32_16x16x32_bf16 v[28:31], v[120:123], v[60:63], v[28:31]
  ds_read2_b32 v[166:167], v12 offset0:242 offset1:243
  v_mfma_f32_16x16x32_bf16 v[32:35], v[124:127], v[60:63], v[32:35]
  ds_read2_b32 v[168:169], v13 offset0:112 offset1:113
  v_mfma_f32_16x16x32_bf16 v[36:39], v[128:131], v[60:63], v[36:39]
  ds_read2_b32 v[170:171], v13 offset0:114 offset1:115
  v_mfma_f32_16x16x32_bf16 v[40:43], v[132:135], v[60:63], v[40:43]
  ds_read2_b32 v[172:173], v13 offset0:240 offset1:241
  v_mfma_f32_16x16x32_bf16 v[44:47], v[136:139], v[60:63], v[44:47]
  ds_read2_b32 v[174:175], v13 offset0:242 offset1:243
  v_mfma_f32_16x16x32_bf16 v[48:51], v[140:143], v[60:63], v[48:51]
  ds_read2_b32 v[176:177], v14 offset0:112 offset1:113
  v_mfma_f32_16x16x32_bf16 v[52:55], v[144:147], v[60:63], v[52:55]
  ds_read2_b32 v[178:179], v14 offset0:114 offset1:115
  v_mfma_f32_16x16x32_bf16 v[32:35], v[120:123], v[64:67], v[32:35]
  ds_read2_b32 v[180:181], v14 offset0:240 offset1:241
  v_mfma_f32_16x16x32_bf16 v[36:39], v[124:127], v[64:67], v[36:39]
  ds_read2_b32 v[182:183], v14 offset0:242 offset1:243
  v_mfma_f32_16x16x32_bf16 v[40:43], v[128:131], v[64:67], v[40:43]
  ds_read_b128 v[92:95], v15 offset:512
  v_mfma_f32_16x16x32_bf16 v[44:47], v[132:135], v[64:67], v[44:47]
  ds_read_b128 v[96:99], v15 offset:1024
  v_mfma_f32_16x16x32_bf16 v[48:51], v[136:139], v[64:67], v[48:51]
  ds_read_b128 v[100:103], v15 offset:1536
  v_mfma_f32_16x16x32_bf16 v[52:55], v[140:143], v[64:67], v[52:55]
  ds_read_b128 v[104:107], v15 offset:2048
  v_mfma_f32_16x16x32_bf16 v[36:39], v[120:123], v[68:71], v[36:39]
  ds_read_b128 v[108:111], v15 offset:2560
  v_mfma_f32_16x16x32_bf16 v[40:43], v[124:127], v[68:71], v[40:43]
  ds_read_b128 v[112:115], v15 offset:3072
  v_mfma_f32_16x16x32_bf16 v[44:47], v[128:131], v[68:71], v[44:47]
  ds_read_b128 v[116:119], v15 offset:3584
  v_mfma_f32_16x16x32_bf16 v[48:51], v[132:135], v[68:71], v[48:51]
  s_add_u32 s55, s55, 0
  v_mfma_f32_16x16x32_bf16 v[52:55], v[136:139], v[68:71], v[52:55]
  s_lshl_b32 s54, s54, 10
  v_mfma_f32_16x16x32_bf16 v[40:43], v[120:123], v[72:75], v[40:43]
  s_lshl_b32 m0, s55, 10
  v_mfma_f32_16x16x32_bf16 v[44:47], v[124:127], v[72:75], v[44:47]
  s_add_u32 s54, s54, 22061056
  v_mfma_f32_16x16x32_bf16 v[48:51], v[128:131], v[72:75], v[48:51]
  buffer_load_dwordx4 v1, s[8:11], s54 offen offset:0 sc1 lds
  v_mfma_f32_16x16x32_bf16 v[52:55], v[132:135], v[72:75], v[52:55]
  buffer_load_dwordx4 v1, s[8:11], s54 offen offset:1024 sc1 lds
  v_mfma_f32_16x16x32_bf16 v[52:55], v[128:131], v[76:79], v[52:55]
  buffer_load_dwordx4 v1, s[8:11], s54 offen offset:2048 sc1 lds
  v_mfma_f32_16x16x32_bf16 v[44:47], v[120:123], v[76:79], v[44:47]
  buffer_load_dwordx4 v1, s[8:11], s54 offen offset:3072 sc1 lds
  v_mfma_f32_16x16x32_bf16 v[48:51], v[124:127], v[76:79], v[48:51]
  s_add_u32 m0, m0, 4096
  v_mfma_f32_16x16x32_bf16 v[52:55], v[124:127], v[80:83], v[52:55]
  s_add_u32 s54, s54, 4096
  v_mfma_f32_16x16x32_bf16 v[48:51], v[120:123], v[80:83], v[48:51]
  buffer_load_dwordx4 v1, s[8:11], s54 offen offset:0 sc1 lds
  v_mfma_f32_16x16x32_bf16 v[52:55], v[120:123], v[84:87], v[52:55]
  buffer_load_dwordx4 v1, s[8:11], s54 offen offset:1024 sc1 lds
  s_waitcnt lgkmcnt(0)
  v_mfma_f32_16x16x32_bf16 v[24:27], v[152:155], v[88:91], v[24:27]
  v_mfma_f32_16x16x32_bf16 v[28:31], v[156:159], v[88:91], v[28:31]
  v_mfma_f32_16x16x32_bf16 v[32:35], v[160:163], v[88:91], v[32:35]
  v_mfma_f32_16x16x32_bf16 v[36:39], v[164:167], v[88:91], v[36:39]
  v_mfma_f32_16x16x32_bf16 v[40:43], v[168:171], v[88:91], v[40:43]
  v_mfma_f32_16x16x32_bf16 v[44:47], v[172:175], v[88:91], v[44:47]
  v_mfma_f32_16x16x32_bf16 v[48:51], v[176:179], v[88:91], v[48:51]
  v_mfma_f32_16x16x32_bf16 v[52:55], v[180:183], v[88:91], v[52:55]
  v_mfma_f32_16x16x32_bf16 v[28:31], v[152:155], v[92:95], v[28:31]
  v_mfma_f32_16x16x32_bf16 v[32:35], v[156:159], v[92:95], v[32:35]
  v_mfma_f32_16x16x32_bf16 v[36:39], v[160:163], v[92:95], v[36:39]
  v_mfma_f32_16x16x32_bf16 v[40:43], v[164:167], v[92:95], v[40:43]
  v_mfma_f32_16x16x32_bf16 v[44:47], v[168:171], v[92:95], v[44:47]
  v_mfma_f32_16x16x32_bf16 v[48:51], v[172:175], v[92:95], v[48:51]
  v_mfma_f32_16x16x32_bf16 v[52:55], v[176:179], v[92:95], v[52:55]
  v_mfma_f32_16x16x32_bf16 v[32:35], v[152:155], v[96:99], v[32:35]
  v_mfma_f32_16x16x32_bf16 v[36:39], v[156:159], v[96:99], v[36:39]
  v_mfma_f32_16x16x32_bf16 v[40:43], v[160:163], v[96:99], v[40:43]
  v_mfma_f32_16x16x32_bf16 v[44:47], v[164:167], v[96:99], v[44:47]
  v_mfma_f32_16x16x32_bf16 v[48:51], v[168:171], v[96:99], v[48:51]
  v_mfma_f32_16x16x32_bf16 v[52:55], v[172:175], v[96:99], v[52:55]
  v_mfma_f32_16x16x32_bf16 v[36:39], v[152:155], v[100:103], v[36:39]
  v_mfma_f32_16x16x32_bf16 v[40:43], v[156:159], v[100:103], v[40:43]
  v_mfma_f32_16x16x32_bf16 v[44:47], v[160:163], v[100:103], v[44:47]
  v_mfma_f32_16x16x32_bf16 v[48:51], v[164:167], v[100:103], v[48:51]
  v_lshlrev_b32 v244, 7, v0
  v_mfma_f32_16x16x32_bf16 v[52:55], v[168:171], v[100:103], v[52:55]
  s_lshl_b32 s57, s3, 13
  v_mfma_f32_16x16x32_bf16 v[40:43], v[152:155], v[104:107], v[40:43]
  s_add_u32 s57, s57, 28639232
  buffer_load_dword v240, v244, s[4:7], s57 offen sc1
  v_mfma_f32_16x16x32_bf16 v[44:47], v[156:159], v[104:107], v[44:47]
  buffer_load_dwordx4 v1, s[8:11], s54 offen offset:2048 sc1 lds
  v_mfma_f32_16x16x32_bf16 v[48:51], v[160:163], v[104:107], v[48:51]
  buffer_load_dwordx4 v1, s[8:11], s54 offen offset:3072 sc1 lds
  s_add_u32 m0, m0, 4096
  v_mfma_f32_16x16x32_bf16 v[52:55], v[164:167], v[104:107], v[52:55]
  s_add_u32 s54, s54, 4096
  v_mfma_f32_16x16x32_bf16 v[52:55], v[160:163], v[108:111], v[52:55]
  buffer_load_dwordx4 v1, s[8:11], s54 offen offset:0 sc1 lds
  v_mfma_f32_16x16x32_bf16 v[44:47], v[152:155], v[108:111], v[44:47]
  buffer_load_dwordx4 v1, s[8:11], s54 offen offset:1024 sc1 lds
  buffer_load_dwordx4 v1, s[8:11], s54 offen offset:2048 sc1 lds
  v_mfma_f32_16x16x32_bf16 v[48:51], v[156:159], v[108:111], v[48:51]
  buffer_load_dwordx4 v1, s[8:11], s54 offen offset:3072 sc1 lds
  v_mfma_f32_16x16x32_bf16 v[52:55], v[156:159], v[112:115], v[52:55]
  s_add_u32 m0, m0, 4096
  s_add_u32 s54, s54, 4096
  v_mfma_f32_16x16x32_bf16 v[48:51], v[152:155], v[112:115], v[48:51]
  buffer_load_dwordx4 v1, s[8:11], s54 offen offset:0 sc1 lds
  v_mfma_f32_16x16x32_bf16 v[52:55], v[152:155], v[116:119], v[52:55]
  buffer_load_dwordx4 v1, s[8:11], s54 offen offset:1024 sc1 lds
  buffer_load_dwordx4 v1, s[8:11], s54 offen offset:2048 sc1 lds
  v_cvt_pk_bf16_f32 v56, v24, v26
  v_cvt_pk_bf16_f32 v57, v25, v27
  ds_write2st64_b32 v16, v56, v57 offset0:0 offset1:1
  v_cvt_pk_bf16_f32 v58, v28, v30
  v_cvt_pk_bf16_f32 v59, v29, v31
  ds_write2st64_b32 v16, v58, v59 offset0:2 offset1:3
  v_cvt_pk_bf16_f32 v60, v32, v34
  v_cvt_pk_bf16_f32 v61, v33, v35
  ds_write2st64_b32 v16, v60, v61 offset0:4 offset1:5
  v_cvt_pk_bf16_f32 v62, v36, v38
  v_cvt_pk_bf16_f32 v63, v37, v39
  ds_write2st64_b32 v16, v62, v63 offset0:6 offset1:7
  v_cvt_pk_bf16_f32 v64, v40, v42
  v_cvt_pk_bf16_f32 v65, v41, v43
  ds_write2st64_b32 v16, v64, v65 offset0:8 offset1:9
  v_cvt_pk_bf16_f32 v66, v44, v46
  v_cvt_pk_bf16_f32 v67, v45, v47
  ds_write2st64_b32 v16, v66, v67 offset0:10 offset1:11
  v_cvt_pk_bf16_f32 v68, v48, v50
  v_cvt_pk_bf16_f32 v69, v49, v51
  ds_write2st64_b32 v16, v68, v69 offset0:12 offset1:13
  v_cvt_pk_bf16_f32 v70, v52, v54
  v_cvt_pk_bf16_f32 v71, v53, v55
  ds_write2st64_b32 v16, v70, v71 offset0:14 offset1:15
  v_lshlrev_b32 v128, 16, v208
  v_and_b32 v129, s48, v208
  v_lshlrev_b32 v130, 16, v209
  v_and_b32 v131, s48, v209
  v_lshlrev_b32 v132, 16, v210
  v_and_b32 v133, s48, v210
  v_lshlrev_b32 v134, 16, v211
  v_and_b32 v135, s48, v211
  v_lshlrev_b32 v136, 16, v212
  v_and_b32 v137, s48, v212
  v_lshlrev_b32 v138, 16, v213
  v_and_b32 v139, s48, v213
  v_lshlrev_b32 v140, 16, v214
  v_and_b32 v141, s48, v214
  v_lshlrev_b32 v142, 16, v215
  v_and_b32 v143, s48, v215
  v_lshlrev_b32 v144, 16, v216
  v_and_b32 v145, s48, v216
  v_lshlrev_b32 v146, 16, v217
  v_and_b32 v147, s48, v217
  v_lshlrev_b32 v148, 16, v218
  v_and_b32 v149, s48, v218
  v_lshlrev_b32 v150, 16, v219
  v_and_b32 v151, s48, v219
  v_lshlrev_b32 v152, 16, v220
  v_and_b32 v153, s48, v220
  v_lshlrev_b32 v154, 16, v221
  v_and_b32 v155, s48, v221
  v_lshlrev_b32 v156, 16, v222
  v_and_b32 v157, s48, v222
  v_lshlrev_b32 v158, 16, v223
  v_and_b32 v159, s48, v223
  s_lshl_b32 s57, s3, 2
  s_add_u32 s57, s57, 65536
  v_mov_b32 v242, s57
  v_mov_b32 v243, 65536
  s_waitcnt vmcnt(9)
  v_cmp_ne_u32 vcc, s60, v240
  s_cmp_eq_u32 s10, 0
  s_cselect_b32 s57, 1, vcc_lo
  s_or_b32 s57, s57, vcc_hi
  v_mov_b32 v241, s57
  ds_write_b32 v242, v241
  s_waitcnt lgkmcnt(0)
  s_barrier
  ds_read_b128 v[240:243], v243
  ds_read_b64_tr_b16 v[72:73], v17 offset:0
  ds_read_b64_tr_b16 v[74:75], v17 offset:256
  ds_read_b64_tr_b16 v[76:77], v17 offset:128
  ds_read_b64_tr_b16 v[78:79], v17 offset:384
  ds_read_b64_tr_b16 v[80:81], v17 offset:512
  ds_read_b64_tr_b16 v[82:83], v17 offset:768
  ds_read_b64_tr_b16 v[84:85], v17 offset:640
  ds_read_b64_tr_b16 v[86:87], v17 offset:896
  s_waitcnt lgkmcnt(7)
  v_lshlrev_b32 v96, 16, v72
  v_and_b32 v97, s48, v72
  v_pk_add_f32 v[96:97], v[96:97], v[128:129]
  v_cvt_pk_bf16_f32 v72, v96, v97
  v_lshlrev_b32 v98, 16, v73
  v_and_b32 v99, s48, v73
  v_pk_add_f32 v[98:99], v[98:99], v[130:131]
  v_cvt_pk_bf16_f32 v73, v98, v99
  s_waitcnt lgkmcnt(6)
  v_lshlrev_b32 v100, 16, v74
  v_and_b32 v101, s48, v74
  v_pk_add_f32 v[100:101], v[100:101], v[132:133]
  v_cvt_pk_bf16_f32 v74, v100, v101
  v_lshlrev_b32 v102, 16, v75
  v_and_b32 v103, s48, v75
  v_pk_add_f32 v[102:103], v[102:103], v[134:135]
  v_cvt_pk_bf16_f32 v75, v102, v103
  buffer_store_dwordx4 v[72:75], v18, s[4:7], s44 offen sc1
  s_add_u32 s44, s44, 163840
  s_waitcnt lgkmcnt(5)
  v_lshlrev_b32 v104, 16, v76
  v_and_b32 v105, s48, v76
  v_pk_add_f32 v[104:105], v[104:105], v[136:137]
  v_cvt_pk_bf16_f32 v76, v104, v105
  v_lshlrev_b32 v106, 16, v77
  v_and_b32 v107, s48, v77
  v_pk_add_f32 v[106:107], v[106:107], v[138:139]
  v_cvt_pk_bf16_f32 v77, v106, v107
  s_waitcnt lgkmcnt(4)
  v_lshlrev_b32 v108, 16, v78
  v_and_b32 v109, s48, v78
  v_pk_add_f32 v[108:109], v[108:109], v[140:141]
  v_cvt_pk_bf16_f32 v78, v108, v109
  v_lshlrev_b32 v110, 16, v79
  v_and_b32 v111, s48, v79
  v_pk_add_f32 v[110:111], v[110:111], v[142:143]
  v_cvt_pk_bf16_f32 v79, v110, v111
  buffer_store_dwordx4 v[76:79], v18, s[4:7], s44 offen sc1
  s_add_u32 s44, s44, 163840
  s_waitcnt lgkmcnt(3)
  v_lshlrev_b32 v112, 16, v80
  v_and_b32 v113, s48, v80
  v_pk_add_f32 v[112:113], v[112:113], v[144:145]
  v_cvt_pk_bf16_f32 v80, v112, v113
  v_lshlrev_b32 v114, 16, v81
  v_and_b32 v115, s48, v81
  v_pk_add_f32 v[114:115], v[114:115], v[146:147]
  v_cvt_pk_bf16_f32 v81, v114, v115
  s_waitcnt lgkmcnt(2)
  v_lshlrev_b32 v116, 16, v82
  v_and_b32 v117, s48, v82
  v_pk_add_f32 v[116:117], v[116:117], v[148:149]
  v_cvt_pk_bf16_f32 v82, v116, v117
  v_lshlrev_b32 v118, 16, v83
  v_and_b32 v119, s48, v83
  v_pk_add_f32 v[118:119], v[118:119], v[150:151]
  v_cvt_pk_bf16_f32 v83, v118, v119
  buffer_store_dwordx4 v[80:83], v18, s[4:7], s44 offen sc1
  s_add_u32 s44, s44, 163840
  s_waitcnt lgkmcnt(1)
  v_lshlrev_b32 v120, 16, v84
  v_and_b32 v121, s48, v84
  v_pk_add_f32 v[120:121], v[120:121], v[152:153]
  v_cvt_pk_bf16_f32 v84, v120, v121
  v_lshlrev_b32 v122, 16, v85
  v_and_b32 v123, s48, v85
  v_pk_add_f32 v[122:123], v[122:123], v[154:155]
  v_cvt_pk_bf16_f32 v85, v122, v123
  s_waitcnt lgkmcnt(0)
  v_lshlrev_b32 v124, 16, v86
  v_and_b32 v125, s48, v86
  v_pk_add_f32 v[124:125], v[124:125], v[156:157]
  v_cvt_pk_bf16_f32 v86, v124, v125
  v_lshlrev_b32 v126, 16, v87
  v_and_b32 v127, s48, v87
  v_pk_add_f32 v[126:127], v[126:127], v[158:159]
  v_cvt_pk_bf16_f32 v87, v126, v127
  buffer_store_dwordx4 v[84:87], v18, s[4:7], s44 offen sc1
  v_or3_b32 v240, v240, v241, v242
  v_or_b32 v240, v240, v243
  v_cmp_ne_u32 vcc, 0, v240
  s_cbranch_vccz join1
  s_branch slow1
role_b:
  s_sub_u32 s21, s2, 192
  s_cmp_lt_u32 s2, 192
  s_cbranch_scc1 rl_c
  v_lshrrev_b32 v1, 4, v0
  v_and_b32 v2, 15, v0
  s_lshl_b32 s24, s21, 2
  s_add_u32 s24, s24, s3
  s_mov_b32 s8, s64
  s_mov_b32 s9, s65
  s_mov_b32 s10, 2621440
  s_mov_b32 s11, 0x20000
  v_mul_u32_u24 v3, 1280, v1
  v_lshl_add_u32 v3, v2, 4, v3
  s_mul_i32 s24, s24, 10240
  buffer_load_dwordx4 v[8:11], v3, s[8:11], s24 offen offset:0
  buffer_load_dwordx4 v[12:15], v3, s[8:11], s24 offen offset:256
  buffer_load_dwordx4 v[16:19], v3, s[8:11], s24 offen offset:512
  buffer_load_dwordx4 v[20:23], v3, s[8:11], s24 offen offset:768
  buffer_load_dwordx4 v[24:27], v3, s[8:11], s24 offen offset:1024
  s_add_u32 s24, s24, 5120
  buffer_load_dwordx4 v[100:103], v3, s[8:11], s24 offen offset:0
  buffer_load_dwordx4 v[104:107], v3, s[8:11], s24 offen offset:256
  buffer_load_dwordx4 v[108:111], v3, s[8:11], s24 offen offset:512
  buffer_load_dwordx4 v[112:115], v3, s[8:11], s24 offen offset:768
  buffer_load_dwordx4 v[116:119], v3, s[8:11], s24 offen offset:1024
  s_barrier
  v_lshrrev_b32 v1, 4, v0
  v_and_b32 v2, 15, v0
  s_lshl_b32 s24, s21, 2
  s_add_u32 s24, s24, s3
  s_lshl_b32 s25, s24, 6
  s_add_u32 s25, s25, 28327936
  v_lshl_add_u32 v4, v2, 2, v1
  v_lshlrev_b32 v4, 3, v4
  s_mov_b32 s28, 0xffff0000
  s_waitcnt vmcnt(9)
  v_lshlrev_b32 v32, 16, v8
  v_and_b32 v33, s28, v8
  v_lshlrev_b32 v34, 16, v9
  v_and_b32 v35, s28, v9
  v_lshlrev_b32 v36, 16, v10
  v_and_b32 v37, s28, v10
  v_lshlrev_b32 v38, 16, v11
  v_and_b32 v39, s28, v11
  v_pk_add_f32 v[72:73], v[32:33], v[34:35]
  v_pk_add_f32 v[74:75], v[36:37], v[38:39]
  s_waitcnt vmcnt(8)
  v_lshlrev_b32 v40, 16, v12
  v_and_b32 v41, s28, v12
  v_lshlrev_b32 v42, 16, v13
  v_and_b32 v43, s28, v13
  v_lshlrev_b32 v44, 16, v14
  v_and_b32 v45, s28, v14
  v_lshlrev_b32 v46, 16, v15
  v_and_b32 v47, s28, v15
  v_pk_add_f32 v[72:73], v[72:73], v[40:41]
  v_pk_add_f32 v[74:75], v[74:75], v[42:43]
  v_pk_add_f32 v[72:73], v[72:73], v[44:45]
  v_pk_add_f32 v[74:75], v[74:75], v[46:47]
  s_waitcnt vmcnt(7)
  v_lshlrev_b32 v48, 16, v16
  v_and_b32 v49, s28, v16
  v_lshlrev_b32 v50, 16, v17
  v_and_b32 v51, s28, v17
  v_lshlrev_b32 v52, 16, v18
  v_and_b32 v53, s28, v18
  v_lshlrev_b32 v54, 16, v19
  v_and_b32 v55, s28, v19
  v_pk_add_f32 v[72:73], v[72:73], v[48:49]
  v_pk_add_f32 v[74:75], v[74:75], v[50:51]
  v_pk_add_f32 v[72:73], v[72:73], v[52:53]
  v_pk_add_f32 v[74:75], v[74:75], v[54:55]
  s_waitcnt vmcnt(6)
  v_lshlrev_b32 v56, 16, v20
  v_and_b32 v57, s28, v20
  v_lshlrev_b32 v58, 16, v21
  v_and_b32 v59, s28, v21
  v_lshlrev_b32 v60, 16, v22
  v_and_b32 v61, s28, v22
  v_lshlrev_b32 v62, 16, v23
  v_and_b32 v63, s28, v23
  v_pk_add_f32 v[72:73], v[72:73], v[56:57]
  v_pk_add_f32 v[74:75], v[74:75], v[58:59]
  v_pk_add_f32 v[72:73], v[72:73], v[60:61]
  v_pk_add_f32 v[74:75], v[74:75], v[62:63]
  s_waitcnt vmcnt(5)
  v_lshlrev_b32 v64, 16, v24
  v_and_b32 v65, s28, v24
  v_lshlrev_b32 v66, 16, v25
  v_and_b32 v67, s28, v25
  v_lshlrev_b32 v68, 16, v26
  v_and_b32 v69, s28, v26
  v_lshlrev_b32 v70, 16, v27
  v_and_b32 v71, s28, v27
  v_pk_add_f32 v[72:73], v[72:73], v[64:65]
  v_pk_add_f32 v[74:75], v[74:75], v[66:67]
  v_pk_add_f32 v[72:73], v[72:73], v[68:69]
  v_pk_add_f32 v[74:75], v[74:75], v[70:71]
  v_pk_add_f32 v[72:73], v[72:73], v[74:75]
  v_add_f32 v72, v72, v73
  s_nop 1
  v_add_f32_dpp v72, v72, v72 row_ror:8 row_mask:0xf bank_mask:0xf
  s_nop 1
  v_add_f32_dpp v72, v72, v72 row_ror:4 row_mask:0xf bank_mask:0xf
  s_nop 1
  v_add_f32_dpp v72, v72, v72 row_ror:2 row_mask:0xf bank_mask:0xf
  s_nop 1
  v_add_f32_dpp v72, v72, v72 row_ror:1 row_mask:0xf bank_mask:0xf
  v_mul_f32 v72, 0x3acccccd, v72
  v_pk_add_f32 v[32:33], v[32:33], v[72:73] op_sel_hi:[1,0] neg_lo:[0,1] neg_hi:[0,1]
  v_pk_add_f32 v[34:35], v[34:35], v[72:73] op_sel_hi:[1,0] neg_lo:[0,1] neg_hi:[0,1]
  v_pk_add_f32 v[36:37], v[36:37], v[72:73] op_sel_hi:[1,0] neg_lo:[0,1] neg_hi:[0,1]
  v_pk_add_f32 v[38:39], v[38:39], v[72:73] op_sel_hi:[1,0] neg_lo:[0,1] neg_hi:[0,1]
  v_pk_add_f32 v[40:41], v[40:41], v[72:73] op_sel_hi:[1,0] neg_lo:[0,1] neg_hi:[0,1]
  v_pk_add_f32 v[42:43], v[42:43], v[72:73] op_sel_hi:[1,0] neg_lo:[0,1] neg_hi:[0,1]
  v_pk_add_f32 v[44:45], v[44:45], v[72:73] op_sel_hi:[1,0] neg_lo:[0,1] neg_hi:[0,1]
  v_pk_add_f32 v[46:47], v[46:47], v[72:73] op_sel_hi:[1,0] neg_lo:[0,1] neg_hi:[0,1]
  v_pk_add_f32 v[48:49], v[48:49], v[72:73] op_sel_hi:[1,0] neg_lo:[0,1] neg_hi:[0,1]
  v_pk_add_f32 v[50:51], v[50:51], v[72:73] op_sel_hi:[1,0] neg_lo:[0,1] neg_hi:[0,1]
  v_pk_add_f32 v[52:53], v[52:53], v[72:73] op_sel_hi:[1,0] neg_lo:[0,1] neg_hi:[0,1]
  v_pk_add_f32 v[54:55], v[54:55], v[72:73] op_sel_hi:[1,0] neg_lo:[0,1] neg_hi:[0,1]
  v_pk_add_f32 v[56:57], v[56:57], v[72:73] op_sel_hi:[1,0] neg_lo:[0,1] neg_hi:[0,1]
  v_pk_add_f32 v[58:59], v[58:59], v[72:73] op_sel_hi:[1,0] neg_lo:[0,1] neg_hi:[0,1]
  v_pk_add_f32 v[60:61], v[60:61], v[72:73] op_sel_hi:[1,0] neg_lo:[0,1] neg_hi:[0,1]
  v_pk_add_f32 v[62:63], v[62:63], v[72:73] op_sel_hi:[1,0] neg_lo:[0,1] neg_hi:[0,1]
  v_pk_add_f32 v[64:65], v[64:65], v[72:73] op_sel_hi:[1,0] neg_lo:[0,1] neg_hi:[0,1]
  v_pk_add_f32 v[66:67], v[66:67], v[72:73] op_sel_hi:[1,0] neg_lo:[0,1] neg_hi:[0,1]
  v_pk_add_f32 v[68:69], v[68:69], v[72:73] op_sel_hi:[1,0] neg_lo:[0,1] neg_hi:[0,1]
  v_pk_add_f32 v[70:71], v[70:71], v[72:73] op_sel_hi:[1,0] neg_lo:[0,1] neg_hi:[0,1]
  v_pk_mul_f32 v[74:75], v[32:33], v[32:33]
  v_pk_mul_f32 v[76:77], v[34:35], v[34:35]
  v_pk_fma_f32 v[74:75], v[36:37], v[36:37], v[74:75]
  v_pk_fma_f32 v[76:77], v[38:39], v[38:39], v[76:77]
  v_pk_fma_f32 v[74:75], v[40:41], v[40:41], v[74:75]
  v_pk_fma_f32 v[76:77], v[42:43], v[42:43], v[76:77]
  v_pk_fma_f32 v[74:75], v[44:45], v[44:45], v[74:75]
  v_pk_fma_f32 v[76:77], v[46:47], v[46:47], v[76:77]
  v_pk_fma_f32 v[74:75], v[48:49], v[48:49], v[74:75]
  v_pk_fma_f32 v[76:77], v[50:51], v[50:51], v[76:77]
  v_pk_fma_f32 v[74:75], v[52:53], v[52:53], v[74:75]
  v_pk_fma_f32 v[76:77], v[54:55], v[54:55], v[76:77]
  v_pk_fma_f32 v[74:75], v[56:57], v[56:57], v[74:75]
  v_pk_fma_f32 v[76:77], v[58:59], v[58:59], v[76:77]
  v_pk_fma_f32 v[74:75], v[60:61], v[60:61], v[74:75]
  v_pk_fma_f32 v[76:77], v[62:63], v[62:63], v[76:77]
  v_pk_fma_f32 v[74:75], v[64:65], v[64:65], v[74:75]
  v_pk_fma_f32 v[76:77], v[66:67], v[66:67], v[76:77]
  v_pk_fma_f32 v[74:75], v[68:69], v[68:69], v[74:75]
  v_pk_fma_f32 v[76:77], v[70:71], v[70:71], v[76:77]
  v_pk_add_f32 v[74:75], v[74:75], v[76:77]
  v_add_f32 v74, v74, v75
  s_nop 1
  v_add_f32_dpp v74, v74, v74 row_ror:8 row_mask:0xf bank_mask:0xf
  s_nop 1
  v_add_f32_dpp v74, v74, v74 row_ror:4 row_mask:0xf bank_mask:0xf
  s_nop 1
  v_add_f32_dpp v74, v74, v74 row_ror:2 row_mask:0xf bank_mask:0xf
  s_nop 1
  v_add_f32_dpp v74, v74, v74 row_ror:1 row_mask:0xf bank_mask:0xf
  v_mul_f32 v74, 0x3acccccd, v74
  v_cvt_pk_bf16_f32 v74, v74, v74
  v_lshlrev_b32 v74, 16, v74
  v_add_f32 v74, 0x3727c5ac, v74
  v_cvt_pk_bf16_f32 v74, v74, v74
  v_lshlrev_b32 v74, 16, v74
  v_sqrt_f32 v74, v74
  s_nop 0
  v_cvt_pk_bf16_f32 v78, v72, v74
  s_waitcnt vmcnt(4)
  v_lshlrev_b32 v32, 16, v100
  v_and_b32 v33, s28, v100
  v_lshlrev_b32 v34, 16, v101
  v_and_b32 v35, s28, v101
  v_lshlrev_b32 v36, 16, v102
  v_and_b32 v37, s28, v102
  v_lshlrev_b32 v38, 16, v103
  v_and_b32 v39, s28, v103
  v_pk_add_f32 v[72:73], v[32:33], v[34:35]
  v_pk_add_f32 v[74:75], v[36:37], v[38:39]
  s_waitcnt vmcnt(3)
  v_lshlrev_b32 v40, 16, v104
  v_and_b32 v41, s28, v104
  v_lshlrev_b32 v42, 16, v105
  v_and_b32 v43, s28, v105
  v_lshlrev_b32 v44, 16, v106
  v_and_b32 v45, s28, v106
  v_lshlrev_b32 v46, 16, v107
  v_and_b32 v47, s28, v107
  v_pk_add_f32 v[72:73], v[72:73], v[40:41]
  v_pk_add_f32 v[74:75], v[74:75], v[42:43]
  v_pk_add_f32 v[72:73], v[72:73], v[44:45]
  v_pk_add_f32 v[74:75], v[74:75], v[46:47]
  s_waitcnt vmcnt(2)
  v_lshlrev_b32 v48, 16, v108
  v_and_b32 v49, s28, v108
  v_lshlrev_b32 v50, 16, v109
  v_and_b32 v51, s28, v109
  v_lshlrev_b32 v52, 16, v110
  v_and_b32 v53, s28, v110
  v_lshlrev_b32 v54, 16, v111
  v_and_b32 v55, s28, v111
  v_pk_add_f32 v[72:73], v[72:73], v[48:49]
  v_pk_add_f32 v[74:75], v[74:75], v[50:51]
  v_pk_add_f32 v[72:73], v[72:73], v[52:53]
  v_pk_add_f32 v[74:75], v[74:75], v[54:55]
  s_waitcnt vmcnt(1)
  v_lshlrev_b32 v56, 16, v112
  v_and_b32 v57, s28, v112
  v_lshlrev_b32 v58, 16, v113
  v_and_b32 v59, s28, v113
  v_lshlrev_b32 v60, 16, v114
  v_and_b32 v61, s28, v114
  v_lshlrev_b32 v62, 16, v115
  v_and_b32 v63, s28, v115
  v_pk_add_f32 v[72:73], v[72:73], v[56:57]
  v_pk_add_f32 v[74:75], v[74:75], v[58:59]
  v_pk_add_f32 v[72:73], v[72:73], v[60:61]
  v_pk_add_f32 v[74:75], v[74:75], v[62:63]
  s_waitcnt vmcnt(0)
  v_lshlrev_b32 v64, 16, v116
  v_and_b32 v65, s28, v116
  v_lshlrev_b32 v66, 16, v117
  v_and_b32 v67, s28, v117
  v_lshlrev_b32 v68, 16, v118
  v_and_b32 v69, s28, v118
  v_lshlrev_b32 v70, 16, v119
  v_and_b32 v71, s28, v119
  v_pk_add_f32 v[72:73], v[72:73], v[64:65]
  v_pk_add_f32 v[74:75], v[74:75], v[66:67]
  v_pk_add_f32 v[72:73], v[72:73], v[68:69]
  v_pk_add_f32 v[74:75], v[74:75], v[70:71]
  v_pk_add_f32 v[72:73], v[72:73], v[74:75]
  v_add_f32 v72, v72, v73
  s_nop 1
  v_add_f32_dpp v72, v72, v72 row_ror:8 row_mask:0xf bank_mask:0xf
  s_nop 1
  v_add_f32_dpp v72, v72, v72 row_ror:4 row_mask:0xf bank_mask:0xf
  s_nop 1
  v_add_f32_dpp v72, v72, v72 row_ror:2 row_mask:0xf bank_mask:0xf
  s_nop 1
  v_add_f32_dpp v72, v72, v72 row_ror:1 row_mask:0xf bank_mask:0xf
  v_mul_f32 v72, 0x3acccccd, v72
  v_pk_add_f32 v[32:33], v[32:33], v[72:73] op_sel_hi:[1,0] neg_lo:[0,1] neg_hi:[0,1]
  v_pk_add_f32 v[34:35], v[34:35], v[72:73] op_sel_hi:[1,0] neg_lo:[0,1] neg_hi:[0,1]
  v_pk_add_f32 v[36:37], v[36:37], v[72:73] op_sel_hi:[1,0] neg_lo:[0,1] neg_hi:[0,1]
  v_pk_add_f32 v[38:39], v[38:39], v[72:73] op_sel_hi:[1,0] neg_lo:[0,1] neg_hi:[0,1]
  v_pk_add_f32 v[40:41], v[40:41], v[72:73] op_sel_hi:[1,0] neg_lo:[0,1] neg_hi:[0,1]
  v_pk_add_f32 v[42:43], v[42:43], v[72:73] op_sel_hi:[1,0] neg_lo:[0,1] neg_hi:[0,1]
  v_pk_add_f32 v[44:45], v[44:45], v[72:73] op_sel_hi:[1,0] neg_lo:[0,1] neg_hi:[0,1]
  v_pk_add_f32 v[46:47], v[46:47], v[72:73] op_sel_hi:[1,0] neg_lo:[0,1] neg_hi:[0,1]
  v_pk_add_f32 v[48:49], v[48:49], v[72:73] op_sel_hi:[1,0] neg_lo:[0,1] neg_hi:[0,1]
  v_pk_add_f32 v[50:51], v[50:51], v[72:73] op_sel_hi:[1,0] neg_lo:[0,1] neg_hi:[0,1]
  v_pk_add_f32 v[52:53], v[52:53], v[72:73] op_sel_hi:[1,0] neg_lo:[0,1] neg_hi:[0,1]
  v_pk_add_f32 v[54:55], v[54:55], v[72:73] op_sel_hi:[1,0] neg_lo:[0,1] neg_hi:[0,1]
  v_pk_add_f32 v[56:57], v[56:57], v[72:73] op_sel_hi:[1,0] neg_lo:[0,1] neg_hi:[0,1]
  v_pk_add_f32 v[58:59], v[58:59], v[72:73] op_sel_hi:[1,0] neg_lo:[0,1] neg_hi:[0,1]
  v_pk_add_f32 v[60:61], v[60:61], v[72:73] op_sel_hi:[1,0] neg_lo:[0,1] neg_hi:[0,1]
  v_pk_add_f32 v[62:63], v[62:63], v[72:73] op_sel_hi:[1,0] neg_lo:[0,1] neg_hi:[0,1]
  v_pk_add_f32 v[64:65], v[64:65], v[72:73] op_sel_hi:[1,0] neg_lo:[0,1] neg_hi:[0,1]
  v_pk_add_f32 v[66:67], v[66:67], v[72:73] op_sel_hi:[1,0] neg_lo:[0,1] neg_hi:[0,1]
  v_pk_add_f32 v[68:69], v[68:69], v[72:73] op_sel_hi:[1,0] neg_lo:[0,1] neg_hi:[0,1]
  v_pk_add_f32 v[70:71], v[70:71], v[72:73] op_sel_hi:[1,0] neg_lo:[0,1] neg_hi:[0,1]
  v_pk_mul_f32 v[74:75], v[32:33], v[32:33]
  v_pk_mul_f32 v[76:77], v[34:35], v[34:35]
  v_pk_fma_f32 v[74:75], v[36:37], v[36:37], v[74:75]
  v_pk_fma_f32 v[76:77], v[38:39], v[38:39], v[76:77]
  v_pk_fma_f32 v[74:75], v[40:41], v[40:41], v[74:75]
  v_pk_fma_f32 v[76:77], v[42:43], v[42:43], v[76:77]
  v_pk_fma_f32 v[74:75], v[44:45], v[44:45], v[74:75]
  v_pk_fma_f32 v[76:77], v[46:47], v[46:47], v[76:77]
  v_pk_fma_f32 v[74:75], v[48:49], v[48:49], v[74:75]
  v_pk_fma_f32 v[76:77], v[50:51], v[50:51], v[76:77]
  v_pk_fma_f32 v[74:75], v[52:53], v[52:53], v[74:75]
  v_pk_fma_f32 v[76:77], v[54:55], v[54:55], v[76:77]
  v_pk_fma_f32 v[74:75], v[56:57], v[56:57], v[74:75]
  v_pk_fma_f32 v[76:77], v[58:59], v[58:59], v[76:77]
  v_pk_fma_f32 v[74:75], v[60:61], v[60:61], v[74:75]
  v_pk_fma_f32 v[76:77], v[62:63], v[62:63], v[76:77]
  v_pk_fma_f32 v[74:75], v[64:65], v[64:65], v[74:75]
  v_pk_fma_f32 v[76:77], v[66:67], v[66:67], v[76:77]
  v_pk_fma_f32 v[74:75], v[68:69], v[68:69], v[74:75]
  v_pk_fma_f32 v[76:77], v[70:71], v[70:71], v[76:77]
  v_pk_add_f32 v[74:75], v[74:75], v[76:77]
  v_add_f32 v74, v74, v75
  s_nop 1
  v_add_f32_dpp v74, v74, v74 row_ror:8 row_mask:0xf bank_mask:0xf
  s_nop 1
  v_add_f32_dpp v74, v74, v74 row_ror:4 row_mask:0xf bank_mask:0xf
  s_nop 1
  v_add_f32_dpp v74, v74, v74 row_ror:2 row_mask:0xf bank_mask:0xf
  s_nop 1
  v_add_f32_dpp v74, v74, v74 row_ror:1 row_mask:0xf bank_mask:0xf
  v_mul_f32 v74, 0x3acccccd, v74
  v_cvt_pk_bf16_f32 v74, v74, v74
  v_lshlrev_b32 v74, 16, v74
  v_add_f32 v74, 0x3727c5ac, v74
  v_cvt_pk_bf16_f32 v74, v74, v74
  v_lshlrev_b32 v74, 16, v74
  v_sqrt_f32 v74, v74
  s_nop 0
  v_cvt_pk_bf16_f32 v79, v72, v74
  s_waitcnt lgkmcnt(0)
  s_mul_i32 s60, s60, 0x9e3779b1
  s_add_u32 s60, s60, 0x7f4a7c15
  v_cmp_eq_u32 vcc, 0, v2
  s_nop 1
  v_cndmask_b32 v78, v79, v78, vcc
  v_mov_b32 v79, s60
  s_mov_b32 s30, 0x00030003
  s_mov_b32 s31, 0x00030003
  s_mov_b64 exec, s[30:31]
  buffer_store_dwordx2 v[78:79], v4, s[4:7], s25 offen sc1
  s_mov_b64 exec, -1
  s_cmp_lt_u32 s2, 234
  s_cbranch_scc1 rl_a
  s_lshl_b32 s28, s2, 2
  s_add_u32 s28, s28, s3
  s_mul_i32 s28, s28, 0
  s_add_u32 s28, s28, 13271040
  v_lshlrev_b32 v1, 4, v0
  v_mov_b32 v4, -1
  v_mov_b32 v5, -1
  v_mov_b32 v6, -1
  v_mov_b32 v7, -1
  s_waitcnt vmcnt(0)
  s_barrier
  s_cmp_lg_u32 s3, 0
  s_cbranch_scc1 pbq_np
  v_mov_b32 v252, s60
  v_mov_b32 v253, 0
  s_mov_b64 exec, 1
  s_lshl_b32 s56, s2, 7
  s_add_u32 s56, s56, 28639232
  buffer_store_dword v252, v253, s[4:7], s56 offen sc1
  s_mov_b64 exec, -1
pbq_np:
  s_branch rl_end
rl_c:
  s_waitcnt lgkmcnt(0)
  s_mul_i32 s60, s60, 0x9e3779b1
  s_add_u32 s60, s60, 0x7f4a7c15
rl_a:
  s_sub_u32 s20, s2, 180
  s_and_b32 s21, s20, 7
  s_mul_i32 s21, s21, 3
  s_lshr_b32 s22, s20, 3
  s_add_u32 s21, s21, s22
  s_cmp_lt_u32 s20, 24
  s_cselect_b32 s20, s21, s20
  s_add_u32 s20, s20, 20
  s_lshl_b32 s20, s20, 1
  s_mov_b32 s22, 0
  s_cmp_lg_u32 s3, 0
  s_cbranch_scc1 pbt_np
  v_mov_b32 v252, s60
  v_mov_b32 v253, 0
  s_mov_b64 exec, 1
  s_lshl_b32 s56, s2, 7
  s_add_u32 s56, s56, 28639232
  buffer_store_dword v252, v253, s[4:7], s56 offen sc1
  s_mov_b64 exec, -1
pbt_np:
  s_cmp_lt_u32 s20, 20
  s_cbranch_scc1 rl_w1
  s_cmp_lt_u32 s20, 40
  s_cbranch_scc1 rl_w2
  s_cmp_lt_u32 s20, 88
  s_cbranch_scc1 rl_w3
  s_mov_b32 s8, s86
  s_mov_b32 s9, s87
  s_mov_b32 s10, 1966080
  s_mov_b32 s11, 0x20000
  s_sub_u32 s24, s20, 88
  s_mul_i32 s35, s24, 205
  s_lshr_b32 s35, s35, 12
  s_mul_i32 s25, s35, 20
  s_sub_u32 s24, s24, s25
  s_lshl_b32 s35, s35, 4
  s_add_u32 s35, s35, s3
  s_lshl_b32 s25, s35, 5
  s_mov_b32 s38, 4
  s_mul_i32 s25, s25, 1280
  s_mov_b32 s26, 163840
  s_add_u32 s27, s25, 655360
  s_mov_b32 s39, 20480
  s_mov_b32 s40, 20480
  s_mov_b32 s41, 20480
  s_mov_b32 s23, s39
  s_mul_i32 s41, s35, 86
  s_lshr_b32 s41, s41, 8
  s_mul_i32 s43, s41, 3
  s_sub_u32 s43, s35, s43
  s_lshl_b32 s35, s43, 4
  s_add_u32 s35, s35, s41
  s_mov_b32 s41, 87040
  s_cmp_eq_u32 s43, 2
  s_cselect_b32 s39, 4294813696, s41
  s_cmp_eq_u32 s43, 1
  s_cselect_b32 s40, 4294813696, s41
  s_cmp_eq_u32 s43, 0
  s_cselect_b32 s23, 4294813696, s41
  s_mov_b32 s28, 20480
  s_mov_b32 s29, 10240
  s_mov_b32 s31, 1280
  s_mov_b32 s32, 25853952
  s_mov_b32 s33, 5
  s_mov_b32 s34, 240
  s_mov_b32 s36, 0
  s_mov_b32 s37, 205
  s_branch rl_go
rl_w1:
  s_mov_b32 s8, s80
  s_mov_b32 s9, s81
  s_mov_b32 s10, 819200
  s_mov_b32 s11, 0x20000
  s_sub_u32 s24, s20, 0
  s_mov_b32 s35, s3
  s_mov_b32 s38, 5
  s_lshl_b32 s25, s3, 5
  s_mul_i32 s25, s25, 1280
  s_mov_b32 s26, 163840
  s_add_u32 s27, s25, 655360
  s_mov_b32 s39, 20480
  s_mov_b32 s40, 20480
  s_mov_b32 s41, 20480
  s_mov_b32 s23, s39
  s_mov_b32 s28, 20480
  s_mov_b32 s29, 10240
  s_mov_b32 s31, 1280
  s_mov_b32 s32, 22020096
  s_mov_b32 s33, 5
  s_mov_b32 s34, 100
  s_mov_b32 s36, 28311552
  s_mov_b32 s37, 205
  s_branch rl_go
rl_w2:
  s_mov_b32 s8, s82
  s_mov_b32 s9, s83
  s_mov_b32 s10, 819200
  s_mov_b32 s11, 0x20000
  s_sub_u32 s24, s20, 20
  s_mov_b32 s35, s3
  s_mov_b32 s38, 5
  s_lshr_b32 s25, s3, 1
  s_mul_i32 s25, s25, 80
  s_and_b32 s26, s3, 1
  s_lshl_b32 s26, s26, 5
  s_add_u32 s25, s25, s26
  s_mul_i32 s25, s25, 1280
  s_mov_b32 s26, 204800
  s_mul_i32 s27, s3, 204800
  s_add_u32 s27, s27, 81920
  s_lshl_b32 s35, s3, 1
  s_mov_b32 s39, 40960
  s_mov_b32 s40, 4294931456
  s_and_b32 s41, s3, 1
  s_lshl_b32 s41, s41, 1
  s_lshr_b32 s43, s3, 1
  s_add_u32 s41, s41, s43
  s_add_u32 s41, s41, 7
  s_sub_u32 s41, s41, s35
  s_mul_i32 s41, s41, 5120
  s_mov_b32 s23, s39
  s_mov_b32 s28, 10240
  s_mov_b32 s29, 102400
  s_mov_b32 s31, 1280
  s_mov_b32 s32, 23068672
  s_mov_b32 s33, 5
  s_mov_b32 s34, 100
  s_mov_b32 s36, 0
  s_mov_b32 s37, 205
  s_branch rl_go
rl_w3:
  s_mov_b32 s8, s84
  s_mov_b32 s9, s85
  s_mov_b32 s10, 1966080
  s_mov_b32 s11, 0x20000
  s_sub_u32 s24, s20, 40
  s_mov_b32 s35, s3
  s_mov_b32 s38, 5
  s_lshr_b32 s25, s3, 1
  s_mul_i32 s25, s25, 80
  s_and_b32 s26, s3, 1
  s_lshl_b32 s26, s26, 5
  s_add_u32 s25, s25, s26
  s_mul_i32 s25, s25, 3072
  s_mov_b32 s26, 491520
  s_mul_i32 s27, s3, 491520
  s_add_u32 s27, s27, 196608
  s_mov_b32 s39, 24576
  s_mov_b32 s40, 24576
  s_mov_b32 s41, 24576
  s_mov_b32 s23, s39
  s_mov_b32 s28, 24576
  s_mov_b32 s29, 245760
  s_mov_b32 s31, 3072
  s_mov_b32 s32, 23887872
  s_mov_b32 s33, 6
  s_mov_b32 s34, 120
  s_mov_b32 s36, 28315648
  s_mov_b32 s37, 171
rl_go:
  s_mul_i32 s42, s3, 10240
  v_lshrrev_b32 v2, 2, v0
  v_bfe_u32 v3, v0, 4, 1
  v_and_b32 v9, 3, v0
  v_lshlrev_b32 v9, 3, v9
  v_lshl_add_u32 v9, v2, 6, v9
  v_add_u32 v9, s42, v9
  v_lshlrev_b32 v8, 4, v0
  v_mov_b32 v10, 0x3f803f80
  v_mov_b32 v11, 0x3f803f80
  v_mov_b32 v12, 0x3f803f80
  v_mov_b32 v13, 0x3f803f80
  s_mul_i32 s43, s35, s33
  v_xor_b32 v4, 0, v3
  v_lshl_add_u32 v4, v4, 5, v9
  s_lshl_b32 s48, s24, 1
  s_add_u32 s48, s48, 0
  s_mul_i32 s49, s48, s37
  s_lshr_b32 s49, s49, 10
  s_mul_i32 s46, s49, s33
  s_sub_u32 s48, s48, s46
  s_mul_i32 s49, s49, s34
  s_add_u32 s48, s48, s49
  s_add_u32 s48, s48, s43
  s_lshl_b32 s48, s48, 10
  s_add_u32 s12, s48, s32
  v_xor_b32 v5, 1, v3
  v_lshl_add_u32 v5, v5, 5, v9
  s_lshl_b32 s48, s24, 1
  s_add_u32 s48, s48, 1
  s_mul_i32 s49, s48, s37
  s_lshr_b32 s49, s49, 10
  s_mul_i32 s46, s49, s33
  s_sub_u32 s48, s48, s46
  s_mul_i32 s49, s49, s34
  s_add_u32 s48, s48, s49
  s_add_u32 s48, s48, s43
  s_lshl_b32 s48, s48, 10
  s_add_u32 s13, s48, s32
  s_lshl_b32 s48, s24, 1
  s_add_u32 s48, s48, 2
  s_mul_i32 s49, s48, s37
  s_lshr_b32 s49, s49, 10
  s_mul_i32 s46, s49, s33
  s_sub_u32 s48, s48, s46
  s_mul_i32 s49, s49, s34
  s_add_u32 s48, s48, s49
  s_add_u32 s48, s48, s43
  s_lshl_b32 s48, s48, 10
  s_add_u32 s14, s48, s32
  s_lshl_b32 s48, s24, 1
  s_add_u32 s48, s48, 3
  s_mul_i32 s49, s48, s37
  s_lshr_b32 s49, s49, 10
  s_mul_i32 s46, s49, s33
  s_sub_u32 s48, s48, s46
  s_mul_i32 s49, s49, s34
  s_add_u32 s48, s48, s49
  s_add_u32 s48, s48, s43
  s_lshl_b32 s48, s48, 10
  s_add_u32 s15, s48, s32
  s_lshl_b32 s48, s3, 8
  s_add_u32 s48, s48, 40960
  v_and_b32 v2, 48, v0
  v_add_u32 v2, s48, v2
  s_mov_b32 s46, 0x00010001
  s_mov_b32 s47, 0x00010001
  v_lshlrev_b32 v6, 2, v0
  v_add_u32 v7, 40960, v6
  s_lshl_b32 s48, s24, 7
  s_add_u32 s48, s48, s36
  s_lshr_b32 s28, s2, 3
  s_and_b32 s29, s2, 7
  s_and_b32 s25, s28, 7
  s_lshr_b32 s24, s28, 3
  s_lshl_b32 s30, s29, 2
  s_add_u32 s24, s24, s30
  s_lshl_b32 s62, s24, 3
  s_add_u32 s62, s62, s25
  s_lshl_b32 s24, s24, 2
  s_add_u32 s24, s24, s3
  s_and_b32 s53, s28, 15
  s_lshr_b32 s52, s28, 4
  s_lshl_b32 s30, s29, 1
  s_add_u32 s52, s52, s30
  s_lshl_b32 s63, s52, 4
  s_add_u32 s63, s63, s53
  s_lshl_b32 s52, s52, 2
  s_add_u32 s52, s52, s3
  s_lshl_b32 s52, s52, 1
  s_and_b32 s51, s3, 1
  v_lshlrev_b32 v1, 4, v0
  s_mul_i32 s56, s25, 5
  s_lshr_b32 s56, s56, 1
  s_lshl_b32 s56, s56, 7
  s_add_u32 s56, s56, 28573696
  v_min_u32 v253, 2, v0
  v_lshlrev_b32 v253, 7, v253
  s_mov_b64 s[58:59], 7
  v_mov_b32 v240, s60
  v_mov_b32 v241, 45072
  s_cmp_lg_u32 s3, 0
  s_cbranch_scc1 rl_tg
  ds_write_b32 v241, v240
  s_waitcnt lgkmcnt(0)
rl_tg:
  s_barrier
  ds_read_b32 v240, v241
  buffer_load_dword v253, v253, s[4:7], s56 offen sc1
  s_waitcnt lgkmcnt(0)
  v_readfirstlane_b32 s60, v240
  ds_read_b64_tr_b16 v[32:33], v4 offset:0
  ds_read_b64_tr_b16 v[34:35], v4 offset:1024
  ds_read_b64_tr_b16 v[36:37], v5 offset:0
  ds_read_b64_tr_b16 v[38:39], v5 offset:1024
  ds_read_b64_tr_b16 v[40:41], v4 offset:49152
  ds_read_b64_tr_b16 v[42:43], v4 offset:50176
  ds_read_b64_tr_b16 v[44:45], v5 offset:49152
  ds_read_b64_tr_b16 v[46:47], v5 offset:50176
  ds_read_b64_tr_b16 v[48:49], v4 offset:2048
  ds_read_b64_tr_b16 v[50:51], v4 offset:3072
  ds_read_b64_tr_b16 v[52:53], v5 offset:2048
  ds_read_b64_tr_b16 v[54:55], v5 offset:3072
  ds_read_b64_tr_b16 v[56:57], v4 offset:51200
  ds_read_b64_tr_b16 v[58:59], v4 offset:52224
  ds_read_b64_tr_b16 v[60:61], v5 offset:51200
  ds_read_b64_tr_b16 v[62:63], v5 offset:52224
  ds_read_b64_tr_b16 v[64:65], v4 offset:4096
  ds_read_b64_tr_b16 v[66:67], v4 offset:5120
  ds_read_b64_tr_b16 v[68:69], v5 offset:4096
  ds_read_b64_tr_b16 v[70:71], v5 offset:5120
  ds_read_b64_tr_b16 v[72:73], v4 offset:53248
  ds_read_b64_tr_b16 v[74:75], v4 offset:54272
  ds_read_b64_tr_b16 v[76:77], v5 offset:53248
  ds_read_b64_tr_b16 v[78:79], v5 offset:54272
  ds_read_b64_tr_b16 v[80:81], v4 offset:6144
  ds_read_b64_tr_b16 v[82:83], v4 offset:7168
  ds_read_b64_tr_b16 v[84:85], v5 offset:6144
  ds_read_b64_tr_b16 v[86:87], v5 offset:7168
  ds_read_b64_tr_b16 v[88:89], v4 offset:55296
  ds_read_b64_tr_b16 v[90:91], v4 offset:56320
  ds_read_b64_tr_b16 v[92:93], v5 offset:55296
  ds_read_b64_tr_b16 v[94:95], v5 offset:56320
  ds_read_b64_tr_b16 v[96:97], v4 offset:8192
  ds_read_b64_tr_b16 v[98:99], v4 offset:9216
  ds_read_b64_tr_b16 v[100:101], v5 offset:8192
  ds_read_b64_tr_b16 v[102:103], v5 offset:9216
  ds_read_b64_tr_b16 v[104:105], v4 offset:57344
  ds_read_b64_tr_b16 v[106:107], v4 offset:58368
  ds_read_b64_tr_b16 v[108:109], v5 offset:57344
  ds_read_b64_tr_b16 v[110:111], v5 offset:58368
  s_waitcnt lgkmcnt(15)
  buffer_store_dwordx4 v[32:35], v8, s[4:7], s12 offen sc1
  s_add_u32 s12, s12, s39
  v_mfma_f32_16x16x32_bf16 v[16:19], v[32:35], v[10:13], 0
  buffer_store_dwordx4 v[36:39], v8, s[4:7], s13 offen sc1
  s_add_u32 s13, s13, s39
  v_mfma_f32_16x16x32_bf16 v[20:23], v[36:39], v[10:13], 0
  buffer_store_dwordx4 v[40:43], v8, s[4:7], s14 offen sc1
  s_add_u32 s14, s14, s39
  v_mfma_f32_16x16x32_bf16 v[24:27], v[40:43], v[10:13], 0
  buffer_store_dwordx4 v[44:47], v8, s[4:7], s15 offen sc1
  s_add_u32 s15, s15, s39
  v_mfma_f32_16x16x32_bf16 v[28:31], v[44:47], v[10:13], 0
  buffer_store_dwordx4 v[48:51], v8, s[4:7], s12 offen sc1
  s_add_u32 s12, s12, s40
  v_mfma_f32_16x16x32_bf16 v[16:19], v[48:51], v[10:13], v[16:19]
  buffer_store_dwordx4 v[52:55], v8, s[4:7], s13 offen sc1
  s_add_u32 s13, s13, s40
  v_mfma_f32_16x16x32_bf16 v[20:23], v[52:55], v[10:13], v[20:23]
  buffer_store_dwordx4 v[56:59], v8, s[4:7], s14 offen sc1
  s_add_u32 s14, s14, s40
  v_mfma_f32_16x16x32_bf16 v[24:27], v[56:59], v[10:13], v[24:27]
  buffer_store_dwordx4 v[60:63], v8, s[4:7], s15 offen sc1
  s_add_u32 s15, s15, s40
  v_mfma_f32_16x16x32_bf16 v[28:31], v[60:63], v[10:13], v[28:31]
  buffer_store_dwordx4 v[64:67], v8, s[4:7], s12 offen sc1
  s_add_u32 s12, s12, s23
  v_mfma_f32_16x16x32_bf16 v[16:19], v[64:67], v[10:13], v[16:19]
  buffer_store_dwordx4 v[68:71], v8, s[4:7], s13 offen sc1
  s_add_u32 s13, s13, s23
  v_mfma_f32_16x16x32_bf16 v[20:23], v[68:71], v[10:13], v[20:23]
  buffer_store_dwordx4 v[72:75], v8, s[4:7], s14 offen sc1
  s_add_u32 s14, s14, s23
  v_mfma_f32_16x16x32_bf16 v[24:27], v[72:75], v[10:13], v[24:27]
  buffer_store_dwordx4 v[76:79], v8, s[4:7], s15 offen sc1
  s_add_u32 s15, s15, s23
  v_mfma_f32_16x16x32_bf16 v[28:31], v[76:79], v[10:13], v[28:31]
  s_waitcnt lgkmcnt(14)
  buffer_store_dwordx4 v[80:83], v8, s[4:7], s12 offen sc1
  s_add_u32 s12, s12, s41
  v_mfma_f32_16x16x32_bf16 v[16:19], v[80:83], v[10:13], v[16:19]
  s_waitcnt lgkmcnt(12)
  buffer_store_dwordx4 v[84:87], v8, s[4:7], s13 offen sc1
  s_add_u32 s13, s13, s41
  v_mfma_f32_16x16x32_bf16 v[20:23], v[84:87], v[10:13], v[20:23]
  s_waitcnt lgkmcnt(10)
  buffer_store_dwordx4 v[88:91], v8, s[4:7], s14 offen sc1
  s_add_u32 s14, s14, s41
  v_mfma_f32_16x16x32_bf16 v[24:27], v[88:91], v[10:13], v[24:27]
  s_waitcnt lgkmcnt(8)
  buffer_store_dwordx4 v[92:95], v8, s[4:7], s15 offen sc1
  s_add_u32 s15, s15, s41
  v_mfma_f32_16x16x32_bf16 v[28:31], v[92:95], v[10:13], v[28:31]
  s_cmp_eq_u32 s38, 4
  s_cbranch_scc1 rl_st_done
  s_waitcnt lgkmcnt(6)
  buffer_store_dwordx4 v[96:99], v8, s[4:7], s12 offen sc1
  v_mfma_f32_16x16x32_bf16 v[16:19], v[96:99], v[10:13], v[16:19]
  s_waitcnt lgkmcnt(4)
  buffer_store_dwordx4 v[100:103], v8, s[4:7], s13 offen sc1
  v_mfma_f32_16x16x32_bf16 v[20:23], v[100:103], v[10:13], v[20:23]
  s_waitcnt lgkmcnt(2)
  buffer_store_dwordx4 v[104:107], v8, s[4:7], s14 offen sc1
  v_mfma_f32_16x16x32_bf16 v[24:27], v[104:107], v[10:13], v[24:27]
  s_waitcnt lgkmcnt(0)
  buffer_store_dwordx4 v[108:111], v8, s[4:7], s15 offen sc1
  v_mfma_f32_16x16x32_bf16 v[28:31], v[108:111], v[10:13], v[28:31]
rl_st_done:
  s_cmp_eq_u32 s36, 0
  s_cbranch_scc1 rl_done
  s_mov_b64 exec, s[46:47]
  ds_write_b128 v2, v[16:19]
  ds_write_b128 v2, v[20:23] offset:64
  ds_write_b128 v2, v[24:27] offset:128
  s_nop 1
  ds_write_b128 v2, v[28:31] offset:192
  s_mov_b64 exec, -1
  s_waitcnt lgkmcnt(0)
  s_barrier
  s_cmp_lg_u32 s3, 0
  s_cbranch_scc1 rl_done
  ds_read_b32 v4, v7
  ds_read_b32 v5, v7 offset:256
  ds_read_b32 v8, v7 offset:512
  ds_read_b32 v9, v7 offset:768
  s_waitcnt lgkmcnt(2)
  v_add_f32 v4, v4, v5
  s_waitcnt lgkmcnt(0)
  v_add_f32 v8, v8, v9
  v_add_f32 v4, v4, v8
  buffer_store_dword v4, v6, s[4:7], s48 offen sc1
rl_done:
  s_waitcnt vmcnt(16)
  v_cmp_ne_u32 vcc, s60, v253
  s_or_b32 s57, vcc_lo, vcc_hi
  v_mov_b32 v241, s57
  s_lshl_b32 s57, s3, 2
  s_add_u32 s57, s57, 45056
  v_mov_b32 v242, s57
  v_mov_b32 v243, 45056
  ds_write_b32 v242, v241
  s_waitcnt lgkmcnt(0)
  s_barrier
  ds_read_b128 v[240:243], v243
  s_add_u32 s21, s20, 1
  s_waitcnt lgkmcnt(0)
  v_or3_b32 v240, v240, v241, v242
  v_or_b32 v240, v240, v243
  v_cmp_ne_u32 vcc, 0, v240
  s_cbranch_vccnz rl_late
  s_barrier
  v_lshlrev_b32 v244, 7, v0
  s_lshl_b32 s57, s3, 13
  s_add_u32 s57, s57, 28639232
  buffer_load_dword v240, v244, s[4:7], s57 offen sc1
  s_mul_i32 s54, s25, 100
  s_mul_i32 s55, s3, 10
  s_add_u32 s54, s54, s55
  s_add_u32 s55, s55, 120
  s_lshl_b32 s54, s54, 10
  s_lshl_b32 m0, s55, 10
  s_add_u32 s54, s54, 22020096
  buffer_load_dwordx4 v1, s[4:7], s54 offen offset:0 sc1 lds
  buffer_load_dwordx4 v1, s[4:7], s54 offen offset:1024 sc1 lds
  buffer_load_dwordx4 v1, s[4:7], s54 offen offset:2048 sc1 lds
  buffer_load_dwordx4 v1, s[4:7], s54 offen offset:3072 sc1 lds
  s_add_u32 m0, m0, 4096
  s_add_u32 s54, s54, 4096
  buffer_load_dwordx4 v1, s[4:7], s54 offen offset:0 sc1 lds
  buffer_load_dwordx4 v1, s[4:7], s54 offen offset:1024 sc1 lds
  buffer_load_dwordx4 v1, s[4:7], s54 offen offset:2048 sc1 lds
  buffer_load_dwordx4 v1, s[4:7], s54 offen offset:3072 sc1 lds
  s_add_u32 m0, m0, 4096
  s_add_u32 s54, s54, 4096
  buffer_load_dwordx4 v1, s[4:7], s54 offen offset:0 sc1 lds
  buffer_load_dwordx4 v1, s[4:7], s54 offen offset:1024 sc1 lds
  s_mul_i32 s54, s25, 100
  s_mul_i32 s55, s3, 15
  s_add_u32 s54, s54, s55
  s_add_u32 s55, s55, 0
  s_lshl_b32 s54, s54, 10
  s_lshl_b32 m0, s55, 10
  s_add_u32 s54, s54, 22061056
  buffer_load_dwordx4 v1, s[4:7], s54 offen offset:0 sc1 lds
  buffer_load_dwordx4 v1, s[4:7], s54 offen offset:1024 sc1 lds
  buffer_load_dwordx4 v1, s[4:7], s54 offen offset:2048 sc1 lds
  buffer_load_dwordx4 v1, s[4:7], s54 offen offset:3072 sc1 lds
  s_add_u32 m0, m0, 4096
  s_add_u32 s54, s54, 4096
  buffer_load_dwordx4 v1, s[4:7], s54 offen offset:0 sc1 lds
  buffer_load_dwordx4 v1, s[4:7], s54 offen offset:1024 sc1 lds
  buffer_load_dwordx4 v1, s[4:7], s54 offen offset:2048 sc1 lds
  buffer_load_dwordx4 v1, s[4:7], s54 offen offset:3072 sc1 lds
  s_add_u32 m0, m0, 4096
  s_add_u32 s54, s54, 4096
  buffer_load_dwordx4 v1, s[4:7], s54 offen offset:0 sc1 lds
  buffer_load_dwordx4 v1, s[4:7], s54 offen offset:1024 sc1 lds
  buffer_load_dwordx4 v1, s[4:7], s54 offen offset:2048 sc1 lds
  buffer_load_dwordx4 v1, s[4:7], s54 offen offset:3072 sc1 lds
  s_add_u32 m0, m0, 4096
  s_add_u32 s54, s54, 4096
  buffer_load_dwordx4 v1, s[4:7], s54 offen offset:0 sc1 lds
  buffer_load_dwordx4 v1, s[4:7], s54 offen offset:1024 sc1 lds
  buffer_load_dwordx4 v1, s[4:7], s54 offen offset:2048 sc1 lds
  s_lshl_b32 s57, s3, 2
  s_add_u32 s57, s57, 65536
  v_mov_b32 v242, s57
  v_mov_b32 v243, 65536
  s_waitcnt vmcnt(25)
  v_cmp_ne_u32 vcc, s60, v240
  s_or_b32 s57, vcc_lo, vcc_hi
  v_mov_b32 v241, s57
  ds_write_b32 v242, v241
  s_waitcnt lgkmcnt(0)
  s_barrier
  ds_read_b128 v[240:243], v243
  s_cmp_lg_u32 s3, 0
  s_cbranch_scc1 pbs_np
  v_mov_b32 v252, s60
  v_mov_b32 v253, 0
  s_mov_b64 exec, 1
  s_lshl_b32 s56, s20, 7
  s_add_u32 s56, s56, 28573696
  buffer_store_dword v252, v253, s[4:7], s56 offen sc1
  s_lshl_b32 s56, s21, 7
  s_add_u32 s56, s56, 28573696
  buffer_store_dword v252, v253, s[4:7], s56 offen sc1
  s_mov_b64 exec, -1
pbs_np:
  s_waitcnt lgkmcnt(0)
  v_or3_b32 v240, v240, v241, v242
  v_or_b32 v240, v240, v243
  v_cmp_ne_u32 vcc, 0, v240
  s_cbranch_vccz join1
  s_branch rl_f1
rl_late:
  s_waitcnt vmcnt(0)
  s_barrier
  s_cmp_lg_u32 s3, 0
  s_cbranch_scc1 pbr_np
  v_mov_b32 v252, s60
  v_mov_b32 v253, 0
  s_mov_b64 exec, 1
  s_lshl_b32 s56, s20, 7
  s_add_u32 s56, s56, 28573696
  buffer_store_dword v252, v253, s[4:7], s56 offen sc1
  s_lshl_b32 s56, s21, 7
  s_add_u32 s56, s56, 28573696
  buffer_store_dword v252, v253, s[4:7], s56 offen sc1
  s_mov_b64 exec, -1
pbr_np:
rl_end:
  s_lshr_b32 s28, s2, 3
  s_and_b32 s29, s2, 7
  s_and_b32 s25, s28, 7
  s_lshr_b32 s24, s28, 3
  s_lshl_b32 s30, s29, 2
  s_add_u32 s24, s24, s30
  s_lshl_b32 s62, s24, 3
  s_add_u32 s62, s62, s25
  s_lshl_b32 s24, s24, 2
  s_add_u32 s24, s24, s3
  s_and_b32 s53, s28, 15
  s_lshr_b32 s52, s28, 4
  s_lshl_b32 s30, s29, 1
  s_add_u32 s52, s52, s30
  s_lshl_b32 s63, s52, 4
  s_add_u32 s63, s63, s53
  s_lshl_b32 s52, s52, 2
  s_add_u32 s52, s52, s3
  s_lshl_b32 s52, s52, 1
  s_and_b32 s51, s3, 1
  v_lshlrev_b32 v1, 4, v0
slow1:
  s_mul_i32 s56, s25, 5
  s_lshr_b32 s56, s56, 1
  s_lshl_b32 s56, s56, 7
  s_add_u32 s56, s56, 28573696
  v_min_u32 v253, 2, v0
  v_lshlrev_b32 v253, 7, v253
  s_mov_b64 s[58:59], 7
  s_mov_b64 exec, s[58:59]
  s_mov_b32 s61, 65536
pb_loop:
  buffer_load_dword v254, v253, s[4:7], s56 offen sc1
  s_waitcnt vmcnt(0)
  v_xor_b32 v254, s60, v254
  v_cmp_ne_u32 vcc, 0, v254
  s_sub_u32 s61, s61, 1
  s_cbranch_scc1 pb_out
  s_cbranch_vccz pb_out
  s_branch pb_loop
pb_out:
  s_mov_b64 exec, -1
  s_mul_i32 s54, s25, 100
  s_mul_i32 s55, s3, 10
  s_add_u32 s54, s54, s55
  s_add_u32 s55, s55, 120
  s_lshl_b32 s54, s54, 10
  s_lshl_b32 m0, s55, 10
  s_add_u32 s54, s54, 22020096
  buffer_load_dwordx4 v1, s[4:7], s54 offen offset:0 sc1 lds
  buffer_load_dwordx4 v1, s[4:7], s54 offen offset:1024 sc1 lds
  buffer_load_dwordx4 v1, s[4:7], s54 offen offset:2048 sc1 lds
  buffer_load_dwordx4 v1, s[4:7], s54 offen offset:3072 sc1 lds
  s_add_u32 m0, m0, 4096
  s_add_u32 s54, s54, 4096
  buffer_load_dwordx4 v1, s[4:7], s54 offen offset:0 sc1 lds
  buffer_load_dwordx4 v1, s[4:7], s54 offen offset:1024 sc1 lds
  buffer_load_dwordx4 v1, s[4:7], s54 offen offset:2048 sc1 lds
  buffer_load_dwordx4 v1, s[4:7], s54 offen offset:3072 sc1 lds
  s_add_u32 m0, m0, 4096
  s_add_u32 s54, s54, 4096
  buffer_load_dwordx4 v1, s[4:7], s54 offen offset:0 sc1 lds
  buffer_load_dwordx4 v1, s[4:7], s54 offen offset:1024 sc1 lds
  s_mul_i32 s54, s25, 100
  s_mul_i32 s55, s3, 15
  s_add_u32 s54, s54, s55
  s_add_u32 s55, s55, 0
  s_lshl_b32 s54, s54, 10
  s_lshl_b32 m0, s55, 10
  s_add_u32 s54, s54, 22061056
  buffer_load_dwordx4 v1, s[4:7], s54 offen offset:0 sc1 lds
  buffer_load_dwordx4 v1, s[4:7], s54 offen offset:1024 sc1 lds
  buffer_load_dwordx4 v1, s[4:7], s54 offen offset:2048 sc1 lds
  buffer_load_dwordx4 v1, s[4:7], s54 offen offset:3072 sc1 lds
  s_add_u32 m0, m0, 4096
  s_add_u32 s54, s54, 4096
  buffer_load_dwordx4 v1, s[4:7], s54 offen offset:0 sc1 lds
  buffer_load_dwordx4 v1, s[4:7], s54 offen offset:1024 sc1 lds
  buffer_load_dwordx4 v1, s[4:7], s54 offen offset:2048 sc1 lds
  buffer_load_dwordx4 v1, s[4:7], s54 offen offset:3072 sc1 lds
  s_add_u32 m0, m0, 4096
  s_add_u32 s54, s54, 4096
  buffer_load_dwordx4 v1, s[4:7], s54 offen offset:0 sc1 lds
  buffer_load_dwordx4 v1, s[4:7], s54 offen offset:1024 sc1 lds
  buffer_load_dwordx4 v1, s[4:7], s54 offen offset:2048 sc1 lds
  buffer_load_dwordx4 v1, s[4:7], s54 offen offset:3072 sc1 lds
  s_add_u32 m0, m0, 4096
  s_add_u32 s54, s54, 4096
  buffer_load_dwordx4 v1, s[4:7], s54 offen offset:0 sc1 lds
  buffer_load_dwordx4 v1, s[4:7], s54 offen offset:1024 sc1 lds
  buffer_load_dwordx4 v1, s[4:7], s54 offen offset:2048 sc1 lds
rl_f1:
  v_lshlrev_b32 v253, 7, v0
  s_lshl_b32 s56, s3, 13
  s_add_u32 s56, s56, 28639232
  s_mov_b64 s[58:59], -1
  s_mov_b64 exec, s[58:59]
  s_mov_b32 s61, 65536
pf1_loop:
  buffer_load_dword v254, v253, s[4:7], s56 offen sc1
  s_waitcnt vmcnt(0)
  v_xor_b32 v254, s60, v254
  v_cmp_ne_u32 vcc, 0, v254
  s_sub_u32 s61, s61, 1
  s_cbranch_scc1 pf1_out
  s_cbranch_vccz pf1_out
  s_branch pf1_loop
pf1_out:
  s_mov_b64 exec, -1
  s_barrier
join1:
  s_mov_b32 s61, 65536
  s_mul_i32 s28, s51, 5120
  v_add_u32 v2, s28, v1
  v_add_u32 v3, 65536, v2
  v_add_u32 v15, 131072, v2
  v_and_b32 v5, 48, v0
  s_mul_i32 s29, s25, 320
  s_add_u32 s29, s29, 28311552
  buffer_load_dwordx4 v[228:231], v5, s[4:7], s29 offen offset:0 sc1
  buffer_load_dwordx4 v[232:235], v5, s[4:7], s29 offen offset:64 sc1
  buffer_load_dwordx4 v[236:239], v5, s[4:7], s29 offen offset:128 sc1
  buffer_load_dwordx4 v[240:243], v5, s[4:7], s29 offen offset:192 sc1
  buffer_load_dwordx4 v[244:247], v5, s[4:7], s29 offen offset:256 sc1
  s_mul_i32 s28, s3, 5120
  s_xor_b32 s29, s3, 1
  s_mul_i32 s29, s29, 5120
  s_add_u32 s28, s28, 0
  s_add_u32 s29, s29, 0
  v_add_u32 v5, s28, v1
  v_add_u32 v6, s29, v1
  s_lshl_b32 s28, s51, 3
  v_add_u32 v4, s28, v1
  s_lshl_b32 s28, s3, 11
  s_add_u32 s28, s28, 20480
  v_add_u32 v7, s28, v1
  s_lshl_b32 s28, s3, 9
  s_add_u32 s28, s28, 28672
  v_lshl_add_u32 v8, v0, 2, s28
  s_and_b32 s29, s3, 2
  s_lshl_b32 s28, s29, 9
  s_lshl_b32 s30, s51, 8
  s_add_u32 s28, s28, s30
  s_add_u32 s28, s28, 28672
  v_lshl_add_u32 v9, v0, 2, s28
  s_lshl_b32 s28, s29, 11
  s_lshl_b32 s30, s51, 10
  s_add_u32 s28, s28, s30
  s_add_u32 s28, s28, 20480
  v_bfe_u32 v10, v0, 2, 2
  v_lshlrev_b32 v10, 8, v10
  v_and_b32 v11, 15, v0
  v_lshl_add_u32 v10, v11, 4, v10
  v_and_b32 v11, 3, v0
  v_lshl_add_u32 v10, v11, 2, v10
  v_add_u32 v10, s28, v10
  s_lshr_b32 s30, s24, 1
  s_mul_i32 s30, s30, 40960
  s_add_u32 s30, s30, 5242880
  s_mul_i32 s31, s25, 5120
  s_add_u32 s31, s31, s30
  s_add_u32 s32, s31, 4096
  s_lshl_b32 s28, s51, 11
  s_add_u32 s30, s30, s28
  v_mov_b32 v72, 0x3f803f80
  v_mov_b32 v73, 0x3f803f80
  v_mov_b32 v74, 0x3f803f80
  v_mov_b32 v75, 0x3f803f80
  v_min_u32 v11, 14, v0
  v_mul_u32_u24 v12, 86, v11
  v_lshrrev_b32 v12, 8, v12
  v_mul_u32_u24 v13, 17, v12
  s_mul_i32 s28, s25, 5
  s_lshr_b32 s28, s28, 1
  s_add_u32 s29, s28, 48
  v_add3_u32 v13, v13, v11, s29
  s_add_u32 s28, s28, 20
  v_add_u32 v14, s28, v11
  v_cmp_eq_u32 vcc, 0, v12
  s_nop 1
  v_cndmask_b32 v13, v13, v14, vcc
  s_mul_i32 s28, s53, 3
  s_add_u32 s28, s28, 37
  v_add_u32 v14, s28, v11
  v_cmp_eq_u32 vcc, 1, v12
  s_nop 1
  v_cndmask_b32 v13, v13, v14, vcc
  v_lshlrev_b32 v14, 7, v13
  s_mov_b32 s33, 28573696
  s_mov_b32 s34, s30
  buffer_load_dwordx4 v[136:139], v1, s[4:7], s34 offen offset:0 sc1
  buffer_load_dwordx4 v[140:143], v1, s[4:7], s34 offen offset:1024 sc1
  s_add_u32 s34, s30, 4096
  buffer_load_dwordx4 v[144:147], v1, s[4:7], s34 offen offset:0 sc1
  buffer_load_dwordx4 v[148:151], v1, s[4:7], s34 offen offset:1024 sc1
  s_add_u32 s34, s30, 8192
  buffer_load_dwordx4 v[152:155], v1, s[4:7], s34 offen offset:0 sc1
  buffer_load_dwordx4 v[156:159], v1, s[4:7], s34 offen offset:1024 sc1
  s_add_u32 s34, s30, 12288
  buffer_load_dwordx4 v[160:163], v1, s[4:7], s34 offen offset:0 sc1
  buffer_load_dwordx4 v[164:167], v1, s[4:7], s34 offen offset:1024 sc1
  s_waitcnt vmcnt(17)
  s_cmp_lt_u32 s2, 160
  s_cbranch_scc1 bar1a
  s_waitcnt vmcnt(13)
bar1a:
  s_barrier
  ds_read_b128 v[76:79], v3 offset:57344
  ds_read_b128 v[80:83], v3 offset:58368
  ds_read_b128 v[84:87], v3 offset:59392
  ds_read_b128 v[88:91], v3 offset:60416
  ds_read_b128 v[92:95], v3 offset:61440
  ds_read_b128 v[96:99], v15 offset:2048
  ds_read_b128 v[100:103], v15 offset:3072
  ds_read_b128 v[104:107], v15 offset:4096
  ds_read_b128 v[108:111], v15 offset:5120
  ds_read_b128 v[112:115], v15 offset:6144
  s_waitcnt vmcnt(6)
  v_max3_u32 v250, v136, v137, v138
  v_max3_u32 v251, v139, v140, v141
  v_max3_u32 v250, v250, v142, v143
  v_max_u32 v250, v250, v251
  v_cmp_eq_u32 vcc, -1, v250
  s_cbranch_vccnz x1_0
x1_0_b:
  v_swap_b32 v138, v140
  v_swap_b32 v139, v141
  s_waitcnt lgkmcnt(5)
  s_nop 0
  v_mfma_f32_16x16x32_bf16 v[16:19], v[76:79], v[136:139], 0
  ds_read_b128 v[116:119], v15 offset:12288
  ds_read_b128 v[120:123], v15 offset:13312
  v_mfma_f32_16x16x32_bf16 v[36:39], v[76:79], v[140:143], 0
  ds_read_b128 v[124:127], v15 offset:14336
  v_mfma_f32_16x16x32_bf16 v[56:59], v[72:75], v[136:139], 0
  ds_read_b128 v[128:131], v15 offset:15360
  v_mfma_f32_16x16x32_bf16 v[64:67], v[136:139], v[136:139], 0
  ds_read_b128 v[132:135], v15 offset:16384
  v_mfma_f32_16x16x32_bf16 v[20:23], v[80:83], v[136:139], 0
  s_add_u32 s34, s30, 16384
  buffer_load_dwordx4 v[168:171], v1, s[4:7], s34 offen offset:0 sc1
  v_mfma_f32_16x16x32_bf16 v[40:43], v[80:83], v[140:143], 0
  buffer_load_dwordx4 v[172:175], v1, s[4:7], s34 offen offset:1024 sc1
  v_mfma_f32_16x16x32_bf16 v[60:63], v[72:75], v[140:143], 0
  s_add_u32 s34, s30, 20480
  v_mfma_f32_16x16x32_bf16 v[68:71], v[140:143], v[140:143], 0
  buffer_load_dwordx4 v[176:179], v1, s[4:7], s34 offen offset:0 sc1
  v_mfma_f32_16x16x32_bf16 v[24:27], v[84:87], v[136:139], 0
  buffer_load_dwordx4 v[180:183], v1, s[4:7], s34 offen offset:1024 sc1
  v_mfma_f32_16x16x32_bf16 v[44:47], v[84:87], v[140:143], 0
  s_waitcnt vmcnt(8)
  v_max3_u32 v250, v144, v145, v146
  v_max3_u32 v251, v147, v148, v149
  v_mfma_f32_16x16x32_bf16 v[28:31], v[88:91], v[136:139], 0
  v_max3_u32 v250, v250, v150, v151
  v_max_u32 v250, v250, v251
  v_mfma_f32_16x16x32_bf16 v[48:51], v[88:91], v[140:143], 0
  v_cmp_eq_u32 vcc, -1, v250
  v_mfma_f32_16x16x32_bf16 v[32:35], v[92:95], v[136:139], 0
  s_cbranch_vccnz x1_1
x1_1_b:
  v_swap_b32 v146, v148
  v_swap_b32 v147, v149
  v_mfma_f32_16x16x32_bf16 v[52:55], v[92:95], v[140:143], 0
  s_waitcnt lgkmcnt(5)
  v_mfma_f32_16x16x32_bf16 v[16:19], v[96:99], v[144:147], v[16:19]
  ds_read_b128 v[76:79], v15 offset:22528
  ds_read_b128 v[80:83], v15 offset:23552
  v_mfma_f32_16x16x32_bf16 v[36:39], v[96:99], v[148:151], v[36:39]
  ds_read_b128 v[84:87], v15 offset:24576
  v_mfma_f32_16x16x32_bf16 v[56:59], v[72:75], v[144:147], v[56:59]
  ds_read_b128 v[88:91], v15 offset:25600
  v_mfma_f32_16x16x32_bf16 v[64:67], v[144:147], v[144:147], v[64:67]
  ds_read_b128 v[92:95], v15 offset:26624
  s_add_u32 s34, s30, 24576
  v_mfma_f32_16x16x32_bf16 v[20:23], v[100:103], v[144:147], v[20:23]
  buffer_load_dwordx4 v[184:187], v1, s[4:7], s34 offen offset:0 sc1
  v_mfma_f32_16x16x32_bf16 v[40:43], v[100:103], v[148:151], v[40:43]
  buffer_load_dwordx4 v[188:191], v1, s[4:7], s34 offen offset:1024 sc1
  v_mfma_f32_16x16x32_bf16 v[60:63], v[72:75], v[148:151], v[60:63]
  s_add_u32 s34, s30, 28672
  buffer_load_dwordx4 v[192:195], v1, s[4:7], s34 offen offset:0 sc1
  v_mfma_f32_16x16x32_bf16 v[68:71], v[148:151], v[148:151], v[68:71]
  buffer_load_dwordx4 v[196:199], v1, s[4:7], s34 offen offset:1024 sc1
  v_mfma_f32_16x16x32_bf16 v[24:27], v[104:107], v[144:147], v[24:27]
  buffer_load_dword v13, v14, s[4:7], s33 offen sc1
  v_mfma_f32_16x16x32_bf16 v[44:47], v[104:107], v[148:151], v[44:47]
  s_waitcnt vmcnt(11)
  v_max3_u32 v250, v152, v153, v154
  v_max3_u32 v251, v155, v156, v157
  v_mfma_f32_16x16x32_bf16 v[28:31], v[108:111], v[144:147], v[28:31]
  v_max3_u32 v250, v250, v158, v159
  v_max_u32 v250, v250, v251
  v_mfma_f32_16x16x32_bf16 v[48:51], v[108:111], v[148:151], v[48:51]
  v_cmp_eq_u32 vcc, -1, v250
  v_mfma_f32_16x16x32_bf16 v[32:35], v[112:115], v[144:147], v[32:35]
  s_cbranch_vccnz x1_2
x1_2_b:
  v_swap_b32 v154, v156
  v_swap_b32 v155, v157
  v_mfma_f32_16x16x32_bf16 v[52:55], v[112:115], v[148:151], v[52:55]
  s_waitcnt lgkmcnt(5)
  v_mfma_f32_16x16x32_bf16 v[16:19], v[116:119], v[152:155], v[16:19]
  ds_read_b128 v[96:99], v2 offset:0
  ds_read_b128 v[100:103], v2 offset:1024
  v_mfma_f32_16x16x32_bf16 v[36:39], v[116:119], v[156:159], v[36:39]
  ds_read_b128 v[104:107], v2 offset:2048
  v_mfma_f32_16x16x32_bf16 v[56:59], v[72:75], v[152:155], v[56:59]
  ds_read_b128 v[108:111], v2 offset:3072
  v_mfma_f32_16x16x32_bf16 v[64:67], v[152:155], v[152:155], v[64:67]
  ds_read_b128 v[112:115], v2 offset:4096
  v_mfma_f32_16x16x32_bf16 v[20:23], v[120:123], v[152:155], v[20:23]
  s_add_u32 s34, s30, 32768
  buffer_load_dwordx4 v[200:203], v1, s[4:7], s34 offen offset:0 sc1
  v_mfma_f32_16x16x32_bf16 v[40:43], v[120:123], v[156:159], v[40:43]
  buffer_load_dwordx4 v[204:207], v1, s[4:7], s34 offen offset:1024 sc1
  v_mfma_f32_16x16x32_bf16 v[60:63], v[72:75], v[156:159], v[60:63]
  s_add_u32 s34, s30, 36864
  v_mfma_f32_16x16x32_bf16 v[68:71], v[156:159], v[156:159], v[68:71]
  buffer_load_dwordx4 v[208:211], v1, s[4:7], s34 offen offset:0 sc1
  v_mfma_f32_16x16x32_bf16 v[24:27], v[124:127], v[152:155], v[24:27]
  buffer_load_dwordx4 v[212:215], v1, s[4:7], s34 offen offset:1024 sc1
  v_mfma_f32_16x16x32_bf16 v[44:47], v[124:127], v[156:159], v[44:47]
  s_waitcnt vmcnt(13)
  v_max3_u32 v250, v160, v161, v162
  v_max3_u32 v251, v163, v164, v165
  v_mfma_f32_16x16x32_bf16 v[28:31], v[128:131], v[152:155], v[28:31]
  v_max3_u32 v250, v250, v166, v167
  v_max_u32 v250, v250, v251
  v_mfma_f32_16x16x32_bf16 v[48:51], v[128:131], v[156:159], v[48:51]
  v_cmp_eq_u32 vcc, -1, v250
  v_mfma_f32_16x16x32_bf16 v[32:35], v[132:135], v[152:155], v[32:35]
  s_cbranch_vccnz x1_3
x1_3_b:
  v_swap_b32 v162, v164
  v_swap_b32 v163, v165
  v_mfma_f32_16x16x32_bf16 v[52:55], v[132:135], v[156:159], v[52:55]
  s_waitcnt lgkmcnt(5)
  v_mfma_f32_16x16x32_bf16 v[16:19], v[76:79], v[160:163], v[16:19]
  ds_read_b128 v[116:119], v2 offset:10240
  v_mfma_f32_16x16x32_bf16 v[36:39], v[76:79], v[164:167], v[36:39]
  ds_read_b128 v[120:123], v2 offset:11264
  v_mfma_f32_16x16x32_bf16 v[56:59], v[72:75], v[160:163], v[56:59]
  v_mfma_f32_16x16x32_bf16 v[64:67], v[160:163], v[160:163], v[64:67]
  ds_read_b128 v[124:127], v2 offset:12288
  v_mfma_f32_16x16x32_bf16 v[20:23], v[80:83], v[160:163], v[20:23]
  v_mfma_f32_16x16x32_bf16 v[40:43], v[80:83], v[164:167], v[40:43]
  ds_read_b128 v[128:131], v2 offset:13312
  v_mfma_f32_16x16x32_bf16 v[60:63], v[72:75], v[164:167], v[60:63]
  v_mfma_f32_16x16x32_bf16 v[68:71], v[164:167], v[164:167], v[68:71]
  ds_read_b128 v[132:135], v2 offset:14336
  v_mfma_f32_16x16x32_bf16 v[24:27], v[84:87], v[160:163], v[24:27]
  v_mfma_f32_16x16x32_bf16 v[44:47], v[84:87], v[164:167], v[44:47]
  s_waitcnt vmcnt(11)
  v_max3_u32 v250, v168, v169, v170
  v_max3_u32 v251, v171, v172, v173
  v_mfma_f32_16x16x32_bf16 v[28:31], v[88:91], v[160:163], v[28:31]
  v_max3_u32 v250, v250, v174, v175
  v_max_u32 v250, v250, v251
  v_mfma_f32_16x16x32_bf16 v[48:51], v[88:91], v[164:167], v[48:51]
  v_cmp_eq_u32 vcc, -1, v250
  v_mfma_f32_16x16x32_bf16 v[32:35], v[92:95], v[160:163], v[32:35]
  s_cbranch_vccnz x1_4
x1_4_b:
  v_swap_b32 v170, v172
  v_swap_b32 v171, v173
  v_mfma_f32_16x16x32_bf16 v[52:55], v[92:95], v[164:167], v[52:55]
  s_waitcnt lgkmcnt(5)
  v_mfma_f32_16x16x32_bf16 v[16:19], v[96:99], v[168:171], v[16:19]
  ds_read_b128 v[76:79], v2 offset:20480
  ds_read_b128 v[80:83], v2 offset:21504
  v_mfma_f32_16x16x32_bf16 v[36:39], v[96:99], v[172:175], v[36:39]
  ds_read_b128 v[84:87], v2 offset:22528
  v_mfma_f32_16x16x32_bf16 v[56:59], v[72:75], v[168:171], v[56:59]
  ds_read_b128 v[88:91], v2 offset:23552
  v_mfma_f32_16x16x32_bf16 v[64:67], v[168:171], v[168:171], v[64:67]
  ds_read_b128 v[92:95], v2 offset:24576
  v_mfma_f32_16x16x32_bf16 v[20:23], v[100:103], v[168:171], v[20:23]
  s_waitcnt vmcnt(4)
  v_cmp_ne_u32 vcc, s60, v13
  s_cbranch_vccnz wfs
wfs_b:
  v_mfma_f32_16x16x32_bf16 v[40:43], v[100:103], v[172:175], v[40:43]
  s_mul_i32 s54, s25, 100
  v_mfma_f32_16x16x32_bf16 v[60:63], v[72:75], v[172:175], v[60:63]
  s_mul_i32 s55, s3, 15
  v_mfma_f32_16x16x32_bf16 v[68:71], v[172:175], v[172:175], v[68:71]
  s_add_u32 s54, s54, s55
  v_mfma_f32_16x16x32_bf16 v[24:27], v[104:107], v[168:171], v[24:27]
  s_add_u32 s55, s55, 60
  v_mfma_f32_16x16x32_bf16 v[44:47], v[104:107], v[172:175], v[44:47]
  s_waitcnt vmcnt(9)
  v_max3_u32 v250, v176, v177, v178
  v_max3_u32 v251, v179, v180, v181
  v_mfma_f32_16x16x32_bf16 v[28:31], v[108:111], v[168:171], v[28:31]
  v_max3_u32 v250, v250, v182, v183
  v_max_u32 v250, v250, v251
  v_mfma_f32_16x16x32_bf16 v[48:51], v[108:111], v[172:175], v[48:51]
  v_cmp_eq_u32 vcc, -1, v250
  v_mfma_f32_16x16x32_bf16 v[32:35], v[112:115], v[168:171], v[32:35]
  s_cbranch_vccnz x1_5
x1_5_b:
  v_swap_b32 v178, v180
  v_swap_b32 v179, v181
  v_mfma_f32_16x16x32_bf16 v[52:55], v[112:115], v[172:175], v[52:55]
  s_waitcnt lgkmcnt(5)
  v_mfma_f32_16x16x32_bf16 v[16:19], v[116:119], v[176:179], v[16:19]
  ds_read_b128 v[96:99], v2 offset:30720
  ds_read_b128 v[100:103], v2 offset:31744
  v_mfma_f32_16x16x32_bf16 v[36:39], v[116:119], v[180:183], v[36:39]
  ds_read_b128 v[104:107], v2 offset:32768
  v_mfma_f32_16x16x32_bf16 v[56:59], v[72:75], v[176:179], v[56:59]
  ds_read_b128 v[108:111], v2 offset:33792
  v_mfma_f32_16x16x32_bf16 v[64:67], v[176:179], v[176:179], v[64:67]
  ds_read_b128 v[112:115], v2 offset:34816
  v_mfma_f32_16x16x32_bf16 v[20:23], v[120:123], v[176:179], v[20:23]
  s_lshl_b32 s54, s54, 10
  v_mfma_f32_16x16x32_bf16 v[40:43], v[120:123], v[180:183], v[40:43]
  s_lshl_b32 m0, s55, 10
  v_mfma_f32_16x16x32_bf16 v[60:63], v[72:75], v[180:183], v[60:63]
  s_add_u32 s54, s54, 23068672
  v_mfma_f32_16x16x32_bf16 v[68:71], v[180:183], v[180:183], v[68:71]
  buffer_load_dwordx4 v1, s[4:7], s54 offen offset:0 sc1 lds
  v_mfma_f32_16x16x32_bf16 v[24:27], v[124:127], v[176:179], v[24:27]
  buffer_load_dwordx4 v1, s[4:7], s54 offen offset:1024 sc1 lds
  v_mfma_f32_16x16x32_bf16 v[44:47], v[124:127], v[180:183], v[44:47]
  s_waitcnt vmcnt(9)
  v_max3_u32 v250, v184, v185, v186
  v_max3_u32 v251, v187, v188, v189
  v_mfma_f32_16x16x32_bf16 v[28:31], v[128:131], v[176:179], v[28:31]
  v_max3_u32 v250, v250, v190, v191
  v_max_u32 v250, v250, v251
  v_mfma_f32_16x16x32_bf16 v[48:51], v[128:131], v[180:183], v[48:51]
  v_cmp_eq_u32 vcc, -1, v250
  v_mfma_f32_16x16x32_bf16 v[32:35], v[132:135], v[176:179], v[32:35]
  s_cbranch_vccnz x1_6
x1_6_b:
  v_swap_b32 v186, v188
  v_swap_b32 v187, v189
  v_mfma_f32_16x16x32_bf16 v[52:55], v[132:135], v[180:183], v[52:55]
  s_waitcnt lgkmcnt(5)
  v_mfma_f32_16x16x32_bf16 v[16:19], v[76:79], v[184:187], v[16:19]
  ds_read_b128 v[116:119], v2 offset:40960
  ds_read_b128 v[120:123], v2 offset:41984
  v_mfma_f32_16x16x32_bf16 v[36:39], v[76:79], v[188:191], v[36:39]
  ds_read_b128 v[124:127], v2 offset:43008
  v_mfma_f32_16x16x32_bf16 v[56:59], v[72:75], v[184:187], v[56:59]
  ds_read_b128 v[128:131], v2 offset:44032
  v_mfma_f32_16x16x32_bf16 v[64:67], v[184:187], v[184:187], v[64:67]
  ds_read_b128 v[132:135], v2 offset:45056
  v_mfma_f32_16x16x32_bf16 v[20:23], v[80:83], v[184:187], v[20:23]
  buffer_load_dwordx4 v1, s[4:7], s54 offen offset:2048 sc1 lds
  v_mfma_f32_16x16x32_bf16 v[40:43], v[80:83], v[188:191], v[40:43]
  buffer_load_dwordx4 v1, s[4:7], s54 offen offset:3072 sc1 lds
  v_mfma_f32_16x16x32_bf16 v[60:63], v[72:75], v[188:191], v[60:63]
  s_add_u32 m0, m0, 4096
  v_mfma_f32_16x16x32_bf16 v[68:71], v[188:191], v[188:191], v[68:71]
  s_add_u32 s54, s54, 4096
  v_mfma_f32_16x16x32_bf16 v[24:27], v[84:87], v[184:187], v[24:27]
  buffer_load_dwordx4 v1, s[4:7], s54 offen offset:0 sc1 lds
  v_mfma_f32_16x16x32_bf16 v[44:47], v[84:87], v[188:191], v[44:47]
  s_waitcnt vmcnt(10)
  v_max3_u32 v250, v192, v193, v194
  v_max3_u32 v251, v195, v196, v197
  v_mfma_f32_16x16x32_bf16 v[28:31], v[88:91], v[184:187], v[28:31]
  v_max3_u32 v250, v250, v198, v199
  v_max_u32 v250, v250, v251
  v_mfma_f32_16x16x32_bf16 v[48:51], v[88:91], v[188:191], v[48:51]
  v_cmp_eq_u32 vcc, -1, v250
  v_mfma_f32_16x16x32_bf16 v[32:35], v[92:95], v[184:187], v[32:35]
  s_cbranch_vccnz x1_7
x1_7_b:
  v_swap_b32 v194, v196
  v_swap_b32 v195, v197
  v_mfma_f32_16x16x32_bf16 v[52:55], v[92:95], v[188:191], v[52:55]
  s_waitcnt lgkmcnt(5)
  v_mfma_f32_16x16x32_bf16 v[16:19], v[96:99], v[192:195], v[16:19]
  ds_read_b128 v[76:79], v2 offset:51200
  v_mfma_f32_16x16x32_bf16 v[36:39], v[96:99], v[196:199], v[36:39]
  ds_read_b128 v[80:83], v2 offset:52224
  v_mfma_f32_16x16x32_bf16 v[56:59], v[72:75], v[192:195], v[56:59]
  ds_read_b128 v[84:87], v2 offset:53248
  v_mfma_f32_16x16x32_bf16 v[64:67], v[192:195], v[192:195], v[64:67]
  ds_read_b128 v[88:91], v2 offset:54272
  v_mfma_f32_16x16x32_bf16 v[20:23], v[100:103], v[192:195], v[20:23]
  ds_read_b128 v[92:95], v2 offset:55296
  v_mfma_f32_16x16x32_bf16 v[40:43], v[100:103], v[196:199], v[40:43]
  buffer_load_dwordx4 v1, s[4:7], s54 offen offset:1024 sc1 lds
  v_mfma_f32_16x16x32_bf16 v[60:63], v[72:75], v[196:199], v[60:63]
  buffer_load_dwordx4 v1, s[4:7], s54 offen offset:2048 sc1 lds
  v_mfma_f32_16x16x32_bf16 v[68:71], v[196:199], v[196:199], v[68:71]
  buffer_load_dwordx4 v1, s[4:7], s54 offen offset:3072 sc1 lds
  v_mfma_f32_16x16x32_bf16 v[24:27], v[104:107], v[192:195], v[24:27]
  s_add_u32 m0, m0, 4096
  v_mfma_f32_16x16x32_bf16 v[44:47], v[104:107], v[196:199], v[44:47]
  s_waitcnt vmcnt(10)
  v_max3_u32 v250, v200, v201, v202
  v_max3_u32 v251, v203, v204, v205
  v_mfma_f32_16x16x32_bf16 v[28:31], v[108:111], v[192:195], v[28:31]
  v_max3_u32 v250, v250, v206, v207
  v_max_u32 v250, v250, v251
  v_mfma_f32_16x16x32_bf16 v[48:51], v[108:111], v[196:199], v[48:51]
  v_cmp_eq_u32 vcc, -1, v250
  v_mfma_f32_16x16x32_bf16 v[32:35], v[112:115], v[192:195], v[32:35]
  s_cbranch_vccnz x1_8
x1_8_b:
  v_swap_b32 v202, v204
  v_swap_b32 v203, v205
  v_mfma_f32_16x16x32_bf16 v[52:55], v[112:115], v[196:199], v[52:55]
  s_waitcnt lgkmcnt(5)
  v_mfma_f32_16x16x32_bf16 v[16:19], v[116:119], v[200:203], v[16:19]
  s_add_u32 s54, s54, 4096
  v_mfma_f32_16x16x32_bf16 v[36:39], v[116:119], v[204:207], v[36:39]
  buffer_load_dwordx4 v1, s[4:7], s54 offen offset:0 sc1 lds
  v_mfma_f32_16x16x32_bf16 v[56:59], v[72:75], v[200:203], v[56:59]
  v_mfma_f32_16x16x32_bf16 v[64:67], v[200:203], v[200:203], v[64:67]
  buffer_load_dwordx4 v1, s[4:7], s54 offen offset:1024 sc1 lds
  v_mfma_f32_16x16x32_bf16 v[20:23], v[120:123], v[200:203], v[20:23]
  v_mfma_f32_16x16x32_bf16 v[40:43], v[120:123], v[204:207], v[40:43]
  buffer_load_dwordx4 v1, s[4:7], s54 offen offset:2048 sc1 lds
  v_mfma_f32_16x16x32_bf16 v[60:63], v[72:75], v[204:207], v[60:63]
  v_mfma_f32_16x16x32_bf16 v[68:71], v[204:207], v[204:207], v[68:71]
  buffer_load_dwordx4 v1, s[4:7], s54 offen offset:3072 sc1 lds
  v_mfma_f32_16x16x32_bf16 v[24:27], v[124:127], v[200:203], v[24:27]
  v_mfma_f32_16x16x32_bf16 v[44:47], v[124:127], v[204:207], v[44:47]
  s_waitcnt vmcnt(12)
  v_max3_u32 v250, v208, v209, v210
  v_max3_u32 v251, v211, v212, v213
  v_mfma_f32_16x16x32_bf16 v[28:31], v[128:131], v[200:203], v[28:31]
  v_max3_u32 v250, v250, v214, v215
  v_max_u32 v250, v250, v251
  v_mfma_f32_16x16x32_bf16 v[48:51], v[128:131], v[204:207], v[48:51]
  v_cmp_eq_u32 vcc, -1, v250
  v_mfma_f32_16x16x32_bf16 v[32:35], v[132:135], v[200:203], v[32:35]
  s_cbranch_vccnz x1_9
x1_9_b:
  v_swap_b32 v210, v212
  v_swap_b32 v211, v213
  v_mfma_f32_16x16x32_bf16 v[52:55], v[132:135], v[204:207], v[52:55]
  s_waitcnt lgkmcnt(0)
  v_mfma_f32_16x16x32_bf16 v[16:19], v[76:79], v[208:211], v[16:19]
  s_add_u32 m0, m0, 4096
  v_mfma_f32_16x16x32_bf16 v[36:39], v[76:79], v[212:215], v[36:39]
  v_mfma_f32_16x16x32_bf16 v[56:59], v[72:75], v[208:211], v[56:59]
  s_add_u32 s54, s54, 4096
  v_mfma_f32_16x16x32_bf16 v[64:67], v[208:211], v[208:211], v[64:67]
  v_mfma_f32_16x16x32_bf16 v[20:23], v[80:83], v[208:211], v[20:23]
  v_mfma_f32_16x16x32_bf16 v[40:43], v[80:83], v[212:215], v[40:43]
  buffer_load_dwordx4 v1, s[4:7], s54 offen offset:0 sc1 lds
  v_mfma_f32_16x16x32_bf16 v[60:63], v[72:75], v[212:215], v[60:63]
  v_mfma_f32_16x16x32_bf16 v[68:71], v[212:215], v[212:215], v[68:71]
  v_mfma_f32_16x16x32_bf16 v[24:27], v[84:87], v[208:211], v[24:27]
  buffer_load_dwordx4 v1, s[4:7], s54 offen offset:1024 sc1 lds
  v_mfma_f32_16x16x32_bf16 v[44:47], v[84:87], v[212:215], v[44:47]
  v_mfma_f32_16x16x32_bf16 v[28:31], v[88:91], v[208:211], v[28:31]
  v_mfma_f32_16x16x32_bf16 v[48:51], v[88:91], v[212:215], v[48:51]
  buffer_load_dwordx4 v1, s[4:7], s54 offen offset:2048 sc1 lds
  v_mfma_f32_16x16x32_bf16 v[32:35], v[92:95], v[208:211], v[32:35]
  v_mfma_f32_16x16x32_bf16 v[52:55], v[92:95], v[212:215], v[52:55]
  s_barrier
  buffer_load_dwordx2 v[216:217], v4, s[4:7], s31 offen offset:0 sc1
  buffer_load_dwordx2 v[218:219], v4, s[4:7], s31 offen offset:1024 sc1
  buffer_load_dwordx2 v[220:221], v4, s[4:7], s31 offen offset:2048 sc1
  buffer_load_dwordx2 v[222:223], v4, s[4:7], s31 offen offset:3072 sc1
  buffer_load_dwordx2 v[224:225], v4, s[4:7], s32 offen offset:0 sc1
  ds_write_b128 v7, v[64:67]
  ds_write_b128 v7, v[68:71] offset:1024
  ds_write2st64_b32 v8, v56, v60 offset0:0 offset1:1
  s_cmp_lg_u32 s51, 0
  s_cbranch_scc1 x1_odd
  ds_write_b128 v5, v[36:39] offset:0
  ds_write_b128 v5, v[40:43] offset:1024
  ds_write_b128 v5, v[44:47] offset:2048
  ds_write_b128 v5, v[48:51] offset:3072
  ds_write_b128 v5, v[52:55] offset:4096
  s_waitcnt lgkmcnt(0)
  s_barrier
  ds_read2st64_b32 v[8:9], v9 offset0:0 offset1:2
  ds_read2st64_b32 v[10:11], v10 offset0:0 offset1:8
  ds_read_b128 v[76:79], v6 offset:0
  ds_read_b128 v[80:83], v6 offset:1024
  ds_read_b128 v[84:87], v6 offset:2048
  ds_read_b128 v[88:91], v6 offset:3072
  ds_read_b128 v[92:95], v6 offset:4096
  s_waitcnt lgkmcnt(4)
  v_pk_add_f32 v[16:17], v[16:17], v[76:77]
  v_pk_add_f32 v[18:19], v[18:19], v[78:79]
  s_waitcnt lgkmcnt(3)
  v_pk_add_f32 v[20:21], v[20:21], v[80:81]
  v_pk_add_f32 v[22:23], v[22:23], v[82:83]
  s_waitcnt lgkmcnt(2)
  v_pk_add_f32 v[24:25], v[24:25], v[84:85]
  v_pk_add_f32 v[26:27], v[26:27], v[86:87]
  s_waitcnt lgkmcnt(1)
  v_pk_add_f32 v[28:29], v[28:29], v[88:89]
  v_pk_add_f32 v[30:31], v[30:31], v[90:91]
  s_waitcnt lgkmcnt(0)
  v_pk_add_f32 v[32:33], v[32:33], v[92:93]
  v_pk_add_f32 v[34:35], v[34:35], v[94:95]
  s_branch x1_join
x1_odd:
  ds_write_b128 v5, v[16:19] offset:0
  ds_write_b128 v5, v[20:23] offset:1024
  ds_write_b128 v5, v[24:27] offset:2048
  ds_write_b128 v5, v[28:31] offset:3072
  ds_write_b128 v5, v[32:35] offset:4096
  s_waitcnt lgkmcnt(0)
  s_barrier
  ds_read2st64_b32 v[8:9], v9 offset0:0 offset1:2
  ds_read2st64_b32 v[10:11], v10 offset0:0 offset1:8
  ds_read_b128 v[76:79], v6 offset:0
  ds_read_b128 v[80:83], v6 offset:1024
  ds_read_b128 v[84:87], v6 offset:2048
  ds_read_b128 v[88:91], v6 offset:3072
  ds_read_b128 v[92:95], v6 offset:4096
  s_waitcnt lgkmcnt(4)
  v_pk_add_f32 v[16:17], v[36:37], v[76:77]
  v_pk_add_f32 v[18:19], v[38:39], v[78:79]
  s_waitcnt lgkmcnt(3)
  v_pk_add_f32 v[20:21], v[40:41], v[80:81]
  v_pk_add_f32 v[22:23], v[42:43], v[82:83]
  s_waitcnt lgkmcnt(2)
  v_pk_add_f32 v[24:25], v[44:45], v[84:85]
  v_pk_add_f32 v[26:27], v[46:47], v[86:87]
  s_waitcnt lgkmcnt(1)
  v_pk_add_f32 v[28:29], v[48:49], v[88:89]
  v_pk_add_f32 v[30:31], v[50:51], v[90:91]
  s_waitcnt lgkmcnt(0)
  v_pk_add_f32 v[32:33], v[52:53], v[92:93]
  v_pk_add_f32 v[34:35], v[54:55], v[94:95]
x1_join:
  v_add_f32 v8, v8, v9
  v_add_f32 v10, v10, v11
  v_mul_f32 v8, 0x3acccccd, v8
  v_mov_b32 v13, 0x3acccccd
  s_mul_i32 s54, s25, 100
  v_mul_f32 v9, v8, v8
  v_mov_b32 v56, 0xc0135761
  v_fma_f32 v10, v10, v13, -v9
  v_mov_b32 v13, 0x3727c5ac
  s_mul_i32 s55, s3, 10
  v_max_f32 v10, 0, v10
  v_mov_b32 v57, 0xbdd2d3e8
  v_add_f32 v11, 0x3727c5ac, v10
  v_mov_b32 v58, 1.0
  s_add_u32 s54, s54, s55
  v_rsq_f32 v12, v11
  s_nop 0
  v_mul_f32 v11, v12, v12
  v_fma_f32 v11, v11, v10, v13
  v_mul_f32 v13, -v8, v12
  s_add_u32 s55, s55, 120
  v_rsq_f32 v11, v11
  s_nop 0
  v_mul_f32 v10, v12, v11
  v_mul_f32 v11, v13, v11
  v_pk_mul_f32 v[228:229], v[228:229], v[10:11] op_sel:[0,1] op_sel_hi:[1,1]
  s_lshl_b32 s54, s54, 10
  v_pk_mul_f32 v[230:231], v[230:231], v[10:11] op_sel:[0,1] op_sel_hi:[1,1]
  v_pk_mul_f32 v[232:233], v[232:233], v[10:11] op_sel:[0,1] op_sel_hi:[1,1]
  v_pk_mul_f32 v[234:235], v[234:235], v[10:11] op_sel:[0,1] op_sel_hi:[1,1]
  v_pk_mul_f32 v[236:237], v[236:237], v[10:11] op_sel:[0,1] op_sel_hi:[1,1]
  s_lshl_b32 m0, s55, 10
  v_pk_mul_f32 v[238:239], v[238:239], v[10:11] op_sel:[0,1] op_sel_hi:[1,1]
  v_pk_mul_f32 v[240:241], v[240:241], v[10:11] op_sel:[0,1] op_sel_hi:[1,1]
  v_pk_mul_f32 v[242:243], v[242:243], v[10:11] op_sel:[0,1] op_sel_hi:[1,1]
  v_pk_mul_f32 v[244:245], v[244:245], v[10:11] op_sel:[0,1] op_sel_hi:[1,1]
  s_add_u32 s54, s54, 23130112
  v_pk_mul_f32 v[246:247], v[246:247], v[10:11] op_sel:[0,1] op_sel_hi:[1,1]
  v_pk_fma_f32 v[16:17], v[16:17], v[10:11], v[228:229] op_sel_hi:[1,0,1]
  v_pk_fma_f32 v[18:19], v[18:19], v[10:11], v[230:231] op_sel_hi:[1,0,1]
  v_pk_fma_f32 v[20:21], v[20:21], v[10:11], v[232:233] op_sel_hi:[1,0,1]
  buffer_load_dwordx4 v1, s[4:7], s54 offen offset:0 sc1 lds
  v_pk_fma_f32 v[22:23], v[22:23], v[10:11], v[234:235] op_sel_hi:[1,0,1]
  v_pk_fma_f32 v[24:25], v[24:25], v[10:11], v[236:237] op_sel_hi:[1,0,1]
  v_pk_fma_f32 v[26:27], v[26:27], v[10:11], v[238:239] op_sel_hi:[1,0,1]
  v_pk_fma_f32 v[28:29], v[28:29], v[10:11], v[240:241] op_sel_hi:[1,0,1]
  buffer_load_dwordx4 v1, s[4:7], s54 offen offset:1024 sc1 lds
  v_pk_fma_f32 v[30:31], v[30:31], v[10:11], v[242:243] op_sel_hi:[1,0,1]
  v_pk_fma_f32 v[32:33], v[32:33], v[10:11], v[244:245] op_sel_hi:[1,0,1]
  v_pk_fma_f32 v[34:35], v[34:35], v[10:11], v[246:247] op_sel_hi:[1,0,1]
  v_pk_mul_f32 v[136:137], v[16:17], v[16:17]
  buffer_load_dwordx4 v1, s[4:7], s54 offen offset:2048 sc1 lds
  v_pk_mul_f32 v[138:139], v[18:19], v[18:19]
  v_pk_mul_f32 v[140:141], v[20:21], v[20:21]
  v_pk_mul_f32 v[142:143], v[22:23], v[22:23]
  v_pk_mul_f32 v[144:145], v[24:25], v[24:25]
  buffer_load_dwordx4 v1, s[4:7], s54 offen offset:3072 sc1 lds
  v_pk_mul_f32 v[146:147], v[26:27], v[26:27]
  v_pk_mul_f32 v[148:149], v[28:29], v[28:29]
  v_pk_mul_f32 v[150:151], v[30:31], v[30:31]
  v_pk_mul_f32 v[152:153], v[32:33], v[32:33]
  s_add_u32 m0, m0, 4096
  v_pk_mul_f32 v[154:155], v[34:35], v[34:35]
  v_pk_fma_f32 v[136:137], v[136:137], v[56:57], v[56:57] op_sel:[0,1,0] op_sel_hi:[1,1,0]
  v_pk_fma_f32 v[138:139], v[138:139], v[56:57], v[56:57] op_sel:[0,1,0] op_sel_hi:[1,1,0]
  v_pk_fma_f32 v[140:141], v[140:141], v[56:57], v[56:57] op_sel:[0,1,0] op_sel_hi:[1,1,0]
  s_add_u32 s54, s54, 4096
  v_pk_fma_f32 v[142:143], v[142:143], v[56:57], v[56:57] op_sel:[0,1,0] op_sel_hi:[1,1,0]
  v_pk_fma_f32 v[144:145], v[144:145], v[56:57], v[56:57] op_sel:[0,1,0] op_sel_hi:[1,1,0]
  v_pk_fma_f32 v[146:147], v[146:147], v[56:57], v[56:57] op_sel:[0,1,0] op_sel_hi:[1,1,0]
  v_pk_fma_f32 v[148:149], v[148:149], v[56:57], v[56:57] op_sel:[0,1,0] op_sel_hi:[1,1,0]
  buffer_load_dwordx4 v1, s[4:7], s54 offen offset:0 sc1 lds
  v_pk_fma_f32 v[150:151], v[150:151], v[56:57], v[56:57] op_sel:[0,1,0] op_sel_hi:[1,1,0]
  v_pk_fma_f32 v[152:153], v[152:153], v[56:57], v[56:57] op_sel:[0,1,0] op_sel_hi:[1,1,0]
  v_pk_fma_f32 v[154:155], v[154:155], v[56:57], v[56:57] op_sel:[0,1,0] op_sel_hi:[1,1,0]
  v_pk_mul_f32 v[136:137], v[136:137], v[16:17]
  buffer_load_dwordx4 v1, s[4:7], s54 offen offset:1024 sc1 lds
  v_pk_mul_f32 v[138:139], v[138:139], v[18:19]
  v_pk_mul_f32 v[140:141], v[140:141], v[20:21]
  v_pk_mul_f32 v[142:143], v[142:143], v[22:23]
  v_pk_mul_f32 v[144:145], v[144:145], v[24:25]
  buffer_load_dwordx4 v1, s[4:7], s54 offen offset:2048 sc1 lds
  v_pk_mul_f32 v[146:147], v[146:147], v[26:27]
  v_pk_mul_f32 v[148:149], v[148:149], v[28:29]
  v_pk_mul_f32 v[150:151], v[150:151], v[30:31]
  v_pk_mul_f32 v[152:153], v[152:153], v[32:33]
  buffer_load_dwordx4 v1, s[4:7], s54 offen offset:3072 sc1 lds
  v_pk_mul_f32 v[154:155], v[154:155], v[34:35]
  v_exp_f32 v136, v136
  v_exp_f32 v137, v137
  v_exp_f32 v138, v138
  s_add_u32 m0, m0, 4096
  v_exp_f32 v139, v139
  v_exp_f32 v140, v140
  v_exp_f32 v141, v141
  v_exp_f32 v142, v142
  s_add_u32 s54, s54, 4096
  v_exp_f32 v143, v143
  v_exp_f32 v144, v144
  v_exp_f32 v145, v145
  v_exp_f32 v146, v146
  buffer_load_dwordx4 v1, s[4:7], s54 offen offset:0 sc1 lds
  v_exp_f32 v147, v147
  v_exp_f32 v148, v148
  v_exp_f32 v149, v149
  buffer_load_dwordx4 v1, s[4:7], s54 offen offset:1024 sc1 lds
  v_exp_f32 v150, v150
  v_exp_f32 v151, v151
  v_exp_f32 v152, v152
  v_exp_f32 v153, v153
  v_exp_f32 v154, v154
  v_exp_f32 v155, v155
  v_pk_add_f32 v[136:137], v[136:137], v[58:59] op_sel_hi:[1,0]
  v_pk_add_f32 v[138:139], v[138:139], v[58:59] op_sel_hi:[1,0]
  v_pk_add_f32 v[140:141], v[140:141], v[58:59] op_sel_hi:[1,0]
  v_pk_add_f32 v[142:143], v[142:143], v[58:59] op_sel_hi:[1,0]
  v_pk_add_f32 v[144:145], v[144:145], v[58:59] op_sel_hi:[1,0]
  v_pk_add_f32 v[146:147], v[146:147], v[58:59] op_sel_hi:[1,0]
  v_pk_add_f32 v[148:149], v[148:149], v[58:59] op_sel_hi:[1,0]
  v_pk_add_f32 v[150:151], v[150:151], v[58:59] op_sel_hi:[1,0]
  v_pk_add_f32 v[152:153], v[152:153], v[58:59] op_sel_hi:[1,0]
  v_pk_add_f32 v[154:155], v[154:155], v[58:59] op_sel_hi:[1,0]
  v_rcp_f32 v136, v136
  v_rcp_f32 v137, v137
  v_rcp_f32 v138, v138
  v_rcp_f32 v139, v139
  v_rcp_f32 v140, v140
  v_rcp_f32 v141, v141
  v_rcp_f32 v142, v142
  v_rcp_f32 v143, v143
  v_rcp_f32 v144, v144
  v_rcp_f32 v145, v145
  v_rcp_f32 v146, v146
  v_rcp_f32 v147, v147
  v_rcp_f32 v148, v148
  v_rcp_f32 v149, v149
  v_rcp_f32 v150, v150
  v_rcp_f32 v151, v151
  v_rcp_f32 v152, v152
  v_rcp_f32 v153, v153
  v_rcp_f32 v154, v154
  v_rcp_f32 v155, v155
  v_pk_mul_f32 v[16:17], v[16:17], v[136:137]
  v_pk_mul_f32 v[18:19], v[18:19], v[138:139]
  v_pk_mul_f32 v[20:21], v[20:21], v[140:141]
  v_pk_mul_f32 v[22:23], v[22:23], v[142:143]
  v_pk_mul_f32 v[24:25], v[24:25], v[144:145]
  v_pk_mul_f32 v[26:27], v[26:27], v[146:147]
  v_pk_mul_f32 v[28:29], v[28:29], v[148:149]
  v_pk_mul_f32 v[30:31], v[30:31], v[150:151]
  v_pk_mul_f32 v[32:33], v[32:33], v[152:153]
  v_pk_mul_f32 v[34:35], v[34:35], v[154:155]
  v_cvt_pk_bf16_f32 v60, v16, v17
  v_cvt_pk_bf16_f32 v61, v18, v19
  v_cvt_pk_bf16_f32 v62, v20, v21
  v_cvt_pk_bf16_f32 v63, v22, v23
  v_cvt_pk_bf16_f32 v64, v24, v25
  v_cvt_pk_bf16_f32 v65, v26, v27
  v_cvt_pk_bf16_f32 v66, v28, v29
  v_cvt_pk_bf16_f32 v67, v30, v31
  v_cvt_pk_bf16_f32 v68, v32, v33
  v_cvt_pk_bf16_f32 v69, v34, v35
  s_mul_i32 s28, s24, 20480
  s_add_u32 s28, s28, 7864320
  s_lshl_b32 s29, s25, 11
  s_add_u32 s29, s29, s28
  buffer_store_dwordx4 v[60:63], v1, s[4:7], s29 offen sc1
  buffer_store_dwordx4 v[64:67], v1, s[4:7], s29 offen offset:1024 sc1
  v_permlane32_swap_b32 v68, v70
  v_permlane32_swap_b32 v69, v71
  s_lshl_b32 s29, s25, 9
  s_add_u32 s29, s29, s28
  s_add_u32 s29, s29, 16384
  s_mov_b32 exec_hi, 0
  buffer_store_dwordx4 v[68:71], v1, s[4:7], s29 offen sc1
  s_mov_b32 exec_hi, -1
  s_or_b32 s29, s2, s3
  s_cmp_lg_u32 s29, 0
  s_cbranch_scc1 noep
  v_mov_b32 v252, s60
  v_mov_b32 v253, 0
  s_mov_b32 s56, 28901376
  s_mov_b64 exec, 1
  buffer_store_dword v252, v253, s[4:7], s56 offen sc1
  s_mov_b64 exec, -1
noep:
  v_and_b32 v9, 15, v0
  v_lshlrev_b32 v9, 1, v9
  v_and_b32 v10, 48, v0
  v_lshlrev_b32 v10, 4, v10
  s_movk_i32 s32, 0x800
  v_bfrev_b32 v56, 1
  s_mov_b32 s33, 0xffff0000
  s_lshr_b32 s29, s24, 1
  s_lshl_b32 s29, s29, 5
  s_lshl_b32 s30, s51, 1
  s_sub_u32 s28, s29, 1
  v_add_u32 v11, s28, v9
  v_cmp_gt_u32 vcc, s32, v11
  v_lshrrev_b32 v57, 5, v11
  v_and_b32 v58, 1, v11
  v_lshl_add_u32 v57, v57, 1, v58
  v_mul_u32_u24 v57, 20480, v57
  v_bfe_u32 v11, v11, 1, 4
  v_lshl_add_u32 v57, v11, 4, v57
  v_add_u32 v57, v57, v10
  v_cndmask_b32 v5, v56, v57, vcc
  s_sub_u32 s28, s29, s30
  v_add_u32 v11, s28, v9
  v_cmp_gt_u32 vcc, s32, v11
  v_lshrrev_b32 v57, 5, v11
  v_and_b32 v58, 1, v11
  v_lshl_add_u32 v57, v57, 1, v58
  v_mul_u32_u24 v57, 20480, v57
  v_bfe_u32 v11, v11, 1, 4
  v_lshl_add_u32 v57, v11, 4, v57
  v_add_u32 v57, v57, v10
  v_cndmask_b32 v6, v56, v57, vcc
  s_add_u32 s28, s29, s30
  s_add_u32 s28, s28, 1
  v_add_u32 v11, s28, v9
  v_cmp_gt_u32 vcc, s32, v11
  v_lshrrev_b32 v57, 5, v11
  v_and_b32 v58, 1, v11
  v_lshl_add_u32 v57, v57, 1, v58
  v_mul_u32_u24 v57, 20480, v57
  v_bfe_u32 v11, v11, 1, 4
  v_lshl_add_u32 v57, v11, 4, v57
  v_add_u32 v57, v57, v10
  v_cndmask_b32 v7, v56, v57, vcc
  s_add_u32 s28, s29, 2
  v_add_u32 v11, s28, v9
  v_cmp_gt_u32 vcc, s32, v11
  v_lshrrev_b32 v57, 5, v11
  v_and_b32 v58, 1, v11
  v_lshl_add_u32 v57, v57, 1, v58
  v_mul_u32_u24 v57, 20480, v57
  v_bfe_u32 v11, v11, 1, 4
  v_lshl_add_u32 v57, v11, 4, v57
  v_add_u32 v57, v57, v10
  v_cndmask_b32 v8, v56, v57, vcc
  s_waitcnt vmcnt(17)
  v_lshlrev_b32 v228, 16, v216
  v_and_b32 v229, s33, v216
  v_pk_fma_f32 v[16:17], v[228:229], v[12:13], v[12:13] op_sel:[0,0,1] op_sel_hi:[1,0,1]
  v_lshlrev_b32 v230, 16, v217
  v_and_b32 v231, s33, v217
  v_pk_fma_f32 v[18:19], v[230:231], v[12:13], v[12:13] op_sel:[0,0,1] op_sel_hi:[1,0,1]
  s_waitcnt vmcnt(16)
  v_lshlrev_b32 v232, 16, v218
  v_and_b32 v233, s33, v218
  v_pk_fma_f32 v[20:21], v[232:233], v[12:13], v[12:13] op_sel:[0,0,1] op_sel_hi:[1,0,1]
  v_lshlrev_b32 v234, 16, v219
  v_and_b32 v235, s33, v219
  v_pk_fma_f32 v[22:23], v[234:235], v[12:13], v[12:13] op_sel:[0,0,1] op_sel_hi:[1,0,1]
  s_waitcnt vmcnt(15)
  v_lshlrev_b32 v236, 16, v220
  v_and_b32 v237, s33, v220
  v_pk_fma_f32 v[24:25], v[236:237], v[12:13], v[12:13] op_sel:[0,0,1] op_sel_hi:[1,0,1]
  v_lshlrev_b32 v238, 16, v221
  v_and_b32 v239, s33, v221
  v_pk_fma_f32 v[26:27], v[238:239], v[12:13], v[12:13] op_sel:[0,0,1] op_sel_hi:[1,0,1]
  s_waitcnt vmcnt(14)
  v_lshlrev_b32 v240, 16, v222
  v_and_b32 v241, s33, v222
  v_pk_fma_f32 v[28:29], v[240:241], v[12:13], v[12:13] op_sel:[0,0,1] op_sel_hi:[1,0,1]
  v_lshlrev_b32 v242, 16, v223
  v_and_b32 v243, s33, v223
  v_pk_fma_f32 v[30:31], v[242:243], v[12:13], v[12:13] op_sel:[0,0,1] op_sel_hi:[1,0,1]
  s_waitcnt vmcnt(13)
  v_lshlrev_b32 v244, 16, v224
  v_and_b32 v245, s33, v224
  v_pk_fma_f32 v[32:33], v[244:245], v[12:13], v[12:13] op_sel:[0,0,1] op_sel_hi:[1,0,1]
  v_lshlrev_b32 v246, 16, v225
  v_and_b32 v247, s33, v225
  v_pk_fma_f32 v[34:35], v[246:247], v[12:13], v[12:13] op_sel:[0,0,1] op_sel_hi:[1,0,1]
  s_mul_i32 s28, s3, 5120
  s_xor_b32 s29, s3, 1
  s_mul_i32 s29, s29, 5120
  s_add_u32 s28, s28, 122880
  s_add_u32 s29, s29, 122880
  v_add_u32 v9, s28, v1
  v_add_u32 v10, s29, v1
  s_lshl_b32 s30, s51, 13
  s_add_u32 s30, s30, 7864320
  s_lshl_b32 s31, s51, 11
  s_add_u32 s31, s31, 7880704
  s_waitcnt vmcnt(0)
  s_mov_b32 s34, s30
  s_mov_b32 s35, s31
  buffer_load_dwordx4 v[136:139], v5, s[4:7], s34 offen offset:0 sc1
  buffer_load_dwordx4 v[140:143], v6, s[4:7], s34 offen offset:0 sc1
  buffer_load_dwordx4 v[144:147], v5, s[4:7], s34 offen offset:1024 sc1
  buffer_load_dwordx4 v[148:151], v6, s[4:7], s34 offen offset:1024 sc1
  buffer_load_dwordx4 v[152:155], v5, s[4:7], s34 offen offset:2048 sc1
  buffer_load_dwordx4 v[156:159], v6, s[4:7], s34 offen offset:2048 sc1
  buffer_load_dwordx4 v[160:163], v5, s[4:7], s34 offen offset:3072 sc1
  buffer_load_dwordx4 v[164:167], v6, s[4:7], s34 offen offset:3072 sc1
  s_waitcnt vmcnt(8)
  s_barrier
  ds_read_b128 v[76:79], v2 offset:61440
  ds_read_b128 v[80:83], v2 offset:62464
  ds_read_b128 v[84:87], v2 offset:63488
  ds_read_b128 v[88:91], v2 offset:64512
  ds_read_b128 v[92:95], v3 offset:0
  ds_read_b128 v[96:99], v3 offset:6144
  ds_read_b128 v[100:103], v3 offset:7168
  ds_read_b128 v[104:107], v3 offset:8192
  ds_read_b128 v[108:111], v3 offset:9216
  ds_read_b128 v[112:115], v3 offset:10240
  s_waitcnt vmcnt(6)
  v_max3_u32 v250, v136, v137, v138
  v_max3_u32 v251, v139, v140, v141
  v_max3_u32 v250, v250, v142, v143
  v_max_u32 v250, v250, v251
  v_cmp_eq_u32 vcc, -1, v250
  s_cbranch_vccnz x2_0
x2_0_b:
  s_waitcnt lgkmcnt(5)
  v_mfma_f32_16x16x32_bf16 v[16:19], v[76:79], v[136:139], v[16:19]
  ds_read_b128 v[116:119], v3 offset:16384
  ds_read_b128 v[120:123], v3 offset:17408
  v_mfma_f32_16x16x32_bf16 v[36:39], v[76:79], v[140:143], 0
  ds_read_b128 v[124:127], v3 offset:18432
  ds_read_b128 v[128:131], v3 offset:19456
  v_mfma_f32_16x16x32_bf16 v[20:23], v[80:83], v[136:139], v[20:23]
  ds_read_b128 v[132:135], v3 offset:20480
  v_mfma_f32_16x16x32_bf16 v[40:43], v[80:83], v[140:143], 0
  s_add_u32 s34, s30, 4096
  buffer_load_dwordx4 v[168:171], v7, s[4:7], s34 offen offset:0 sc1
  v_mfma_f32_16x16x32_bf16 v[24:27], v[84:87], v[136:139], v[24:27]
  buffer_load_dwordx4 v[172:175], v8, s[4:7], s34 offen offset:0 sc1
  buffer_load_dwordx4 v[176:179], v7, s[4:7], s34 offen offset:1024 sc1
  v_mfma_f32_16x16x32_bf16 v[44:47], v[84:87], v[140:143], 0
  buffer_load_dwordx4 v[180:183], v8, s[4:7], s34 offen offset:1024 sc1
  v_mfma_f32_16x16x32_bf16 v[28:31], v[88:91], v[136:139], v[28:31]
  s_waitcnt vmcnt(8)
  v_max3_u32 v250, v144, v145, v146
  v_max3_u32 v251, v147, v148, v149
  v_mfma_f32_16x16x32_bf16 v[48:51], v[88:91], v[140:143], 0
  v_max3_u32 v250, v250, v150, v151
  v_max_u32 v250, v250, v251
  v_mfma_f32_16x16x32_bf16 v[32:35], v[92:95], v[136:139], v[32:35]
  v_cmp_eq_u32 vcc, -1, v250
  v_mfma_f32_16x16x32_bf16 v[52:55], v[92:95], v[140:143], 0
  s_cbranch_vccnz x2_1
x2_1_b:
  s_waitcnt lgkmcnt(5)
  v_mfma_f32_16x16x32_bf16 v[16:19], v[96:99], v[144:147], v[16:19]
  ds_read_b128 v[76:79], v3 offset:26624
  ds_read_b128 v[80:83], v3 offset:27648
  v_mfma_f32_16x16x32_bf16 v[36:39], v[96:99], v[148:151], v[36:39]
  ds_read_b128 v[84:87], v3 offset:28672
  ds_read_b128 v[88:91], v3 offset:29696
  v_mfma_f32_16x16x32_bf16 v[20:23], v[100:103], v[144:147], v[20:23]
  ds_read_b128 v[92:95], v3 offset:30720
  buffer_load_dwordx4 v[184:187], v7, s[4:7], s34 offen offset:2048 sc1
  v_mfma_f32_16x16x32_bf16 v[40:43], v[100:103], v[148:151], v[40:43]
  buffer_load_dwordx4 v[188:191], v8, s[4:7], s34 offen offset:2048 sc1
  buffer_load_dwordx4 v[192:195], v7, s[4:7], s34 offen offset:3072 sc1
  v_mfma_f32_16x16x32_bf16 v[24:27], v[104:107], v[144:147], v[24:27]
  buffer_load_dwordx4 v[196:199], v8, s[4:7], s34 offen offset:3072 sc1
  s_mul_i32 s54, s53, 120
  v_mfma_f32_16x16x32_bf16 v[44:47], v[104:107], v[148:151], v[44:47]
  s_mul_i32 s55, s3, 15
  s_add_u32 s54, s54, s55
  v_mfma_f32_16x16x32_bf16 v[28:31], v[108:111], v[144:147], v[28:31]
  s_waitcnt vmcnt(10)
  v_max3_u32 v250, v152, v153, v154
  v_max3_u32 v251, v155, v156, v157
  v_mfma_f32_16x16x32_bf16 v[48:51], v[108:111], v[148:151], v[48:51]
  v_max3_u32 v250, v250, v158, v159
  v_max_u32 v250, v250, v251
  v_mfma_f32_16x16x32_bf16 v[32:35], v[112:115], v[144:147], v[32:35]
  v_cmp_eq_u32 vcc, -1, v250
  v_mfma_f32_16x16x32_bf16 v[52:55], v[112:115], v[148:151], v[52:55]
  s_cbranch_vccnz x2_2
x2_2_b:
  s_waitcnt lgkmcnt(5)
  v_mfma_f32_16x16x32_bf16 v[16:19], v[116:119], v[152:155], v[16:19]
  ds_read_b128 v[96:99], v3 offset:36864
  ds_read_b128 v[100:103], v3 offset:37888
  v_mfma_f32_16x16x32_bf16 v[36:39], v[116:119], v[156:159], v[36:39]
  ds_read_b128 v[104:107], v3 offset:38912
  ds_read_b128 v[108:111], v3 offset:39936
  v_mfma_f32_16x16x32_bf16 v[20:23], v[120:123], v[152:155], v[20:23]
  ds_read_b128 v[112:115], v3 offset:40960
  buffer_load_dwordx4 v[200:203], v5, s[4:7], s35 offen offset:0 sc1
  v_mfma_f32_16x16x32_bf16 v[40:43], v[120:123], v[156:159], v[40:43]
  buffer_load_dwordx4 v[204:207], v6, s[4:7], s35 offen offset:0 sc1
  buffer_load_dwordx4 v[208:211], v7, s[4:7], s35 offen offset:1024 sc1
  v_mfma_f32_16x16x32_bf16 v[24:27], v[124:127], v[152:155], v[24:27]
  buffer_load_dwordx4 v[212:215], v8, s[4:7], s35 offen offset:1024 sc1
  s_add_u32 s55, s55, 0
  v_mfma_f32_16x16x32_bf16 v[44:47], v[124:127], v[156:159], v[44:47]
  s_lshl_b32 s54, s54, 10
  s_lshl_b32 m0, s55, 10
  v_mfma_f32_16x16x32_bf16 v[28:31], v[128:131], v[152:155], v[28:31]
  s_waitcnt vmcnt(12)
  v_max3_u32 v250, v160, v161, v162
  v_max3_u32 v251, v163, v164, v165
  v_mfma_f32_16x16x32_bf16 v[48:51], v[128:131], v[156:159], v[48:51]
  v_max3_u32 v250, v250, v166, v167
  v_max_u32 v250, v250, v251
  v_mfma_f32_16x16x32_bf16 v[32:35], v[132:135], v[152:155], v[32:35]
  v_cmp_eq_u32 vcc, -1, v250
  v_mfma_f32_16x16x32_bf16 v[52:55], v[132:135], v[156:159], v[52:55]
  s_cbranch_vccnz x2_3
x2_3_b:
  s_waitcnt lgkmcnt(5)
  v_mfma_f32_16x16x32_bf16 v[16:19], v[76:79], v[160:163], v[16:19]
  ds_read_b128 v[116:119], v3 offset:47104
  ds_read_b128 v[120:123], v3 offset:48128
  v_mfma_f32_16x16x32_bf16 v[36:39], v[76:79], v[164:167], v[36:39]
  ds_read_b128 v[124:127], v3 offset:49152
  v_mfma_f32_16x16x32_bf16 v[20:23], v[80:83], v[160:163], v[20:23]
  ds_read_b128 v[128:131], v3 offset:50176
  v_mfma_f32_16x16x32_bf16 v[40:43], v[80:83], v[164:167], v[40:43]
  ds_read_b128 v[132:135], v3 offset:51200
  s_add_u32 s54, s54, 23887872
  v_mfma_f32_16x16x32_bf16 v[24:27], v[84:87], v[160:163], v[24:27]
  buffer_load_dwordx4 v1, s[4:7], s54 offen offset:0 sc1 lds
  v_mfma_f32_16x16x32_bf16 v[44:47], v[84:87], v[164:167], v[44:47]
  buffer_load_dwordx4 v1, s[4:7], s54 offen offset:1024 sc1 lds
  v_mfma_f32_16x16x32_bf16 v[28:31], v[88:91], v[160:163], v[28:31]
  s_waitcnt vmcnt(12)
  v_max3_u32 v250, v168, v169, v170
  v_max3_u32 v251, v171, v172, v173
  v_mfma_f32_16x16x32_bf16 v[48:51], v[88:91], v[164:167], v[48:51]
  v_max3_u32 v250, v250, v174, v175
  v_max_u32 v250, v250, v251
  v_mfma_f32_16x16x32_bf16 v[32:35], v[92:95], v[160:163], v[32:35]
  v_cmp_eq_u32 vcc, -1, v250
  v_mfma_f32_16x16x32_bf16 v[52:55], v[92:95], v[164:167], v[52:55]
  s_cbranch_vccnz x2_4
x2_4_b:
  s_waitcnt lgkmcnt(5)
  v_mfma_f32_16x16x32_bf16 v[16:19], v[96:99], v[168:171], v[16:19]
  ds_read_b128 v[76:79], v3 offset:57344
  ds_read_b128 v[80:83], v3 offset:58368
  v_mfma_f32_16x16x32_bf16 v[36:39], v[96:99], v[172:175], v[36:39]
  ds_read_b128 v[84:87], v3 offset:59392
  v_mfma_f32_16x16x32_bf16 v[20:23], v[100:103], v[168:171], v[20:23]
  ds_read_b128 v[88:91], v3 offset:60416
  v_mfma_f32_16x16x32_bf16 v[40:43], v[100:103], v[172:175], v[40:43]
  ds_read_b128 v[92:95], v3 offset:61440
  buffer_load_dwordx4 v1, s[4:7], s54 offen offset:2048 sc1 lds
  v_mfma_f32_16x16x32_bf16 v[24:27], v[104:107], v[168:171], v[24:27]
  buffer_load_dwordx4 v1, s[4:7], s54 offen offset:3072 sc1 lds
  v_mfma_f32_16x16x32_bf16 v[44:47], v[104:107], v[172:175], v[44:47]
  s_add_u32 m0, m0, 4096
  v_mfma_f32_16x16x32_bf16 v[28:31], v[108:111], v[168:171], v[28:31]
  s_waitcnt vmcnt(12)
  v_max3_u32 v250, v176, v177, v178
  v_max3_u32 v251, v179, v180, v181
  v_mfma_f32_16x16x32_bf16 v[48:51], v[108:111], v[172:175], v[48:51]
  v_max3_u32 v250, v250, v182, v183
  v_max_u32 v250, v250, v251
  v_mfma_f32_16x16x32_bf16 v[32:35], v[112:115], v[168:171], v[32:35]
  v_cmp_eq_u32 vcc, -1, v250
  v_mfma_f32_16x16x32_bf16 v[52:55], v[112:115], v[172:175], v[52:55]
  s_cbranch_vccnz x2_5
x2_5_b:
  s_waitcnt lgkmcnt(5)
  v_mfma_f32_16x16x32_bf16 v[16:19], v[116:119], v[176:179], v[16:19]
  ds_read_b128 v[96:99], v15 offset:2048
  ds_read_b128 v[100:103], v15 offset:3072
  v_mfma_f32_16x16x32_bf16 v[36:39], v[116:119], v[180:183], v[36:39]
  ds_read_b128 v[104:107], v15 offset:4096
  v_mfma_f32_16x16x32_bf16 v[20:23], v[120:123], v[176:179], v[20:23]
  ds_read_b128 v[108:111], v15 offset:5120
  v_mfma_f32_16x16x32_bf16 v[40:43], v[120:123], v[180:183], v[40:43]
  ds_read_b128 v[112:115], v15 offset:6144
  s_add_u32 s54, s54, 4096
  v_mfma_f32_16x16x32_bf16 v[24:27], v[124:127], v[176:179], v[24:27]
  buffer_load_dwordx4 v1, s[4:7], s54 offen offset:0 sc1 lds
  v_mfma_f32_16x16x32_bf16 v[44:47], v[124:127], v[180:183], v[44:47]
  buffer_load_dwordx4 v1, s[4:7], s54 offen offset:1024 sc1 lds
  v_mfma_f32_16x16x32_bf16 v[28:31], v[128:131], v[176:179], v[28:31]
  s_waitcnt vmcnt(12)
  v_max3_u32 v250, v184, v185, v186
  v_max3_u32 v251, v187, v188, v189
  v_mfma_f32_16x16x32_bf16 v[48:51], v[128:131], v[180:183], v[48:51]
  v_max3_u32 v250, v250, v190, v191
  v_max_u32 v250, v250, v251
  v_mfma_f32_16x16x32_bf16 v[32:35], v[132:135], v[176:179], v[32:35]
  v_cmp_eq_u32 vcc, -1, v250
  v_mfma_f32_16x16x32_bf16 v[52:55], v[132:135], v[180:183], v[52:55]
  s_cbranch_vccnz x2_6
x2_6_b:
  s_waitcnt lgkmcnt(5)
  v_mfma_f32_16x16x32_bf16 v[16:19], v[76:79], v[184:187], v[16:19]
  ds_read_b128 v[116:119], v15 offset:12288
  ds_read_b128 v[120:123], v15 offset:13312
  v_mfma_f32_16x16x32_bf16 v[36:39], v[76:79], v[188:191], v[36:39]
  ds_read_b128 v[124:127], v15 offset:14336
  v_mfma_f32_16x16x32_bf16 v[20:23], v[80:83], v[184:187], v[20:23]
  ds_read_b128 v[128:131], v15 offset:15360
  v_mfma_f32_16x16x32_bf16 v[40:43], v[80:83], v[188:191], v[40:43]
  ds_read_b128 v[132:135], v15 offset:16384
  buffer_load_dwordx4 v1, s[4:7], s54 offen offset:2048 sc1 lds
  v_mfma_f32_16x16x32_bf16 v[24:27], v[84:87], v[184:187], v[24:27]
  buffer_load_dwordx4 v1, s[4:7], s54 offen offset:3072 sc1 lds
  v_mfma_f32_16x16x32_bf16 v[44:47], v[84:87], v[188:191], v[44:47]
  s_add_u32 m0, m0, 4096
  v_mfma_f32_16x16x32_bf16 v[28:31], v[88:91], v[184:187], v[28:31]
  s_waitcnt vmcnt(12)
  v_max3_u32 v250, v192, v193, v194
  v_max3_u32 v251, v195, v196, v197
  v_mfma_f32_16x16x32_bf16 v[48:51], v[88:91], v[188:191], v[48:51]
  v_max3_u32 v250, v250, v198, v199
  v_max_u32 v250, v250, v251
  v_mfma_f32_16x16x32_bf16 v[32:35], v[92:95], v[184:187], v[32:35]
  v_cmp_eq_u32 vcc, -1, v250
  v_mfma_f32_16x16x32_bf16 v[52:55], v[92:95], v[188:191], v[52:55]
  s_cbranch_vccnz x2_7
x2_7_b:
  s_waitcnt lgkmcnt(5)
  v_mfma_f32_16x16x32_bf16 v[16:19], v[96:99], v[192:195], v[16:19]
  ds_read_b128 v[76:79], v15 offset:22528
  ds_read_b128 v[80:83], v15 offset:23552
  v_mfma_f32_16x16x32_bf16 v[36:39], v[96:99], v[196:199], v[36:39]
  ds_read_b128 v[84:87], v15 offset:24576
  v_mfma_f32_16x16x32_bf16 v[20:23], v[100:103], v[192:195], v[20:23]
  ds_read_b128 v[88:91], v15 offset:25600
  v_mfma_f32_16x16x32_bf16 v[40:43], v[100:103], v[196:199], v[40:43]
  ds_read_b128 v[92:95], v15 offset:26624
  s_add_u32 s54, s54, 4096
  v_mfma_f32_16x16x32_bf16 v[24:27], v[104:107], v[192:195], v[24:27]
  buffer_load_dwordx4 v1, s[4:7], s54 offen offset:0 sc1 lds
  v_mfma_f32_16x16x32_bf16 v[44:47], v[104:107], v[196:199], v[44:47]
  buffer_load_dwordx4 v1, s[4:7], s54 offen offset:1024 sc1 lds
  v_mfma_f32_16x16x32_bf16 v[28:31], v[108:111], v[192:195], v[28:31]
  s_waitcnt vmcnt(12)
  v_max3_u32 v250, v200, v201, v202
  v_max3_u32 v251, v203, v204, v205
  v_mfma_f32_16x16x32_bf16 v[48:51], v[108:111], v[196:199], v[48:51]
  v_max3_u32 v250, v250, v206, v207
  v_max_u32 v250, v250, v251
  v_mfma_f32_16x16x32_bf16 v[32:35], v[112:115], v[192:195], v[32:35]
  v_cmp_eq_u32 vcc, -1, v250
  v_mfma_f32_16x16x32_bf16 v[52:55], v[112:115], v[196:199], v[52:55]
  s_cbranch_vccnz x2_8
x2_8_b:
  s_waitcnt lgkmcnt(5)
  v_mfma_f32_16x16x32_bf16 v[16:19], v[116:119], v[200:203], v[16:19]
  buffer_load_dwordx4 v1, s[4:7], s54 offen offset:2048 sc1 lds
  v_mfma_f32_16x16x32_bf16 v[36:39], v[116:119], v[204:207], v[36:39]
  v_mfma_f32_16x16x32_bf16 v[20:23], v[120:123], v[200:203], v[20:23]
  buffer_load_dwordx4 v1, s[4:7], s54 offen offset:3072 sc1 lds
  v_mfma_f32_16x16x32_bf16 v[40:43], v[120:123], v[204:207], v[40:43]
  v_mfma_f32_16x16x32_bf16 v[24:27], v[124:127], v[200:203], v[24:27]
  s_add_u32 m0, m0, 4096
  v_mfma_f32_16x16x32_bf16 v[44:47], v[124:127], v[204:207], v[44:47]
  v_mfma_f32_16x16x32_bf16 v[28:31], v[128:131], v[200:203], v[28:31]
  s_waitcnt vmcnt(12)
  v_max3_u32 v250, v208, v209, v210
  v_max3_u32 v251, v211, v212, v213
  v_mfma_f32_16x16x32_bf16 v[48:51], v[128:131], v[204:207], v[48:51]
  v_max3_u32 v250, v250, v214, v215
  v_max_u32 v250, v250, v251
  v_mfma_f32_16x16x32_bf16 v[32:35], v[132:135], v[200:203], v[32:35]
  v_cmp_eq_u32 vcc, -1, v250
  v_mfma_f32_16x16x32_bf16 v[52:55], v[132:135], v[204:207], v[52:55]
  s_cbranch_vccnz x2_9
x2_9_b:
  s_waitcnt lgkmcnt(0)
  v_mfma_f32_16x16x32_bf16 v[16:19], v[76:79], v[208:211], v[16:19]
  s_add_u32 s54, s54, 4096
  v_mfma_f32_16x16x32_bf16 v[36:39], v[76:79], v[212:215], v[36:39]
  v_mfma_f32_16x16x32_bf16 v[20:23], v[80:83], v[208:211], v[20:23]
  buffer_load_dwordx4 v1, s[4:7], s54 offen offset:0 sc1 lds
  v_mfma_f32_16x16x32_bf16 v[40:43], v[80:83], v[212:215], v[40:43]
  v_mfma_f32_16x16x32_bf16 v[24:27], v[84:87], v[208:211], v[24:27]
  v_mfma_f32_16x16x32_bf16 v[44:47], v[84:87], v[212:215], v[44:47]
  buffer_load_dwordx4 v1, s[4:7], s54 offen offset:1024 sc1 lds
  v_mfma_f32_16x16x32_bf16 v[28:31], v[88:91], v[208:211], v[28:31]
  v_mfma_f32_16x16x32_bf16 v[48:51], v[88:91], v[212:215], v[48:51]
  buffer_load_dwordx4 v1, s[4:7], s54 offen offset:2048 sc1 lds
  v_mfma_f32_16x16x32_bf16 v[32:35], v[92:95], v[208:211], v[32:35]
  v_mfma_f32_16x16x32_bf16 v[52:55], v[92:95], v[212:215], v[52:55]
  s_barrier
  ds_write_b128 v9, v[36:39] offset:0
  ds_write_b128 v9, v[40:43] offset:1024
  ds_write_b128 v9, v[44:47] offset:2048
  s_nop 0
  ds_write_b128 v9, v[48:51] offset:3072
  s_nop 1
  ds_write_b128 v9, v[52:55] offset:4096
  s_mul_i32 s54, s53, 120
  s_mul_i32 s55, s3, 15
  s_add_u32 s54, s54, s55
  s_add_u32 s55, s55, 60
  s_lshl_b32 s54, s54, 10
  s_lshl_b32 m0, s55, 10
  s_add_u32 s54, s54, 23949312
  buffer_load_dwordx4 v1, s[4:7], s54 offen offset:0 sc1 lds
  buffer_load_dwordx4 v1, s[4:7], s54 offen offset:1024 sc1 lds
  buffer_load_dwordx4 v1, s[4:7], s54 offen offset:2048 sc1 lds
  buffer_load_dwordx4 v1, s[4:7], s54 offen offset:3072 sc1 lds
  s_waitcnt lgkmcnt(0)
  s_barrier
  ds_read_b128 v[76:79], v10 offset:0
  ds_read_b128 v[80:83], v10 offset:1024
  ds_read_b128 v[84:87], v10 offset:2048
  ds_read_b128 v[88:91], v10 offset:3072
  ds_read_b128 v[92:95], v10 offset:4096
  s_waitcnt lgkmcnt(4)
  v_pk_add_f32 v[16:17], v[16:17], v[76:77]
  v_pk_add_f32 v[18:19], v[18:19], v[78:79]
  s_waitcnt lgkmcnt(3)
  v_pk_add_f32 v[20:21], v[20:21], v[80:81]
  v_pk_add_f32 v[22:23], v[22:23], v[82:83]
  s_add_u32 m0, m0, 4096
  v_mov_b32 v8, 0
  v_mov_b32 v9, 0
  v_mov_b32 v10, 0
  s_add_u32 s54, s54, 4096
  v_mov_b32 v11, 0
  v_cvt_pk_bf16_f32 v60, v16, v17
  v_cvt_pk_bf16_f32 v61, v18, v19
  buffer_load_dwordx4 v1, s[4:7], s54 offen offset:0 sc1 lds
  s_waitcnt lgkmcnt(2)
  v_pk_add_f32 v[24:25], v[24:25], v[84:85]
  v_pk_add_f32 v[26:27], v[26:27], v[86:87]
  v_dot2c_f32_bf16 v8, v60, v72
  buffer_load_dwordx4 v1, s[4:7], s54 offen offset:1024 sc1 lds
  v_dot2c_f32_bf16 v9, v60, v60
  v_dot2c_f32_bf16 v10, v61, v72
  v_dot2c_f32_bf16 v11, v61, v61
  buffer_load_dwordx4 v1, s[4:7], s54 offen offset:2048 sc1 lds
  v_cvt_pk_bf16_f32 v62, v20, v21
  v_cvt_pk_bf16_f32 v63, v22, v23
  s_waitcnt lgkmcnt(1)
  v_pk_add_f32 v[28:29], v[28:29], v[88:89]
  buffer_load_dwordx4 v1, s[4:7], s54 offen offset:3072 sc1 lds
  v_pk_add_f32 v[30:31], v[30:31], v[90:91]
  v_dot2c_f32_bf16 v8, v62, v72
  v_dot2c_f32_bf16 v9, v62, v62
  s_add_u32 m0, m0, 4096
  v_dot2c_f32_bf16 v10, v63, v72
  v_dot2c_f32_bf16 v11, v63, v63
  v_cvt_pk_bf16_f32 v64, v24, v25
  s_add_u32 s54, s54, 4096
  v_cvt_pk_bf16_f32 v65, v26, v27
  s_waitcnt lgkmcnt(0)
  v_pk_add_f32 v[32:33], v[32:33], v[92:93]
  v_pk_add_f32 v[34:35], v[34:35], v[94:95]
  buffer_load_dwordx4 v1, s[4:7], s54 offen offset:0 sc1 lds
  v_dot2c_f32_bf16 v8, v64, v72
  v_dot2c_f32_bf16 v9, v64, v64
  v_dot2c_f32_bf16 v10, v65, v72
  buffer_load_dwordx4 v1, s[4:7], s54 offen offset:1024 sc1 lds
  v_dot2c_f32_bf16 v11, v65, v65
  v_cvt_pk_bf16_f32 v66, v28, v29
  v_cvt_pk_bf16_f32 v67, v30, v31
  buffer_load_dwordx4 v1, s[4:7], s54 offen offset:2048 sc1 lds
  v_dot2c_f32_bf16 v8, v66, v72
  v_dot2c_f32_bf16 v9, v66, v66
  v_dot2c_f32_bf16 v10, v67, v72
  buffer_load_dwordx4 v1, s[4:7], s54 offen offset:3072 sc1 lds
  v_dot2c_f32_bf16 v11, v67, v67
  v_cvt_pk_bf16_f32 v68, v32, v33
  v_cvt_pk_bf16_f32 v69, v34, v35
  s_add_u32 m0, m0, 4096
  v_dot2c_f32_bf16 v8, v68, v72
  v_dot2c_f32_bf16 v9, v68, v68
  v_dot2c_f32_bf16 v10, v69, v72
  s_add_u32 s54, s54, 4096
  v_dot2c_f32_bf16 v11, v69, v69
  v_lshlrev_b32 v4, 3, v0
  s_nop 1
  v_pk_add_f32 v[8:9], v[8:9], v[10:11]
  buffer_load_dwordx4 v1, s[4:7], s54 offen offset:0 sc1 lds
  v_mov_b32 v10, v8
  v_mov_b32 v11, v9
  s_nop 0
  v_permlane16_swap_b32 v8, v10
  buffer_load_dwordx4 v1, s[4:7], s54 offen offset:1024 sc1 lds
  v_permlane16_swap_b32 v9, v11
  v_add_f32 v8, v8, v10
  v_add_f32 v9, v9, v11
  buffer_load_dwordx4 v1, s[4:7], s54 offen offset:2048 sc1 lds
  v_mov_b32 v10, v8
  v_mov_b32 v11, v9
  s_nop 0
  v_permlane32_swap_b32 v8, v10
  v_permlane32_swap_b32 v9, v11
  v_add_f32 v8, v8, v10
  v_add_f32 v9, v9, v11
  s_mul_i32 s28, s24, 20480
  s_add_u32 s28, s28, 10485760
  s_lshl_b32 s29, s25, 11
  s_add_u32 s29, s29, s28
  buffer_store_dwordx4 v[60:63], v1, s[4:7], s29 offen sc1
  buffer_store_dwordx4 v[64:67], v1, s[4:7], s29 offen offset:1024 sc1
  v_permlane32_swap_b32 v68, v70
  v_permlane32_swap_b32 v69, v71
  s_lshl_b32 s29, s25, 9
  s_add_u32 s29, s29, s28
  s_add_u32 s29, s29, 16384
  s_mov_b32 exec_hi, 0
  buffer_store_dwordx4 v[68:71], v1, s[4:7], s29 offen sc1
  s_mov_b32 exec_hi, -1
  s_lshl_b32 s29, s24, 3
  s_add_u32 s29, s29, s25
  s_lshl_b32 s29, s29, 7
  s_add_u32 s29, s29, 13107200
  s_mov_b64 exec, 0xffff
  buffer_store_dwordx2 v[8:9], v4, s[4:7], s29 offen sc1
  s_mov_b64 exec, -1
  v_pk_add_f32 v[228:229], v[228:229], v[16:17]
  v_pk_add_f32 v[230:231], v[230:231], v[18:19]
  v_pk_add_f32 v[232:233], v[232:233], v[20:21]
  v_pk_add_f32 v[234:235], v[234:235], v[22:23]
  v_pk_add_f32 v[236:237], v[236:237], v[24:25]
  v_pk_add_f32 v[238:239], v[238:239], v[26:27]
  v_pk_add_f32 v[240:241], v[240:241], v[28:29]
  v_pk_add_f32 v[242:243], v[242:243], v[30:31]
  v_pk_add_f32 v[244:245], v[244:245], v[32:33]
  v_pk_add_f32 v[246:247], v[246:247], v[34:35]
  v_add_u32 v3, 65536, v1
  v_add_u32 v15, 131072, v1
  v_and_b32 v6, 15, v0
  v_and_b32 v7, 48, v0
  v_lshlrev_b32 v7, 4, v7
  v_lshl_add_u32 v7, v6, 3, v7
  s_lshl_b32 s29, s52, 10
  s_add_u32 s29, s29, 13107200
  s_mul_i32 s30, s52, 20480
  s_add_u32 s30, s30, 10485760
  s_add_u32 s31, s30, 20480
  v_and_b32 v4, 48, v0
  s_mul_i32 s32, s53, 384
  s_add_u32 s32, s32, 28315648
  s_waitcnt vmcnt(0)
  s_mov_b32 s34, s30
  s_mov_b32 s35, s31
  buffer_load_dwordx4 v[136:139], v1, s[4:7], s34 offen offset:0 sc1
  buffer_load_dwordx4 v[140:143], v1, s[4:7], s35 offen offset:0 sc1
  buffer_load_dwordx4 v[144:147], v1, s[4:7], s34 offen offset:1024 sc1
  buffer_load_dwordx4 v[148:151], v1, s[4:7], s35 offen offset:1024 sc1
  buffer_load_dwordx4 v[152:155], v1, s[4:7], s34 offen offset:2048 sc1
  buffer_load_dwordx4 v[156:159], v1, s[4:7], s35 offen offset:2048 sc1
  s_waitcnt vmcnt(6)
  s_barrier
  ds_read_b128 v[64:67], v1 offset:0
  ds_read_b128 v[68:71], v1 offset:1024
  ds_read_b128 v[72:75], v1 offset:2048
  ds_read_b128 v[76:79], v1 offset:3072
  ds_read_b128 v[80:83], v1 offset:4096
  ds_read_b128 v[84:87], v1 offset:5120
  ds_read_b128 v[88:91], v1 offset:6144
  ds_read_b128 v[92:95], v1 offset:7168
  ds_read_b128 v[96:99], v1 offset:8192
  ds_read_b128 v[100:103], v1 offset:9216
  ds_read_b128 v[104:107], v1 offset:10240
  ds_read_b128 v[108:111], v1 offset:11264
  s_waitcnt vmcnt(4)
  v_max3_u32 v250, v136, v137, v138
  v_max3_u32 v251, v139, v140, v141
  v_max3_u32 v250, v250, v142, v143
  v_max_u32 v250, v250, v251
  v_cmp_eq_u32 vcc, -1, v250
  s_cbranch_vccnz x3_0
x3_0_b:
  s_waitcnt lgkmcnt(6)
  v_mfma_f32_16x16x32_bf16 v[16:19], v[64:67], v[136:139], 0
  ds_read_b128 v[112:115], v1 offset:12288
  ds_read_b128 v[116:119], v1 offset:13312
  v_mfma_f32_16x16x32_bf16 v[40:43], v[64:67], v[140:143], 0
  ds_read_b128 v[120:123], v1 offset:14336
  ds_read_b128 v[124:127], v1 offset:15360
  v_mfma_f32_16x16x32_bf16 v[20:23], v[68:71], v[136:139], 0
  ds_read_b128 v[128:131], v1 offset:16384
  ds_read_b128 v[132:135], v1 offset:17408
  v_mfma_f32_16x16x32_bf16 v[44:47], v[68:71], v[140:143], 0
  buffer_load_dwordx4 v[160:163], v1, s[4:7], s34 offen offset:3072 sc1
  v_mfma_f32_16x16x32_bf16 v[24:27], v[72:75], v[136:139], 0
  buffer_load_dwordx4 v[164:167], v1, s[4:7], s35 offen offset:3072 sc1
  s_add_u32 s34, s30, 4096
  v_mfma_f32_16x16x32_bf16 v[48:51], v[72:75], v[140:143], 0
  s_add_u32 s35, s31, 4096
  buffer_load_dwordx4 v[168:171], v1, s[4:7], s34 offen offset:0 sc1
  v_mfma_f32_16x16x32_bf16 v[28:31], v[76:79], v[136:139], 0
  buffer_load_dwordx4 v[172:175], v1, s[4:7], s35 offen offset:0 sc1
  buffer_load_dwordx4 v[176:179], v1, s[4:7], s34 offen offset:1024 sc1
  v_mfma_f32_16x16x32_bf16 v[52:55], v[76:79], v[140:143], 0
  buffer_load_dwordx4 v[180:183], v1, s[4:7], s35 offen offset:1024 sc1
  v_mfma_f32_16x16x32_bf16 v[32:35], v[80:83], v[136:139], 0
  s_waitcnt vmcnt(8)
  v_max3_u32 v250, v144, v145, v146
  v_max3_u32 v251, v147, v148, v149
  v_mfma_f32_16x16x32_bf16 v[56:59], v[80:83], v[140:143], 0
  v_max3_u32 v250, v250, v150, v151
  v_max_u32 v250, v250, v251
  v_mfma_f32_16x16x32_bf16 v[36:39], v[84:87], v[136:139], 0
  v_cmp_eq_u32 vcc, -1, v250
  v_mfma_f32_16x16x32_bf16 v[60:63], v[84:87], v[140:143], 0
  s_cbranch_vccnz x3_1
x3_1_b:
  s_waitcnt lgkmcnt(6)
  v_mfma_f32_16x16x32_bf16 v[16:19], v[88:91], v[144:147], v[16:19]
  ds_read_b128 v[64:67], v1 offset:18432
  ds_read_b128 v[68:71], v1 offset:19456
  v_mfma_f32_16x16x32_bf16 v[40:43], v[88:91], v[148:151], v[40:43]
  ds_read_b128 v[72:75], v1 offset:20480
  ds_read_b128 v[76:79], v1 offset:21504
  v_mfma_f32_16x16x32_bf16 v[20:23], v[92:95], v[144:147], v[20:23]
  ds_read_b128 v[80:83], v1 offset:22528
  ds_read_b128 v[84:87], v1 offset:23552
  v_mfma_f32_16x16x32_bf16 v[44:47], v[92:95], v[148:151], v[44:47]
  buffer_load_dwordx4 v[184:187], v1, s[4:7], s34 offen offset:2048 sc1
  v_mfma_f32_16x16x32_bf16 v[24:27], v[96:99], v[144:147], v[24:27]
  buffer_load_dwordx4 v[188:191], v1, s[4:7], s35 offen offset:2048 sc1
  buffer_load_dwordx4 v[192:195], v1, s[4:7], s34 offen offset:3072 sc1
  v_mfma_f32_16x16x32_bf16 v[48:51], v[96:99], v[148:151], v[48:51]
  buffer_load_dwordx4 v[196:199], v1, s[4:7], s35 offen offset:3072 sc1
  s_add_u32 s34, s30, 8192
  v_mfma_f32_16x16x32_bf16 v[28:31], v[100:103], v[144:147], v[28:31]
  s_add_u32 s35, s31, 8192
  buffer_load_dwordx4 v[200:203], v1, s[4:7], s34 offen offset:0 sc1
  v_mfma_f32_16x16x32_bf16 v[52:55], v[100:103], v[148:151], v[52:55]
  buffer_load_dwordx4 v[204:207], v1, s[4:7], s35 offen offset:0 sc1
  v_mfma_f32_16x16x32_bf16 v[32:35], v[104:107], v[144:147], v[32:35]
  s_waitcnt vmcnt(12)
  v_max3_u32 v250, v152, v153, v154
  v_max3_u32 v251, v155, v156, v157
  v_mfma_f32_16x16x32_bf16 v[56:59], v[104:107], v[148:151], v[56:59]
  v_max3_u32 v250, v250, v158, v159
  v_max_u32 v250, v250, v251
  v_mfma_f32_16x16x32_bf16 v[36:39], v[108:111], v[144:147], v[36:39]
  v_cmp_eq_u32 vcc, -1, v250
  v_mfma_f32_16x16x32_bf16 v[60:63], v[108:111], v[148:151], v[60:63]
  s_cbranch_vccnz x3_2
x3_2_b:
  s_waitcnt lgkmcnt(6)
  v_mfma_f32_16x16x32_bf16 v[16:19], v[112:115], v[152:155], v[16:19]
  ds_read_b128 v[88:91], v1 offset:24576
  ds_read_b128 v[92:95], v1 offset:25600
  v_mfma_f32_16x16x32_bf16 v[40:43], v[112:115], v[156:159], v[40:43]
  ds_read_b128 v[96:99], v1 offset:26624
  v_mfma_f32_16x16x32_bf16 v[20:23], v[116:119], v[152:155], v[20:23]
  ds_read_b128 v[100:103], v1 offset:27648
  v_mfma_f32_16x16x32_bf16 v[44:47], v[116:119], v[156:159], v[44:47]
  ds_read_b128 v[104:107], v1 offset:28672
  v_mfma_f32_16x16x32_bf16 v[24:27], v[120:123], v[152:155], v[24:27]
  ds_read_b128 v[108:111], v1 offset:29696
  buffer_load_dwordx4 v[136:139], v1, s[4:7], s34 offen offset:1024 sc1
  v_mfma_f32_16x16x32_bf16 v[48:51], v[120:123], v[156:159], v[48:51]
  buffer_load_dwordx4 v[140:143], v1, s[4:7], s35 offen offset:1024 sc1
  v_mfma_f32_16x16x32_bf16 v[28:31], v[124:127], v[152:155], v[28:31]
  buffer_load_dwordx4 v[144:147], v1, s[4:7], s34 offen offset:2048 sc1
  v_mfma_f32_16x16x32_bf16 v[52:55], v[124:127], v[156:159], v[52:55]
  buffer_load_dwordx4 v[148:151], v1, s[4:7], s35 offen offset:2048 sc1
  v_mfma_f32_16x16x32_bf16 v[32:35], v[128:131], v[152:155], v[32:35]
  s_waitcnt vmcnt(14)
  v_max3_u32 v250, v160, v161, v162
  v_max3_u32 v251, v163, v164, v165
  v_mfma_f32_16x16x32_bf16 v[56:59], v[128:131], v[156:159], v[56:59]
  v_max3_u32 v250, v250, v166, v167
  v_max_u32 v250, v250, v251
  v_mfma_f32_16x16x32_bf16 v[36:39], v[132:135], v[152:155], v[36:39]
  v_cmp_eq_u32 vcc, -1, v250
  v_mfma_f32_16x16x32_bf16 v[60:63], v[132:135], v[156:159], v[60:63]
  s_cbranch_vccnz x3_3
x3_3_b:
  s_waitcnt lgkmcnt(6)
  v_mfma_f32_16x16x32_bf16 v[16:19], v[64:67], v[160:163], v[16:19]
  ds_read_b128 v[112:115], v1 offset:30720
  v_mfma_f32_16x16x32_bf16 v[40:43], v[64:67], v[164:167], v[40:43]
  ds_read_b128 v[116:119], v1 offset:31744
  v_mfma_f32_16x16x32_bf16 v[20:23], v[68:71], v[160:163], v[20:23]
  ds_read_b128 v[120:123], v1 offset:32768
  v_mfma_f32_16x16x32_bf16 v[44:47], v[68:71], v[164:167], v[44:47]
  ds_read_b128 v[124:127], v1 offset:33792
  v_mfma_f32_16x16x32_bf16 v[24:27], v[72:75], v[160:163], v[24:27]
  ds_read_b128 v[128:131], v1 offset:34816
  v_mfma_f32_16x16x32_bf16 v[48:51], v[72:75], v[164:167], v[48:51]
  ds_read_b128 v[132:135], v1 offset:35840
  v_mfma_f32_16x16x32_bf16 v[28:31], v[76:79], v[160:163], v[28:31]
  buffer_load_dwordx4 v[152:155], v1, s[4:7], s34 offen offset:3072 sc1
  v_mfma_f32_16x16x32_bf16 v[52:55], v[76:79], v[164:167], v[52:55]
  buffer_load_dwordx4 v[156:159], v1, s[4:7], s35 offen offset:3072 sc1
  v_mfma_f32_16x16x32_bf16 v[32:35], v[80:83], v[160:163], v[32:35]
  s_waitcnt vmcnt(14)
  v_max3_u32 v250, v168, v169, v170
  v_max3_u32 v251, v171, v172, v173
  v_mfma_f32_16x16x32_bf16 v[56:59], v[80:83], v[164:167], v[56:59]
  v_max3_u32 v250, v250, v174, v175
  v_max_u32 v250, v250, v251
  v_mfma_f32_16x16x32_bf16 v[36:39], v[84:87], v[160:163], v[36:39]
  v_cmp_eq_u32 vcc, -1, v250
  v_mfma_f32_16x16x32_bf16 v[60:63], v[84:87], v[164:167], v[60:63]
  s_cbranch_vccnz x3_4
x3_4_b:
  s_waitcnt lgkmcnt(6)
  v_mfma_f32_16x16x32_bf16 v[16:19], v[88:91], v[168:171], v[16:19]
  ds_read_b128 v[64:67], v1 offset:36864
  ds_read_b128 v[68:71], v1 offset:37888
  v_mfma_f32_16x16x32_bf16 v[40:43], v[88:91], v[172:175], v[40:43]
  ds_read_b128 v[72:75], v1 offset:38912
  ds_read_b128 v[76:79], v1 offset:39936
  v_mfma_f32_16x16x32_bf16 v[20:23], v[92:95], v[168:171], v[20:23]
  ds_read_b128 v[80:83], v1 offset:40960
  ds_read_b128 v[84:87], v1 offset:41984
  v_mfma_f32_16x16x32_bf16 v[44:47], v[92:95], v[172:175], v[44:47]
  s_add_u32 s34, s30, 12288
  v_mfma_f32_16x16x32_bf16 v[24:27], v[96:99], v[168:171], v[24:27]
  s_add_u32 s35, s31, 12288
  buffer_load_dwordx4 v[160:163], v1, s[4:7], s34 offen offset:0 sc1
  v_mfma_f32_16x16x32_bf16 v[48:51], v[96:99], v[172:175], v[48:51]
  buffer_load_dwordx4 v[164:167], v1, s[4:7], s35 offen offset:0 sc1
  buffer_load_dwordx2 v[208:209], v7, s[4:7], s29 offen offset:0 sc1
  v_mfma_f32_16x16x32_bf16 v[28:31], v[100:103], v[168:171], v[28:31]
  buffer_load_dwordx2 v[210:211], v7, s[4:7], s29 offen offset:128 sc1
  buffer_load_dwordx2 v[212:213], v7, s[4:7], s29 offen offset:1024 sc1
  v_mfma_f32_16x16x32_bf16 v[52:55], v[100:103], v[172:175], v[52:55]
  buffer_load_dwordx2 v[214:215], v7, s[4:7], s29 offen offset:1152 sc1
  v_mfma_f32_16x16x32_bf16 v[32:35], v[104:107], v[168:171], v[32:35]
  s_waitcnt vmcnt(18)
  v_max3_u32 v250, v176, v177, v178
  v_max3_u32 v251, v179, v180, v181
  v_mfma_f32_16x16x32_bf16 v[56:59], v[104:107], v[172:175], v[56:59]
  v_max3_u32 v250, v250, v182, v183
  v_max_u32 v250, v250, v251
  v_mfma_f32_16x16x32_bf16 v[36:39], v[108:111], v[168:171], v[36:39]
  v_cmp_eq_u32 vcc, -1, v250
  v_mfma_f32_16x16x32_bf16 v[60:63], v[108:111], v[172:175], v[60:63]
  s_cbranch_vccnz x3_5
x3_5_b:
  s_waitcnt lgkmcnt(6)
  v_mfma_f32_16x16x32_bf16 v[16:19], v[112:115], v[176:179], v[16:19]
  ds_read_b128 v[88:91], v1 offset:43008
  ds_read_b128 v[92:95], v1 offset:44032
  v_mfma_f32_16x16x32_bf16 v[40:43], v[112:115], v[180:183], v[40:43]
  ds_read_b128 v[96:99], v1 offset:45056
  v_mfma_f32_16x16x32_bf16 v[20:23], v[116:119], v[176:179], v[20:23]
  ds_read_b128 v[100:103], v1 offset:46080
  ds_read_b128 v[104:107], v1 offset:47104
  v_mfma_f32_16x16x32_bf16 v[44:47], v[116:119], v[180:183], v[44:47]
  ds_read_b128 v[108:111], v1 offset:48128
  v_mfma_f32_16x16x32_bf16 v[24:27], v[120:123], v[176:179], v[24:27]
  buffer_load_dwordx4 v[168:171], v1, s[4:7], s34 offen offset:1024 sc1
  buffer_load_dwordx4 v[172:175], v1, s[4:7], s35 offen offset:1024 sc1
  v_mfma_f32_16x16x32_bf16 v[48:51], v[120:123], v[180:183], v[48:51]
  s_mul_i32 s54, s25, 240
  v_mfma_f32_16x16x32_bf16 v[28:31], v[124:127], v[176:179], v[28:31]
  s_mul_i32 s55, s3, 10
  s_add_u32 s54, s54, s55
  v_mfma_f32_16x16x32_bf16 v[52:55], v[124:127], v[180:183], v[52:55]
  s_add_u32 s55, s55, 120
  v_mfma_f32_16x16x32_bf16 v[32:35], v[128:131], v[176:179], v[32:35]
  s_waitcnt vmcnt(18)
  v_max3_u32 v250, v184, v185, v186
  v_max3_u32 v251, v187, v188, v189
  v_mfma_f32_16x16x32_bf16 v[56:59], v[128:131], v[180:183], v[56:59]
  v_max3_u32 v250, v250, v190, v191
  v_max_u32 v250, v250, v251
  v_mfma_f32_16x16x32_bf16 v[36:39], v[132:135], v[176:179], v[36:39]
  v_cmp_eq_u32 vcc, -1, v250
  v_mfma_f32_16x16x32_bf16 v[60:63], v[132:135], v[180:183], v[60:63]
  s_cbranch_vccnz x3_6
x3_6_b:
  s_waitcnt lgkmcnt(6)
  v_mfma_f32_16x16x32_bf16 v[16:19], v[64:67], v[184:187], v[16:19]
  ds_read_b128 v[112:115], v1 offset:49152
  ds_read_b128 v[116:119], v1 offset:50176
  v_mfma_f32_16x16x32_bf16 v[40:43], v[64:67], v[188:191], v[40:43]
  ds_read_b128 v[120:123], v1 offset:51200
  v_mfma_f32_16x16x32_bf16 v[20:23], v[68:71], v[184:187], v[20:23]
  ds_read_b128 v[124:127], v1 offset:52224
  ds_read_b128 v[128:131], v1 offset:53248
  v_mfma_f32_16x16x32_bf16 v[44:47], v[68:71], v[188:191], v[44:47]
  ds_read_b128 v[132:135], v1 offset:54272
  v_mfma_f32_16x16x32_bf16 v[24:27], v[72:75], v[184:187], v[24:27]
  buffer_load_dwordx4 v[176:179], v1, s[4:7], s34 offen offset:2048 sc1
  buffer_load_dwordx4 v[180:183], v1, s[4:7], s35 offen offset:2048 sc1
  v_mfma_f32_16x16x32_bf16 v[48:51], v[72:75], v[188:191], v[48:51]
  s_lshl_b32 s54, s54, 10
  v_mfma_f32_16x16x32_bf16 v[28:31], v[76:79], v[184:187], v[28:31]
  s_lshl_b32 m0, s55, 10
  s_add_u32 s54, s54, 25853952
  v_mfma_f32_16x16x32_bf16 v[52:55], v[76:79], v[188:191], v[52:55]
  buffer_load_dwordx4 v1, s[4:7], s54 offen offset:0 sc1 lds
  v_mfma_f32_16x16x32_bf16 v[32:35], v[80:83], v[184:187], v[32:35]
  s_waitcnt vmcnt(19)
  v_max3_u32 v250, v192, v193, v194
  v_max3_u32 v251, v195, v196, v197
  v_mfma_f32_16x16x32_bf16 v[56:59], v[80:83], v[188:191], v[56:59]
  v_max3_u32 v250, v250, v198, v199
  v_max_u32 v250, v250, v251
  v_mfma_f32_16x16x32_bf16 v[36:39], v[84:87], v[184:187], v[36:39]
  v_cmp_eq_u32 vcc, -1, v250
  v_mfma_f32_16x16x32_bf16 v[60:63], v[84:87], v[188:191], v[60:63]
  s_cbranch_vccnz x3_7
x3_7_b:
  s_waitcnt lgkmcnt(6)
  v_mfma_f32_16x16x32_bf16 v[16:19], v[88:91], v[192:195], v[16:19]
  ds_read_b128 v[64:67], v1 offset:55296
  ds_read_b128 v[68:71], v1 offset:56320
  v_mfma_f32_16x16x32_bf16 v[40:43], v[88:91], v[196:199], v[40:43]
  ds_read_b128 v[72:75], v1 offset:57344
  v_mfma_f32_16x16x32_bf16 v[20:23], v[92:95], v[192:195], v[20:23]
  ds_read_b128 v[76:79], v1 offset:58368
  ds_read_b128 v[80:83], v1 offset:59392
  v_mfma_f32_16x16x32_bf16 v[44:47], v[92:95], v[196:199], v[44:47]
  ds_read_b128 v[84:87], v1 offset:60416
  v_mfma_f32_16x16x32_bf16 v[24:27], v[96:99], v[192:195], v[24:27]
  buffer_load_dwordx4 v[184:187], v1, s[4:7], s34 offen offset:3072 sc1
  buffer_load_dwordx4 v[188:191], v1, s[4:7], s35 offen offset:3072 sc1
  v_mfma_f32_16x16x32_bf16 v[48:51], v[96:99], v[196:199], v[48:51]
  buffer_load_dwordx4 v1, s[4:7], s54 offen offset:1024 sc1 lds
  v_mfma_f32_16x16x32_bf16 v[28:31], v[100:103], v[192:195], v[28:31]
  buffer_load_dwordx4 v1, s[4:7], s54 offen offset:2048 sc1 lds
  buffer_load_dwordx4 v1, s[4:7], s54 offen offset:3072 sc1 lds
  v_mfma_f32_16x16x32_bf16 v[52:55], v[100:103], v[196:199], v[52:55]
  s_add_u32 m0, m0, 4096
  v_mfma_f32_16x16x32_bf16 v[32:35], v[104:107], v[192:195], v[32:35]
  s_waitcnt vmcnt(22)
  v_max3_u32 v250, v200, v201, v202
  v_max3_u32 v251, v203, v204, v205
  v_mfma_f32_16x16x32_bf16 v[56:59], v[104:107], v[196:199], v[56:59]
  v_max3_u32 v250, v250, v206, v207
  v_max_u32 v250, v250, v251
  v_mfma_f32_16x16x32_bf16 v[36:39], v[108:111], v[192:195], v[36:39]
  v_cmp_eq_u32 vcc, -1, v250
  v_mfma_f32_16x16x32_bf16 v[60:63], v[108:111], v[196:199], v[60:63]
  s_cbranch_vccnz x3_8
x3_8_b:
  s_waitcnt lgkmcnt(6)
  v_mfma_f32_16x16x32_bf16 v[16:19], v[112:115], v[200:203], v[16:19]
  ds_read_b128 v[88:91], v1 offset:61440
  ds_read_b128 v[92:95], v1 offset:62464
  v_mfma_f32_16x16x32_bf16 v[40:43], v[112:115], v[204:207], v[40:43]
  ds_read_b128 v[96:99], v1 offset:63488
  ds_read_b128 v[100:103], v1 offset:64512
  v_mfma_f32_16x16x32_bf16 v[20:23], v[116:119], v[200:203], v[20:23]
  ds_read_b128 v[104:107], v3 offset:0
  ds_read_b128 v[108:111], v3 offset:1024
  v_mfma_f32_16x16x32_bf16 v[44:47], v[116:119], v[204:207], v[44:47]
  s_add_u32 s34, s30, 16384
  v_mfma_f32_16x16x32_bf16 v[24:27], v[120:123], v[200:203], v[24:27]
  s_add_u32 s35, s31, 16384
  buffer_load_dwordx4 v[192:195], v1, s[4:7], s34 offen offset:0 sc1
  v_mfma_f32_16x16x32_bf16 v[48:51], v[120:123], v[204:207], v[48:51]
  buffer_load_dwordx4 v[196:199], v1, s[4:7], s35 offen offset:0 sc1
  s_add_u32 s54, s54, 4096
  v_mfma_f32_16x16x32_bf16 v[28:31], v[124:127], v[200:203], v[28:31]
  buffer_load_dwordx4 v1, s[4:7], s54 offen offset:0 sc1 lds
  buffer_load_dwordx4 v1, s[4:7], s54 offen offset:1024 sc1 lds
  v_mfma_f32_16x16x32_bf16 v[52:55], v[124:127], v[204:207], v[52:55]
  buffer_load_dwordx4 v1, s[4:7], s54 offen offset:2048 sc1 lds
  v_mfma_f32_16x16x32_bf16 v[32:35], v[128:131], v[200:203], v[32:35]
  s_waitcnt vmcnt(25)
  v_max3_u32 v250, v136, v137, v138
  v_max3_u32 v251, v139, v140, v141
  v_mfma_f32_16x16x32_bf16 v[56:59], v[128:131], v[204:207], v[56:59]
  v_max3_u32 v250, v250, v142, v143
  v_max_u32 v250, v250, v251
  v_mfma_f32_16x16x32_bf16 v[36:39], v[132:135], v[200:203], v[36:39]
  v_cmp_eq_u32 vcc, -1, v250
  v_mfma_f32_16x16x32_bf16 v[60:63], v[132:135], v[204:207], v[60:63]
  s_cbranch_vccnz x3_9
x3_9_b:
  s_waitcnt lgkmcnt(6)
  v_mfma_f32_16x16x32_bf16 v[16:19], v[64:67], v[136:139], v[16:19]
  ds_read_b128 v[112:115], v3 offset:2048
  ds_read_b128 v[116:119], v3 offset:3072
  v_mfma_f32_16x16x32_bf16 v[40:43], v[64:67], v[140:143], v[40:43]
  ds_read_b128 v[120:123], v3 offset:4096
  ds_read_b128 v[124:127], v3 offset:5120
  v_mfma_f32_16x16x32_bf16 v[20:23], v[68:71], v[136:139], v[20:23]
  ds_read_b128 v[128:131], v3 offset:6144
  v_mfma_f32_16x16x32_bf16 v[44:47], v[68:71], v[140:143], v[44:47]
  ds_read_b128 v[132:135], v3 offset:7168
  buffer_load_dwordx4 v[200:203], v1, s[4:7], s34 offen offset:1024 sc1
  v_mfma_f32_16x16x32_bf16 v[24:27], v[72:75], v[136:139], v[24:27]
  buffer_load_dwordx4 v[204:207], v1, s[4:7], s35 offen offset:1024 sc1
  buffer_load_dwordx4 v1, s[4:7], s54 offen offset:3072 sc1 lds
  v_mfma_f32_16x16x32_bf16 v[48:51], v[72:75], v[140:143], v[48:51]
  s_add_u32 m0, m0, 4096
  v_mfma_f32_16x16x32_bf16 v[28:31], v[76:79], v[136:139], v[28:31]
  s_add_u32 s54, s54, 4096
  buffer_load_dwordx4 v1, s[4:7], s54 offen offset:0 sc1 lds
  v_mfma_f32_16x16x32_bf16 v[52:55], v[76:79], v[140:143], v[52:55]
  buffer_load_dwordx4 v1, s[4:7], s54 offen offset:1024 sc1 lds
  v_mfma_f32_16x16x32_bf16 v[32:35], v[80:83], v[136:139], v[32:35]
  s_waitcnt vmcnt(28)
  v_max3_u32 v250, v144, v145, v146
  v_max3_u32 v251, v147, v148, v149
  v_mfma_f32_16x16x32_bf16 v[56:59], v[80:83], v[140:143], v[56:59]
  v_max3_u32 v250, v250, v150, v151
  v_max_u32 v250, v250, v251
  v_mfma_f32_16x16x32_bf16 v[36:39], v[84:87], v[136:139], v[36:39]
  v_cmp_eq_u32 vcc, -1, v250
  v_mfma_f32_16x16x32_bf16 v[60:63], v[84:87], v[140:143], v[60:63]
  s_cbranch_vccnz x3_10
x3_10_b:
  s_waitcnt lgkmcnt(6)
  s_barrier
  v_mfma_f32_16x16x32_bf16 v[16:19], v[88:91], v[144:147], v[16:19]
  ds_read_b128 v[64:67], v3 offset:8192
  ds_read_b128 v[68:71], v3 offset:9216
  v_mfma_f32_16x16x32_bf16 v[40:43], v[88:91], v[148:151], v[40:43]
  ds_read_b128 v[72:75], v3 offset:10240
  ds_read_b128 v[76:79], v3 offset:11264
  v_mfma_f32_16x16x32_bf16 v[20:23], v[92:95], v[144:147], v[20:23]
  ds_read_b128 v[80:83], v3 offset:12288
  ds_read_b128 v[84:87], v3 offset:13312
  v_mfma_f32_16x16x32_bf16 v[44:47], v[92:95], v[148:151], v[44:47]
  buffer_load_dwordx4 v[136:139], v1, s[4:7], s34 offen offset:2048 sc1
  buffer_load_dwordx4 v[140:143], v1, s[4:7], s35 offen offset:2048 sc1
  v_mfma_f32_16x16x32_bf16 v[24:27], v[96:99], v[144:147], v[24:27]
  s_waitcnt vmcnt(24)
  v_max3_u32 v250, v208, v209, v210
  s_waitcnt vmcnt(23)
  v_max3_u32 v251, v211, v212, v213
  v_mfma_f32_16x16x32_bf16 v[48:51], v[96:99], v[148:151], v[48:51]
  s_waitcnt vmcnt(22)
  v_max3_u32 v250, v250, v214, v215
  v_max_u32 v250, v250, v251
  v_mfma_f32_16x16x32_bf16 v[28:31], v[100:103], v[144:147], v[28:31]
  v_cmp_eq_u32 vcc, -1, v250
  s_cbranch_vccnz ps3
ps3_b:
  v_mfma_f32_16x16x32_bf16 v[52:55], v[100:103], v[148:151], v[52:55]
  s_mul_i32 s54, s25, 240
  s_mul_i32 s55, s3, 15
  v_mfma_f32_16x16x32_bf16 v[32:35], v[104:107], v[144:147], v[32:35]
  s_waitcnt vmcnt(28)
  v_max3_u32 v250, v152, v153, v154
  v_max3_u32 v251, v155, v156, v157
  v_mfma_f32_16x16x32_bf16 v[56:59], v[104:107], v[148:151], v[56:59]
  v_max3_u32 v250, v250, v158, v159
  v_max_u32 v250, v250, v251
  v_mfma_f32_16x16x32_bf16 v[36:39], v[108:111], v[144:147], v[36:39]
  v_cmp_eq_u32 vcc, -1, v250
  v_mfma_f32_16x16x32_bf16 v[60:63], v[108:111], v[148:151], v[60:63]
  s_cbranch_vccnz x3_11
x3_11_b:
  s_waitcnt lgkmcnt(6)
  v_mfma_f32_16x16x32_bf16 v[16:19], v[112:115], v[152:155], v[16:19]
  ds_read_b128 v[88:91], v3 offset:14336
  ds_read_b128 v[92:95], v3 offset:15360
  ds_read_b128 v[96:99], v3 offset:16384
  v_mfma_f32_16x16x32_bf16 v[40:43], v[112:115], v[156:159], v[40:43]
  ds_read_b128 v[100:103], v3 offset:17408
  ds_read_b128 v[104:107], v3 offset:18432
  v_mfma_f32_16x16x32_bf16 v[20:23], v[116:119], v[152:155], v[20:23]
  ds_read_b128 v[108:111], v3 offset:19456
  buffer_load_dwordx4 v[144:147], v1, s[4:7], s34 offen offset:3072 sc1
  v_mfma_f32_16x16x32_bf16 v[44:47], v[116:119], v[156:159], v[44:47]
  buffer_load_dwordx4 v[148:151], v1, s[4:7], s35 offen offset:3072 sc1
  s_add_u32 s54, s54, s55
  v_mfma_f32_16x16x32_bf16 v[24:27], v[120:123], v[152:155], v[24:27]
  s_add_u32 s55, s55, 0
  s_lshl_b32 s54, s54, 10
  v_add_f32 v208, v208, v210
  v_mfma_f32_16x16x32_bf16 v[48:51], v[120:123], v[156:159], v[48:51]
  v_add_f32 v212, v212, v214
  v_mov_b32 v210, v208
  v_mfma_f32_16x16x32_bf16 v[28:31], v[124:127], v[152:155], v[28:31]
  v_mov_b32 v214, v212
  v_add_f32 v209, v209, v211
  v_mfma_f32_16x16x32_bf16 v[52:55], v[124:127], v[156:159], v[52:55]
  v_permlane16_swap_b32 v208, v210
  v_add_f32 v213, v213, v215
  v_mfma_f32_16x16x32_bf16 v[32:35], v[128:131], v[152:155], v[32:35]
  s_waitcnt vmcnt(28)
  v_max3_u32 v250, v160, v161, v162
  v_max3_u32 v251, v163, v164, v165
  v_mfma_f32_16x16x32_bf16 v[56:59], v[128:131], v[156:159], v[56:59]
  v_max3_u32 v250, v250, v166, v167
  v_max_u32 v250, v250, v251
  v_mfma_f32_16x16x32_bf16 v[36:39], v[132:135], v[152:155], v[36:39]
  v_cmp_eq_u32 vcc, -1, v250
  v_mfma_f32_16x16x32_bf16 v[60:63], v[132:135], v[156:159], v[60:63]
  s_cbranch_vccnz x3_12
x3_12_b:
  s_waitcnt lgkmcnt(6)
  v_mfma_f32_16x16x32_bf16 v[16:19], v[64:67], v[160:163], v[16:19]
  ds_read_b128 v[112:115], v3 offset:20480
  ds_read_b128 v[116:119], v3 offset:21504
  v_mfma_f32_16x16x32_bf16 v[40:43], v[64:67], v[164:167], v[40:43]
  ds_read_b128 v[120:123], v3 offset:22528
  ds_read_b128 v[124:127], v3 offset:23552
  v_mfma_f32_16x16x32_bf16 v[20:23], v[68:71], v[160:163], v[20:23]
  ds_read_b128 v[128:131], v3 offset:24576
  ds_read_b128 v[132:135], v3 offset:25600
  v_mfma_f32_16x16x32_bf16 v[44:47], v[68:71], v[164:167], v[44:47]
  s_lshl_b32 m0, s55, 10
  s_add_u32 s54, s54, 25894912
  v_mfma_f32_16x16x32_bf16 v[24:27], v[72:75], v[160:163], v[24:27]
  buffer_load_dwordx4 v1, s[4:7], s54 offen offset:0 sc1 lds
  v_permlane16_swap_b32 v212, v214
  v_mfma_f32_16x16x32_bf16 v[48:51], v[72:75], v[164:167], v[48:51]
  v_add_f32 v208, v208, v210
  v_mov_b32 v211, v209
  v_mfma_f32_16x16x32_bf16 v[28:31], v[76:79], v[160:163], v[28:31]
  v_add_f32 v212, v212, v214
  v_mov_b32 v215, v213
  v_mfma_f32_16x16x32_bf16 v[52:55], v[76:79], v[164:167], v[52:55]
  v_mov_b32 v210, v208
  v_permlane16_swap_b32 v209, v211
  v_mfma_f32_16x16x32_bf16 v[32:35], v[80:83], v[160:163], v[32:35]
  s_waitcnt vmcnt(23)
  v_max3_u32 v250, v168, v169, v170
  v_max3_u32 v251, v171, v172, v173
  v_mfma_f32_16x16x32_bf16 v[56:59], v[80:83], v[164:167], v[56:59]
  v_max3_u32 v250, v250, v174, v175
  v_max_u32 v250, v250, v251
  v_mfma_f32_16x16x32_bf16 v[36:39], v[84:87], v[160:163], v[36:39]
  v_cmp_eq_u32 vcc, -1, v250
  v_mfma_f32_16x16x32_bf16 v[60:63], v[84:87], v[164:167], v[60:63]
  s_cbranch_vccnz x3_13
x3_13_b:
  s_waitcnt lgkmcnt(6)
  v_mfma_f32_16x16x32_bf16 v[16:19], v[88:91], v[168:171], v[16:19]
  ds_read_b128 v[64:67], v3 offset:26624
  ds_read_b128 v[68:71], v3 offset:27648
  v_mfma_f32_16x16x32_bf16 v[40:43], v[88:91], v[172:175], v[40:43]
  ds_read_b128 v[72:75], v3 offset:28672
  ds_read_b128 v[76:79], v3 offset:29696
  v_mfma_f32_16x16x32_bf16 v[20:23], v[92:95], v[168:171], v[20:23]
  ds_read_b128 v[80:83], v3 offset:30720
  ds_read_b128 v[84:87], v3 offset:31744
  v_mfma_f32_16x16x32_bf16 v[44:47], v[92:95], v[172:175], v[44:47]
  buffer_load_dwordx4 v1, s[4:7], s54 offen offset:1024 sc1 lds
  buffer_load_dwordx4 v1, s[4:7], s54 offen offset:2048 sc1 lds
  v_mfma_f32_16x16x32_bf16 v[24:27], v[96:99], v[168:171], v[24:27]
  buffer_load_dwordx4 v1, s[4:7], s54 offen offset:3072 sc1 lds
  v_mov_b32 v214, v212
  v_mfma_f32_16x16x32_bf16 v[48:51], v[96:99], v[172:175], v[48:51]
  v_permlane16_swap_b32 v213, v215
  v_permlane32_swap_b32 v208, v210
  v_mfma_f32_16x16x32_bf16 v[28:31], v[100:103], v[168:171], v[28:31]
  v_add_f32 v209, v209, v211
  v_permlane32_swap_b32 v212, v214
  v_mfma_f32_16x16x32_bf16 v[52:55], v[100:103], v[172:175], v[52:55]
  v_add_f32 v213, v213, v215
  v_mov_b32 v13, 0x3acccccd
  v_mfma_f32_16x16x32_bf16 v[32:35], v[104:107], v[168:171], v[32:35]
  s_waitcnt vmcnt(24)
  v_max3_u32 v250, v176, v177, v178
  v_max3_u32 v251, v179, v180, v181
  v_mfma_f32_16x16x32_bf16 v[56:59], v[104:107], v[172:175], v[56:59]
  v_max3_u32 v250, v250, v182, v183
  v_max_u32 v250, v250, v251
  v_mfma_f32_16x16x32_bf16 v[36:39], v[108:111], v[168:171], v[36:39]
  v_cmp_eq_u32 vcc, -1, v250
  v_mfma_f32_16x16x32_bf16 v[60:63], v[108:111], v[172:175], v[60:63]
  s_cbranch_vccnz x3_14
x3_14_b:
  s_waitcnt lgkmcnt(6)
  v_mfma_f32_16x16x32_bf16 v[16:19], v[112:115], v[176:179], v[16:19]
  ds_read_b128 v[88:91], v3 offset:32768
  ds_read_b128 v[92:95], v3 offset:33792
  ds_read_b128 v[96:99], v3 offset:34816
  v_mfma_f32_16x16x32_bf16 v[40:43], v[112:115], v[180:183], v[40:43]
  ds_read_b128 v[100:103], v3 offset:35840
  ds_read_b128 v[104:107], v3 offset:36864
  v_mfma_f32_16x16x32_bf16 v[20:23], v[116:119], v[176:179], v[20:23]
  ds_read_b128 v[108:111], v3 offset:37888
  buffer_load_dwordx4 v[152:155], v4, s[4:7], s32 offen offset:0 sc1
  buffer_load_dwordx4 v[156:159], v4, s[4:7], s32 offen offset:64 sc1
  v_mfma_f32_16x16x32_bf16 v[44:47], v[116:119], v[180:183], v[44:47]
  buffer_load_dwordx4 v[160:163], v4, s[4:7], s32 offen offset:128 sc1
  s_add_u32 m0, m0, 4096
  v_mfma_f32_16x16x32_bf16 v[24:27], v[120:123], v[176:179], v[24:27]
  s_add_u32 s54, s54, 4096
  buffer_load_dwordx4 v1, s[4:7], s54 offen offset:0 sc1 lds
  v_mfma_f32_16x16x32_bf16 v[48:51], v[120:123], v[180:183], v[48:51]
  v_add_f32 v208, v208, v210
  v_mov_b32 v211, v209
  v_add_f32 v212, v212, v214
  v_mfma_f32_16x16x32_bf16 v[28:31], v[124:127], v[176:179], v[28:31]
  v_mov_b32 v215, v213
  v_permlane32_swap_b32 v209, v211
  v_mfma_f32_16x16x32_bf16 v[52:55], v[124:127], v[180:183], v[52:55]
  v_mul_f32 v208, v13, -v208
  v_permlane32_swap_b32 v213, v215
  v_mfma_f32_16x16x32_bf16 v[32:35], v[128:131], v[176:179], v[32:35]
  s_waitcnt vmcnt(25)
  v_max3_u32 v250, v184, v185, v186
  v_max3_u32 v251, v187, v188, v189
  v_mfma_f32_16x16x32_bf16 v[56:59], v[128:131], v[180:183], v[56:59]
  v_max3_u32 v250, v250, v190, v191
  v_max_u32 v250, v250, v251
  v_mfma_f32_16x16x32_bf16 v[36:39], v[132:135], v[176:179], v[36:39]
  v_cmp_eq_u32 vcc, -1, v250
  v_mfma_f32_16x16x32_bf16 v[60:63], v[132:135], v[180:183], v[60:63]
  s_cbranch_vccnz x3_15
x3_15_b:
  s_waitcnt lgkmcnt(6)
  v_mfma_f32_16x16x32_bf16 v[16:19], v[64:67], v[184:187], v[16:19]
  ds_read_b128 v[112:115], v3 offset:38912
  ds_read_b128 v[116:119], v3 offset:39936
  ds_read_b128 v[120:123], v3 offset:40960
  v_mfma_f32_16x16x32_bf16 v[40:43], v[64:67], v[188:191], v[40:43]
  ds_read_b128 v[124:127], v3 offset:41984
  ds_read_b128 v[128:131], v3 offset:43008
  v_mfma_f32_16x16x32_bf16 v[20:23], v[68:71], v[184:187], v[20:23]
  ds_read_b128 v[132:135], v3 offset:44032
  buffer_load_dwordx4 v[164:167], v4, s[4:7], s32 offen offset:192 sc1
  v_mfma_f32_16x16x32_bf16 v[44:47], v[68:71], v[188:191], v[44:47]
  buffer_load_dwordx4 v[168:171], v4, s[4:7], s32 offen offset:256 sc1
  buffer_load_dwordx4 v[172:175], v4, s[4:7], s32 offen offset:320 sc1
  v_mfma_f32_16x16x32_bf16 v[24:27], v[72:75], v[184:187], v[24:27]
  buffer_load_dwordx4 v1, s[4:7], s54 offen offset:1024 sc1 lds
  buffer_load_dwordx4 v1, s[4:7], s54 offen offset:2048 sc1 lds
  v_mul_f32 v212, v13, -v212
  v_mfma_f32_16x16x32_bf16 v[48:51], v[72:75], v[188:191], v[48:51]
  v_add_f32 v209, v209, v211
  v_mul_f32 v210, v208, v208
  v_mfma_f32_16x16x32_bf16 v[28:31], v[76:79], v[184:187], v[28:31]
  v_add_f32 v213, v213, v215
  v_mul_f32 v214, v212, v212
  v_mfma_f32_16x16x32_bf16 v[52:55], v[76:79], v[188:191], v[52:55]
  v_fma_f32 v209, v209, v13, -v210
  v_fma_f32 v213, v213, v13, -v214
  v_mfma_f32_16x16x32_bf16 v[32:35], v[80:83], v[184:187], v[32:35]
  s_waitcnt vmcnt(25)
  v_max3_u32 v250, v192, v193, v194
  v_max3_u32 v251, v195, v196, v197
  v_mfma_f32_16x16x32_bf16 v[56:59], v[80:83], v[188:191], v[56:59]
  v_max3_u32 v250, v250, v198, v199
  v_max_u32 v250, v250, v251
  v_mfma_f32_16x16x32_bf16 v[36:39], v[84:87], v[184:187], v[36:39]
  v_cmp_eq_u32 vcc, -1, v250
  v_mfma_f32_16x16x32_bf16 v[60:63], v[84:87], v[188:191], v[60:63]
  s_cbranch_vccnz x3_16
x3_16_b:
  s_waitcnt lgkmcnt(6)
  v_mfma_f32_16x16x32_bf16 v[16:19], v[88:91], v[192:195], v[16:19]
  ds_read_b128 v[64:67], v3 offset:45056
  ds_read_b128 v[68:71], v3 offset:46080
  ds_read_b128 v[72:75], v3 offset:47104
  v_mfma_f32_16x16x32_bf16 v[40:43], v[88:91], v[196:199], v[40:43]
  ds_read_b128 v[76:79], v3 offset:48128
  ds_read_b128 v[80:83], v3 offset:49152
  v_mfma_f32_16x16x32_bf16 v[20:23], v[92:95], v[192:195], v[20:23]
  ds_read_b128 v[84:87], v3 offset:50176
  buffer_load_dwordx4 v1, s[4:7], s54 offen offset:3072 sc1 lds
  v_mfma_f32_16x16x32_bf16 v[44:47], v[92:95], v[196:199], v[44:47]
  s_add_u32 m0, m0, 4096
  s_add_u32 s54, s54, 4096
  v_mfma_f32_16x16x32_bf16 v[24:27], v[96:99], v[192:195], v[24:27]
  v_max_f32 v209, 0, v209
  v_max_f32 v213, 0, v213
  v_mfma_f32_16x16x32_bf16 v[48:51], v[96:99], v[196:199], v[48:51]
  v_add_f32 v209, 0x3727c5ac, v209
  v_add_f32 v213, 0x3727c5ac, v213
  v_mfma_f32_16x16x32_bf16 v[28:31], v[100:103], v[192:195], v[28:31]
  v_rsq_f32 v209, v209
  v_rsq_f32 v213, v213
  v_mfma_f32_16x16x32_bf16 v[52:55], v[100:103], v[196:199], v[52:55]
  v_mul_f32 v208, v208, v209
  v_mul_f32 v212, v212, v213
  v_mfma_f32_16x16x32_bf16 v[32:35], v[104:107], v[192:195], v[32:35]
  s_waitcnt vmcnt(21)
  v_max3_u32 v250, v200, v201, v202
  v_max3_u32 v251, v203, v204, v205
  v_mfma_f32_16x16x32_bf16 v[56:59], v[104:107], v[196:199], v[56:59]
  v_max3_u32 v250, v250, v206, v207
  v_max_u32 v250, v250, v251
  v_mfma_f32_16x16x32_bf16 v[36:39], v[108:111], v[192:195], v[36:39]
  v_cmp_eq_u32 vcc, -1, v250
  v_mfma_f32_16x16x32_bf16 v[60:63], v[108:111], v[196:199], v[60:63]
  s_cbranch_vccnz x3_17
x3_17_b:
  s_waitcnt lgkmcnt(6)
  v_mfma_f32_16x16x32_bf16 v[16:19], v[112:115], v[200:203], v[16:19]
  ds_read_b128 v[88:91], v3 offset:51200
  ds_read_b128 v[92:95], v3 offset:52224
  v_mfma_f32_16x16x32_bf16 v[40:43], v[112:115], v[204:207], v[40:43]
  ds_read_b128 v[96:99], v3 offset:53248
  v_mfma_f32_16x16x32_bf16 v[20:23], v[116:119], v[200:203], v[20:23]
  ds_read_b128 v[100:103], v3 offset:54272
  v_mfma_f32_16x16x32_bf16 v[44:47], v[116:119], v[204:207], v[44:47]
  ds_read_b128 v[104:107], v3 offset:55296
  v_mfma_f32_16x16x32_bf16 v[24:27], v[120:123], v[200:203], v[24:27]
  ds_read_b128 v[108:111], v3 offset:56320
  v_mfma_f32_16x16x32_bf16 v[48:51], v[120:123], v[204:207], v[48:51]
  buffer_load_dwordx4 v1, s[4:7], s54 offen offset:0 sc1 lds
  v_mfma_f32_16x16x32_bf16 v[28:31], v[124:127], v[200:203], v[28:31]
  buffer_load_dwordx4 v1, s[4:7], s54 offen offset:1024 sc1 lds
  v_mfma_f32_16x16x32_bf16 v[52:55], v[124:127], v[204:207], v[52:55]
  buffer_load_dwordx4 v1, s[4:7], s54 offen offset:2048 sc1 lds
  v_mfma_f32_16x16x32_bf16 v[32:35], v[128:131], v[200:203], v[32:35]
  s_waitcnt vmcnt(19)
  v_max3_u32 v250, v136, v137, v138
  v_max3_u32 v251, v139, v140, v141
  v_mfma_f32_16x16x32_bf16 v[56:59], v[128:131], v[204:207], v[56:59]
  v_max3_u32 v250, v250, v142, v143
  v_max_u32 v250, v250, v251
  v_mfma_f32_16x16x32_bf16 v[36:39], v[132:135], v[200:203], v[36:39]
  v_cmp_eq_u32 vcc, -1, v250
  v_mfma_f32_16x16x32_bf16 v[60:63], v[132:135], v[204:207], v[60:63]
  s_cbranch_vccnz x3_18
x3_18_b:
  s_waitcnt lgkmcnt(6)
  v_mfma_f32_16x16x32_bf16 v[16:19], v[64:67], v[136:139], v[16:19]
  buffer_load_dwordx4 v1, s[4:7], s54 offen offset:3072 sc1 lds
  v_mfma_f32_16x16x32_bf16 v[40:43], v[64:67], v[140:143], v[40:43]
  v_mfma_f32_16x16x32_bf16 v[20:23], v[68:71], v[136:139], v[20:23]
  s_add_u32 m0, m0, 4096
  v_mfma_f32_16x16x32_bf16 v[44:47], v[68:71], v[140:143], v[44:47]
  v_mfma_f32_16x16x32_bf16 v[24:27], v[72:75], v[136:139], v[24:27]
  v_mfma_f32_16x16x32_bf16 v[48:51], v[72:75], v[140:143], v[48:51]
  s_add_u32 s54, s54, 4096
  v_mfma_f32_16x16x32_bf16 v[28:31], v[76:79], v[136:139], v[28:31]
  v_mfma_f32_16x16x32_bf16 v[52:55], v[76:79], v[140:143], v[52:55]
  v_mfma_f32_16x16x32_bf16 v[32:35], v[80:83], v[136:139], v[32:35]
  s_waitcnt vmcnt(18)
  v_max3_u32 v250, v144, v145, v146
  v_max3_u32 v251, v147, v148, v149
  v_mfma_f32_16x16x32_bf16 v[56:59], v[80:83], v[140:143], v[56:59]
  v_max3_u32 v250, v250, v150, v151
  v_max_u32 v250, v250, v251
  v_mfma_f32_16x16x32_bf16 v[36:39], v[84:87], v[136:139], v[36:39]
  v_cmp_eq_u32 vcc, -1, v250
  v_mfma_f32_16x16x32_bf16 v[60:63], v[84:87], v[140:143], v[60:63]
  s_cbranch_vccnz x3_19
x3_19_b:
  s_waitcnt lgkmcnt(0)
  v_mfma_f32_16x16x32_bf16 v[16:19], v[88:91], v[144:147], v[16:19]
  buffer_load_dwordx4 v1, s[4:7], s54 offen offset:0 sc1 lds
  v_mfma_f32_16x16x32_bf16 v[40:43], v[88:91], v[148:151], v[40:43]
  v_mfma_f32_16x16x32_bf16 v[20:23], v[92:95], v[144:147], v[20:23]
  v_mfma_f32_16x16x32_bf16 v[44:47], v[92:95], v[148:151], v[44:47]
  v_mfma_f32_16x16x32_bf16 v[24:27], v[96:99], v[144:147], v[24:27]
  buffer_load_dwordx4 v1, s[4:7], s54 offen offset:1024 sc1 lds
  v_mfma_f32_16x16x32_bf16 v[48:51], v[96:99], v[148:151], v[48:51]
  v_mfma_f32_16x16x32_bf16 v[28:31], v[100:103], v[144:147], v[28:31]
  v_mfma_f32_16x16x32_bf16 v[52:55], v[100:103], v[148:151], v[52:55]
  v_mfma_f32_16x16x32_bf16 v[32:35], v[104:107], v[144:147], v[32:35]
  buffer_load_dwordx4 v1, s[4:7], s54 offen offset:2048 sc1 lds
  v_mfma_f32_16x16x32_bf16 v[56:59], v[104:107], v[148:151], v[56:59]
  v_mfma_f32_16x16x32_bf16 v[36:39], v[108:111], v[144:147], v[36:39]
  v_mfma_f32_16x16x32_bf16 v[60:63], v[108:111], v[148:151], v[60:63]
  s_barrier
  v_mov_b32 v8, 0xc0135761
  v_mov_b32 v9, 0xbdd2d3e8
  v_mov_b32 v10, 1.0
  s_mul_i32 s30, s52, 49152
  s_mul_i32 s31, s53, 3072
  s_add_u32 s30, s30, s31
  s_add_u32 s30, s30, 13238272
  s_add_u32 s31, s30, 49152
  s_mul_i32 s28, s51, 3072
  s_add_u32 s28, s28, 13238272
  s_mul_i32 s36, s24, 49152
  s_add_u32 s36, s36, s28
  s_xor_b32 s37, s24, 1
  s_mul_i32 s37, s37, 49152
  s_add_u32 s37, s37, s28
  s_waitcnt vmcnt(16)
  v_pk_mul_f32 v[88:89], v[152:153], v[208:209] op_sel_hi:[1,0]
  v_pk_mul_f32 v[90:91], v[154:155], v[208:209] op_sel_hi:[1,0]
  s_waitcnt vmcnt(15)
  v_pk_mul_f32 v[92:93], v[156:157], v[208:209] op_sel_hi:[1,0]
  v_pk_mul_f32 v[94:95], v[158:159], v[208:209] op_sel_hi:[1,0]
  s_mul_i32 s54, s25, 240
  v_pk_mul_f32 v[96:97], v[152:153], v[212:213] op_sel_hi:[1,0]
  v_pk_mul_f32 v[98:99], v[154:155], v[212:213] op_sel_hi:[1,0]
  v_pk_mul_f32 v[100:101], v[156:157], v[212:213] op_sel_hi:[1,0]
  s_mul_i32 s55, s3, 15
  v_pk_mul_f32 v[102:103], v[158:159], v[212:213] op_sel_hi:[1,0]
  v_pk_fma_f32 v[16:17], v[16:17], v[208:209], v[88:89] op_sel:[0,1,0] op_sel_hi:[1,1,1]
  v_pk_fma_f32 v[18:19], v[18:19], v[208:209], v[90:91] op_sel:[0,1,0] op_sel_hi:[1,1,1]
  s_add_u32 s54, s54, s55
  v_pk_fma_f32 v[20:21], v[20:21], v[208:209], v[92:93] op_sel:[0,1,0] op_sel_hi:[1,1,1]
  v_pk_fma_f32 v[22:23], v[22:23], v[208:209], v[94:95] op_sel:[0,1,0] op_sel_hi:[1,1,1]
  v_pk_fma_f32 v[40:41], v[40:41], v[212:213], v[96:97] op_sel:[0,1,0] op_sel_hi:[1,1,1]
  s_add_u32 s55, s55, 60
  v_pk_fma_f32 v[42:43], v[42:43], v[212:213], v[98:99] op_sel:[0,1,0] op_sel_hi:[1,1,1]
  v_pk_fma_f32 v[44:45], v[44:45], v[212:213], v[100:101] op_sel:[0,1,0] op_sel_hi:[1,1,1]
  v_pk_fma_f32 v[46:47], v[46:47], v[212:213], v[102:103] op_sel:[0,1,0] op_sel_hi:[1,1,1]
  s_lshl_b32 s54, s54, 10
  v_pk_mul_f32 v[88:89], v[16:17], v[16:17]
  v_pk_mul_f32 v[90:91], v[18:19], v[18:19]
  v_pk_mul_f32 v[92:93], v[20:21], v[20:21]
  s_lshl_b32 m0, s55, 10
  v_pk_mul_f32 v[94:95], v[22:23], v[22:23]
  v_pk_mul_f32 v[96:97], v[40:41], v[40:41]
  v_pk_mul_f32 v[98:99], v[42:43], v[42:43]
  s_add_u32 s54, s54, 25956352
  v_pk_mul_f32 v[100:101], v[44:45], v[44:45]
  v_pk_mul_f32 v[102:103], v[46:47], v[46:47]
  v_pk_fma_f32 v[88:89], v[88:89], v[8:9], v[8:9] op_sel:[0,1,0] op_sel_hi:[1,1,0]
  v_pk_fma_f32 v[90:91], v[90:91], v[8:9], v[8:9] op_sel:[0,1,0] op_sel_hi:[1,1,0]
  buffer_load_dwordx4 v1, s[4:7], s54 offen offset:0 sc1 lds
  v_pk_fma_f32 v[92:93], v[92:93], v[8:9], v[8:9] op_sel:[0,1,0] op_sel_hi:[1,1,0]
  v_pk_fma_f32 v[94:95], v[94:95], v[8:9], v[8:9] op_sel:[0,1,0] op_sel_hi:[1,1,0]
  v_pk_fma_f32 v[96:97], v[96:97], v[8:9], v[8:9] op_sel:[0,1,0] op_sel_hi:[1,1,0]
  buffer_load_dwordx4 v1, s[4:7], s54 offen offset:1024 sc1 lds
  v_pk_fma_f32 v[98:99], v[98:99], v[8:9], v[8:9] op_sel:[0,1,0] op_sel_hi:[1,1,0]
  v_pk_fma_f32 v[100:101], v[100:101], v[8:9], v[8:9] op_sel:[0,1,0] op_sel_hi:[1,1,0]
  v_pk_fma_f32 v[102:103], v[102:103], v[8:9], v[8:9] op_sel:[0,1,0] op_sel_hi:[1,1,0]
  buffer_load_dwordx4 v1, s[4:7], s54 offen offset:2048 sc1 lds
  v_pk_mul_f32 v[88:89], v[88:89], v[16:17]
  v_pk_mul_f32 v[90:91], v[90:91], v[18:19]
  v_pk_mul_f32 v[92:93], v[92:93], v[20:21]
  buffer_load_dwordx4 v1, s[4:7], s54 offen offset:3072 sc1 lds
  v_pk_mul_f32 v[94:95], v[94:95], v[22:23]
  v_pk_mul_f32 v[96:97], v[96:97], v[40:41]
  v_pk_mul_f32 v[98:99], v[98:99], v[42:43]
  s_add_u32 m0, m0, 4096
  v_pk_mul_f32 v[100:101], v[100:101], v[44:45]
  v_pk_mul_f32 v[102:103], v[102:103], v[46:47]
  v_exp_f32 v88, v88
  s_add_u32 s54, s54, 4096
  v_exp_f32 v89, v89
  v_exp_f32 v90, v90
  v_exp_f32 v91, v91
  buffer_load_dwordx4 v1, s[4:7], s54 offen offset:0 sc1 lds
  v_exp_f32 v92, v92
  v_exp_f32 v93, v93
  v_exp_f32 v94, v94
  v_exp_f32 v95, v95
  buffer_load_dwordx4 v1, s[4:7], s54 offen offset:1024 sc1 lds
  v_exp_f32 v96, v96
  v_exp_f32 v97, v97
  v_exp_f32 v98, v98
  buffer_load_dwordx4 v1, s[4:7], s54 offen offset:2048 sc1 lds
  v_exp_f32 v99, v99
  v_exp_f32 v100, v100
  v_exp_f32 v101, v101
  buffer_load_dwordx4 v1, s[4:7], s54 offen offset:3072 sc1 lds
  v_exp_f32 v102, v102
  v_exp_f32 v103, v103
  v_pk_add_f32 v[88:89], v[88:89], v[10:11] op_sel_hi:[1,0]
  s_add_u32 m0, m0, 4096
  v_pk_add_f32 v[90:91], v[90:91], v[10:11] op_sel_hi:[1,0]
  v_pk_add_f32 v[92:93], v[92:93], v[10:11] op_sel_hi:[1,0]
  v_pk_add_f32 v[94:95], v[94:95], v[10:11] op_sel_hi:[1,0]
  s_add_u32 s54, s54, 4096
  v_pk_add_f32 v[96:97], v[96:97], v[10:11] op_sel_hi:[1,0]
  v_pk_add_f32 v[98:99], v[98:99], v[10:11] op_sel_hi:[1,0]
  v_pk_add_f32 v[100:101], v[100:101], v[10:11] op_sel_hi:[1,0]
  buffer_load_dwordx4 v1, s[4:7], s54 offen offset:0 sc1 lds
  v_pk_add_f32 v[102:103], v[102:103], v[10:11] op_sel_hi:[1,0]
  v_rcp_f32 v88, v88
  v_rcp_f32 v89, v89
  buffer_load_dwordx4 v1, s[4:7], s54 offen offset:1024 sc1 lds
  v_rcp_f32 v90, v90
  v_rcp_f32 v91, v91
  v_rcp_f32 v92, v92
  v_rcp_f32 v93, v93
  buffer_load_dwordx4 v1, s[4:7], s54 offen offset:2048 sc1 lds
  v_rcp_f32 v94, v94
  v_rcp_f32 v95, v95
  v_rcp_f32 v96, v96
  buffer_load_dwordx4 v1, s[4:7], s54 offen offset:3072 sc1 lds
  v_rcp_f32 v97, v97
  v_rcp_f32 v98, v98
  v_rcp_f32 v99, v99
  s_add_u32 m0, m0, 4096
  v_rcp_f32 v100, v100
  v_rcp_f32 v101, v101
  v_rcp_f32 v102, v102
  s_add_u32 s54, s54, 4096
  v_rcp_f32 v103, v103
  v_pk_mul_f32 v[16:17], v[16:17], v[88:89]
  v_pk_mul_f32 v[18:19], v[18:19], v[90:91]
  buffer_load_dwordx4 v1, s[4:7], s54 offen offset:0 sc1 lds
  v_pk_mul_f32 v[20:21], v[20:21], v[92:93]
  v_pk_mul_f32 v[22:23], v[22:23], v[94:95]
  v_pk_mul_f32 v[40:41], v[40:41], v[96:97]
  buffer_load_dwordx4 v1, s[4:7], s54 offen offset:1024 sc1 lds
  v_pk_mul_f32 v[42:43], v[42:43], v[98:99]
  v_pk_mul_f32 v[44:45], v[44:45], v[100:101]
  v_pk_mul_f32 v[46:47], v[46:47], v[102:103]
  buffer_load_dwordx4 v1, s[4:7], s54 offen offset:2048 sc1 lds
  v_cvt_pk_bf16_f32 v64, v16, v17
  v_cvt_pk_bf16_f32 v65, v18, v19
  v_cvt_pk_bf16_f32 v66, v20, v21
  v_cvt_pk_bf16_f32 v67, v22, v23
  v_cvt_pk_bf16_f32 v76, v40, v41
  v_cvt_pk_bf16_f32 v77, v42, v43
  v_cvt_pk_bf16_f32 v78, v44, v45
  v_cvt_pk_bf16_f32 v79, v46, v47
  buffer_store_dwordx4 v[64:67], v1, s[4:7], s30 offen offset:0 sc1
  buffer_store_dwordx4 v[76:79], v1, s[4:7], s31 offen offset:0 sc1
  s_waitcnt vmcnt(31)
  v_pk_mul_f32 v[88:89], v[160:161], v[208:209] op_sel_hi:[1,0]
  v_pk_mul_f32 v[90:91], v[162:163], v[208:209] op_sel_hi:[1,0]
  s_waitcnt vmcnt(29)
  v_pk_mul_f32 v[92:93], v[164:165], v[208:209] op_sel_hi:[1,0]
  v_pk_mul_f32 v[94:95], v[166:167], v[208:209] op_sel_hi:[1,0]
  v_pk_mul_f32 v[96:97], v[160:161], v[212:213] op_sel_hi:[1,0]
  v_pk_mul_f32 v[98:99], v[162:163], v[212:213] op_sel_hi:[1,0]
  v_pk_mul_f32 v[100:101], v[164:165], v[212:213] op_sel_hi:[1,0]
  v_pk_mul_f32 v[102:103], v[166:167], v[212:213] op_sel_hi:[1,0]
  v_pk_fma_f32 v[24:25], v[24:25], v[208:209], v[88:89] op_sel:[0,1,0] op_sel_hi:[1,1,1]
  v_pk_fma_f32 v[26:27], v[26:27], v[208:209], v[90:91] op_sel:[0,1,0] op_sel_hi:[1,1,1]
  v_pk_fma_f32 v[28:29], v[28:29], v[208:209], v[92:93] op_sel:[0,1,0] op_sel_hi:[1,1,1]
  v_pk_fma_f32 v[30:31], v[30:31], v[208:209], v[94:95] op_sel:[0,1,0] op_sel_hi:[1,1,1]
  v_pk_fma_f32 v[48:49], v[48:49], v[212:213], v[96:97] op_sel:[0,1,0] op_sel_hi:[1,1,1]
  v_pk_fma_f32 v[50:51], v[50:51], v[212:213], v[98:99] op_sel:[0,1,0] op_sel_hi:[1,1,1]
  v_pk_fma_f32 v[52:53], v[52:53], v[212:213], v[100:101] op_sel:[0,1,0] op_sel_hi:[1,1,1]
  v_pk_fma_f32 v[54:55], v[54:55], v[212:213], v[102:103] op_sel:[0,1,0] op_sel_hi:[1,1,1]
  v_pk_mul_f32 v[88:89], v[24:25], v[24:25]
  v_pk_mul_f32 v[90:91], v[26:27], v[26:27]
  v_pk_mul_f32 v[92:93], v[28:29], v[28:29]
  v_pk_mul_f32 v[94:95], v[30:31], v[30:31]
  v_pk_mul_f32 v[96:97], v[48:49], v[48:49]
  v_pk_mul_f32 v[98:99], v[50:51], v[50:51]
  v_pk_mul_f32 v[100:101], v[52:53], v[52:53]
  v_pk_mul_f32 v[102:103], v[54:55], v[54:55]
  v_pk_fma_f32 v[88:89], v[88:89], v[8:9], v[8:9] op_sel:[0,1,0] op_sel_hi:[1,1,0]
  v_pk_fma_f32 v[90:91], v[90:91], v[8:9], v[8:9] op_sel:[0,1,0] op_sel_hi:[1,1,0]
  v_pk_fma_f32 v[92:93], v[92:93], v[8:9], v[8:9] op_sel:[0,1,0] op_sel_hi:[1,1,0]
  v_pk_fma_f32 v[94:95], v[94:95], v[8:9], v[8:9] op_sel:[0,1,0] op_sel_hi:[1,1,0]
  v_pk_fma_f32 v[96:97], v[96:97], v[8:9], v[8:9] op_sel:[0,1,0] op_sel_hi:[1,1,0]
  v_pk_fma_f32 v[98:99], v[98:99], v[8:9], v[8:9] op_sel:[0,1,0] op_sel_hi:[1,1,0]
  v_pk_fma_f32 v[100:101], v[100:101], v[8:9], v[8:9] op_sel:[0,1,0] op_sel_hi:[1,1,0]
  v_pk_fma_f32 v[102:103], v[102:103], v[8:9], v[8:9] op_sel:[0,1,0] op_sel_hi:[1,1,0]
  v_pk_mul_f32 v[88:89], v[88:89], v[24:25]
  v_pk_mul_f32 v[90:91], v[90:91], v[26:27]
  v_pk_mul_f32 v[92:93], v[92:93], v[28:29]
  v_pk_mul_f32 v[94:95], v[94:95], v[30:31]
  v_pk_mul_f32 v[96:97], v[96:97], v[48:49]
  v_pk_mul_f32 v[98:99], v[98:99], v[50:51]
  v_pk_mul_f32 v[100:101], v[100:101], v[52:53]
  v_pk_mul_f32 v[102:103], v[102:103], v[54:55]
  v_exp_f32 v88, v88
  v_exp_f32 v89, v89
  v_exp_f32 v90, v90
  v_exp_f32 v91, v91
  v_exp_f32 v92, v92
  v_exp_f32 v93, v93
  v_exp_f32 v94, v94
  v_exp_f32 v95, v95
  v_exp_f32 v96, v96
  v_exp_f32 v97, v97
  v_exp_f32 v98, v98
  v_exp_f32 v99, v99
  v_exp_f32 v100, v100
  v_exp_f32 v101, v101
  v_exp_f32 v102, v102
  v_exp_f32 v103, v103
  v_pk_add_f32 v[88:89], v[88:89], v[10:11] op_sel_hi:[1,0]
  v_pk_add_f32 v[90:91], v[90:91], v[10:11] op_sel_hi:[1,0]
  v_pk_add_f32 v[92:93], v[92:93], v[10:11] op_sel_hi:[1,0]
  v_pk_add_f32 v[94:95], v[94:95], v[10:11] op_sel_hi:[1,0]
  v_pk_add_f32 v[96:97], v[96:97], v[10:11] op_sel_hi:[1,0]
  v_pk_add_f32 v[98:99], v[98:99], v[10:11] op_sel_hi:[1,0]
  v_pk_add_f32 v[100:101], v[100:101], v[10:11] op_sel_hi:[1,0]
  v_pk_add_f32 v[102:103], v[102:103], v[10:11] op_sel_hi:[1,0]
  v_rcp_f32 v88, v88
  v_rcp_f32 v89, v89
  v_rcp_f32 v90, v90
  v_rcp_f32 v91, v91
  v_rcp_f32 v92, v92
  v_rcp_f32 v93, v93
  v_rcp_f32 v94, v94
  v_rcp_f32 v95, v95
  v_rcp_f32 v96, v96
  v_rcp_f32 v97, v97
  v_rcp_f32 v98, v98
  v_rcp_f32 v99, v99
  v_rcp_f32 v100, v100
  v_rcp_f32 v101, v101
  v_rcp_f32 v102, v102
  v_rcp_f32 v103, v103
  v_pk_mul_f32 v[24:25], v[24:25], v[88:89]
  v_pk_mul_f32 v[26:27], v[26:27], v[90:91]
  v_pk_mul_f32 v[28:29], v[28:29], v[92:93]
  v_pk_mul_f32 v[30:31], v[30:31], v[94:95]
  v_pk_mul_f32 v[48:49], v[48:49], v[96:97]
  v_pk_mul_f32 v[50:51], v[50:51], v[98:99]
  v_pk_mul_f32 v[52:53], v[52:53], v[100:101]
  v_pk_mul_f32 v[54:55], v[54:55], v[102:103]
  v_cvt_pk_bf16_f32 v68, v24, v25
  v_cvt_pk_bf16_f32 v69, v26, v27
  v_cvt_pk_bf16_f32 v70, v28, v29
  v_cvt_pk_bf16_f32 v71, v30, v31
  v_cvt_pk_bf16_f32 v80, v48, v49
  v_cvt_pk_bf16_f32 v81, v50, v51
  v_cvt_pk_bf16_f32 v82, v52, v53
  v_cvt_pk_bf16_f32 v83, v54, v55
  buffer_store_dwordx4 v[68:71], v1, s[4:7], s30 offen offset:1024 sc1
  buffer_store_dwordx4 v[80:83], v1, s[4:7], s31 offen offset:1024 sc1
  s_waitcnt vmcnt(30)
  v_pk_mul_f32 v[88:89], v[168:169], v[208:209] op_sel_hi:[1,0]
  v_pk_mul_f32 v[90:91], v[170:171], v[208:209] op_sel_hi:[1,0]
  s_waitcnt vmcnt(29)
  v_pk_mul_f32 v[92:93], v[172:173], v[208:209] op_sel_hi:[1,0]
  v_pk_mul_f32 v[94:95], v[174:175], v[208:209] op_sel_hi:[1,0]
  v_pk_mul_f32 v[96:97], v[168:169], v[212:213] op_sel_hi:[1,0]
  v_pk_mul_f32 v[98:99], v[170:171], v[212:213] op_sel_hi:[1,0]
  v_pk_mul_f32 v[100:101], v[172:173], v[212:213] op_sel_hi:[1,0]
  v_pk_mul_f32 v[102:103], v[174:175], v[212:213] op_sel_hi:[1,0]
  v_pk_fma_f32 v[32:33], v[32:33], v[208:209], v[88:89] op_sel:[0,1,0] op_sel_hi:[1,1,1]
  v_pk_fma_f32 v[34:35], v[34:35], v[208:209], v[90:91] op_sel:[0,1,0] op_sel_hi:[1,1,1]
  v_pk_fma_f32 v[36:37], v[36:37], v[208:209], v[92:93] op_sel:[0,1,0] op_sel_hi:[1,1,1]
  v_pk_fma_f32 v[38:39], v[38:39], v[208:209], v[94:95] op_sel:[0,1,0] op_sel_hi:[1,1,1]
  v_pk_fma_f32 v[56:57], v[56:57], v[212:213], v[96:97] op_sel:[0,1,0] op_sel_hi:[1,1,1]
  v_pk_fma_f32 v[58:59], v[58:59], v[212:213], v[98:99] op_sel:[0,1,0] op_sel_hi:[1,1,1]
  v_pk_fma_f32 v[60:61], v[60:61], v[212:213], v[100:101] op_sel:[0,1,0] op_sel_hi:[1,1,1]
  v_pk_fma_f32 v[62:63], v[62:63], v[212:213], v[102:103] op_sel:[0,1,0] op_sel_hi:[1,1,1]
  v_pk_mul_f32 v[88:89], v[32:33], v[32:33]
  v_pk_mul_f32 v[90:91], v[34:35], v[34:35]
  v_pk_mul_f32 v[92:93], v[36:37], v[36:37]
  v_pk_mul_f32 v[94:95], v[38:39], v[38:39]
  v_pk_mul_f32 v[96:97], v[56:57], v[56:57]
  v_pk_mul_f32 v[98:99], v[58:59], v[58:59]
  v_pk_mul_f32 v[100:101], v[60:61], v[60:61]
  v_pk_mul_f32 v[102:103], v[62:63], v[62:63]
  v_pk_fma_f32 v[88:89], v[88:89], v[8:9], v[8:9] op_sel:[0,1,0] op_sel_hi:[1,1,0]
  v_pk_fma_f32 v[90:91], v[90:91], v[8:9], v[8:9] op_sel:[0,1,0] op_sel_hi:[1,1,0]
  v_pk_fma_f32 v[92:93], v[92:93], v[8:9], v[8:9] op_sel:[0,1,0] op_sel_hi:[1,1,0]
  v_pk_fma_f32 v[94:95], v[94:95], v[8:9], v[8:9] op_sel:[0,1,0] op_sel_hi:[1,1,0]
  v_pk_fma_f32 v[96:97], v[96:97], v[8:9], v[8:9] op_sel:[0,1,0] op_sel_hi:[1,1,0]
  v_pk_fma_f32 v[98:99], v[98:99], v[8:9], v[8:9] op_sel:[0,1,0] op_sel_hi:[1,1,0]
  v_pk_fma_f32 v[100:101], v[100:101], v[8:9], v[8:9] op_sel:[0,1,0] op_sel_hi:[1,1,0]
  v_pk_fma_f32 v[102:103], v[102:103], v[8:9], v[8:9] op_sel:[0,1,0] op_sel_hi:[1,1,0]
  v_pk_mul_f32 v[88:89], v[88:89], v[32:33]
  v_pk_mul_f32 v[90:91], v[90:91], v[34:35]
  v_pk_mul_f32 v[92:93], v[92:93], v[36:37]
  v_pk_mul_f32 v[94:95], v[94:95], v[38:39]
  v_pk_mul_f32 v[96:97], v[96:97], v[56:57]
  v_pk_mul_f32 v[98:99], v[98:99], v[58:59]
  v_pk_mul_f32 v[100:101], v[100:101], v[60:61]
  v_pk_mul_f32 v[102:103], v[102:103], v[62:63]
  v_exp_f32 v88, v88
  v_exp_f32 v89, v89
  v_exp_f32 v90, v90
  v_exp_f32 v91, v91
  v_exp_f32 v92, v92
  v_exp_f32 v93, v93
  v_exp_f32 v94, v94
  v_exp_f32 v95, v95
  v_exp_f32 v96, v96
  v_exp_f32 v97, v97
  v_exp_f32 v98, v98
  v_exp_f32 v99, v99
  v_exp_f32 v100, v100
  v_exp_f32 v101, v101
  v_exp_f32 v102, v102
  v_exp_f32 v103, v103
  v_pk_add_f32 v[88:89], v[88:89], v[10:11] op_sel_hi:[1,0]
  v_pk_add_f32 v[90:91], v[90:91], v[10:11] op_sel_hi:[1,0]
  v_pk_add_f32 v[92:93], v[92:93], v[10:11] op_sel_hi:[1,0]
  v_pk_add_f32 v[94:95], v[94:95], v[10:11] op_sel_hi:[1,0]
  v_pk_add_f32 v[96:97], v[96:97], v[10:11] op_sel_hi:[1,0]
  v_pk_add_f32 v[98:99], v[98:99], v[10:11] op_sel_hi:[1,0]
  v_pk_add_f32 v[100:101], v[100:101], v[10:11] op_sel_hi:[1,0]
  v_pk_add_f32 v[102:103], v[102:103], v[10:11] op_sel_hi:[1,0]
  v_rcp_f32 v88, v88
  v_rcp_f32 v89, v89
  v_rcp_f32 v90, v90
  v_rcp_f32 v91, v91
  v_rcp_f32 v92, v92
  v_rcp_f32 v93, v93
  v_rcp_f32 v94, v94
  v_rcp_f32 v95, v95
  v_rcp_f32 v96, v96
  v_rcp_f32 v97, v97
  v_rcp_f32 v98, v98
  v_rcp_f32 v99, v99
  v_rcp_f32 v100, v100
  v_rcp_f32 v101, v101
  v_rcp_f32 v102, v102
  v_rcp_f32 v103, v103
  v_pk_mul_f32 v[32:33], v[32:33], v[88:89]
  v_pk_mul_f32 v[34:35], v[34:35], v[90:91]
  v_pk_mul_f32 v[36:37], v[36:37], v[92:93]
  v_pk_mul_f32 v[38:39], v[38:39], v[94:95]
  v_pk_mul_f32 v[56:57], v[56:57], v[96:97]
  v_pk_mul_f32 v[58:59], v[58:59], v[98:99]
  v_pk_mul_f32 v[60:61], v[60:61], v[100:101]
  v_pk_mul_f32 v[62:63], v[62:63], v[102:103]
  v_cvt_pk_bf16_f32 v72, v32, v33
  v_cvt_pk_bf16_f32 v73, v34, v35
  v_cvt_pk_bf16_f32 v74, v36, v37
  v_cvt_pk_bf16_f32 v75, v38, v39
  v_cvt_pk_bf16_f32 v84, v56, v57
  v_cvt_pk_bf16_f32 v85, v58, v59
  v_cvt_pk_bf16_f32 v86, v60, v61
  v_cvt_pk_bf16_f32 v87, v62, v63
  buffer_store_dwordx4 v[72:75], v1, s[4:7], s30 offen offset:2048 sc1
  buffer_store_dwordx4 v[84:87], v1, s[4:7], s31 offen offset:2048 sc1
  s_mov_b32 s8, s88
  s_mov_b32 s9, s89
  s_mov_b32 s10, 2621440
  s_mov_b32 s11, 0x20000
  s_mul_i32 s28, s51, 5120
  v_add_u32 v2, s28, v1
  v_add_u32 v3, 65536, v2
  v_add_u32 v15, 131072, v2
  s_mul_i32 s28, s3, 5120
  s_xor_b32 s29, s3, 1
  s_mul_i32 s29, s29, 5120
  s_add_u32 s28, s28, 0
  s_add_u32 s29, s29, 0
  v_add_u32 v9, s28, v1
  v_add_u32 v10, s29, v1
  v_and_b32 v5, 15, v0
  v_mul_u32_u24 v5, 2560, v5
  v_lshrrev_b32 v7, 4, v0
  v_lshl_add_u32 v6, v7, 3, v5
  v_and_b32 v8, 1, v7
  v_lshl_add_u32 v5, v8, 5, v5
  v_lshrrev_b32 v7, 1, v7
  v_lshl_add_u32 v5, v7, 4, v5
  s_lshr_b32 s32, s24, 1
  s_lshl_b32 s32, s32, 5
  s_add_u32 s32, s32, s51
  s_mul_i32 s32, s32, 1280
  s_mul_i32 s33, s25, 160
  s_add_u32 s32, s32, s33
  s_waitcnt vmcnt(0)
  s_barrier
  s_cmp_lg_u32 s3, 0
  s_cbranch_scc1 pb4x_np
  v_mov_b32 v252, s60
  v_mov_b32 v253, 0
  s_mov_b64 exec, 1
  s_lshl_b32 s56, s63, 7
  s_add_u32 s56, s56, 28835840
  buffer_store_dword v252, v253, s[4:7], s56 offen sc1
  s_mov_b64 exec, -1
pb4x_np:
  s_cmp_lg_u32 s3, 1
  s_cbranch_scc1 p4_skip
  s_and_b32 s56, s62, 0xf0
  s_sub_u32 s95, s63, s56
  s_lshl_b32 s56, s56, 7
  s_add_u32 s56, s56, 28835840
  v_lshlrev_b32 v253, 7, v0
  s_mov_b64 s[58:59], 0xffff
  s_cmp_lt_u32 s95, 64
  s_cselect_b32 s57, 1, 0
  s_mov_b32 s61, 0
  s_and_b32 s95, s95, 63
  s_mov_b32 s96, s57
  s_mov_b32 s97, 0
  s_lshl_b64 s[96:97], s[96:97], s95
  s_andn2_b64 s[58:59], s[58:59], s[96:97]
  s_mov_b64 exec, s[58:59]
  s_mov_b32 s61, 65536
p4_loop:
  buffer_load_dword v254, v253, s[4:7], s56 offen sc1
  s_waitcnt vmcnt(0)
  v_xor_b32 v254, s60, v254
  v_cmp_ne_u32 vcc, 0, v254
  s_sub_u32 s61, s61, 1
  s_cbranch_scc1 p4_out
  s_cbranch_vccz p4_out
  s_branch p4_loop
p4_out:
  s_mov_b64 exec, -1
p4_skip:
  s_waitcnt vmcnt(0)
  s_barrier
  s_mov_b32 s61, 65536
  ds_read_b128 v[36:39], v3 offset:57344
  ds_read_b128 v[40:43], v3 offset:58368
  ds_read_b128 v[44:47], v3 offset:59392
  ds_read_b128 v[48:51], v3 offset:60416
  ds_read_b128 v[52:55], v3 offset:61440
  ds_read_b128 v[56:59], v15 offset:2048
  ds_read_b128 v[60:63], v15 offset:3072
  ds_read_b128 v[64:67], v15 offset:4096
  ds_read_b128 v[68:71], v15 offset:5120
  ds_read_b128 v[72:75], v15 offset:6144
  s_mov_b32 s34, s36
  s_mov_b32 s35, s37
  buffer_load_dwordx4 v[104:107], v1, s[4:7], s34 offen offset:0 sc1
  buffer_load_dwordx4 v[108:111], v1, s[4:7], s35 offen offset:0 sc1
  s_add_u32 s34, s36, 4096
  s_add_u32 s35, s37, 4096
  buffer_load_dwordx4 v[112:115], v1, s[4:7], s34 offen offset:2048 sc1
  buffer_load_dwordx4 v[116:119], v1, s[4:7], s35 offen offset:2048 sc1
  s_add_u32 s34, s36, 12288
  s_add_u32 s35, s37, 12288
  buffer_load_dwordx4 v[120:123], v1, s[4:7], s34 offen offset:0 sc1
  buffer_load_dwordx4 v[124:127], v1, s[4:7], s35 offen offset:0 sc1
  s_add_u32 s34, s36, 16384
  s_add_u32 s35, s37, 16384
  buffer_load_dwordx4 v[128:131], v1, s[4:7], s34 offen offset:2048 sc1
  buffer_load_dwordx4 v[132:135], v1, s[4:7], s35 offen offset:2048 sc1
  s_add_u32 s34, s36, 24576
  s_add_u32 s35, s37, 24576
  buffer_load_dwordx4 v[136:139], v1, s[4:7], s34 offen offset:0 sc1
  buffer_load_dwordx4 v[140:143], v1, s[4:7], s35 offen offset:0 sc1
  s_add_u32 s34, s36, 28672
  s_add_u32 s35, s37, 28672
  buffer_load_dwordx4 v[144:147], v1, s[4:7], s34 offen offset:2048 sc1
  buffer_load_dwordx4 v[148:151], v1, s[4:7], s35 offen offset:2048 sc1
  s_add_u32 s34, s36, 36864
  s_add_u32 s35, s37, 36864
  buffer_load_dwordx4 v[152:155], v1, s[4:7], s34 offen offset:0 sc1
  buffer_load_dwordx4 v[156:159], v1, s[4:7], s35 offen offset:0 sc1
  s_add_u32 s34, s36, 40960
  s_add_u32 s35, s37, 40960
  buffer_load_dwordx4 v[160:163], v1, s[4:7], s34 offen offset:2048 sc1
  buffer_load_dwordx4 v[164:167], v1, s[4:7], s35 offen offset:2048 sc1
  s_add_u32 s34, s36, 0
  s_add_u32 s35, s37, 0
  buffer_load_dwordx4 v[168:171], v1, s[4:7], s34 offen offset:1024 sc1
  buffer_load_dwordx4 v[172:175], v1, s[4:7], s35 offen offset:1024 sc1
  s_add_u32 s34, s36, 4096
  s_add_u32 s35, s37, 4096
  buffer_load_dwordx4 v[176:179], v1, s[4:7], s34 offen offset:3072 sc1
  buffer_load_dwordx4 v[180:183], v1, s[4:7], s35 offen offset:3072 sc1
  s_waitcnt vmcnt(18) lgkmcnt(5)
  v_mfma_f32_16x16x32_bf16 v[228:231], v[36:39], v[104:107], v[228:231]
  ds_read_b128 v[76:79], v15 offset:12288
  v_mfma_f32_16x16x32_bf16 v[16:19], v[36:39], v[108:111], 0
  ds_read_b128 v[80:83], v15 offset:13312
  v_mfma_f32_16x16x32_bf16 v[232:235], v[40:43], v[104:107], v[232:235]
  ds_read_b128 v[84:87], v15 offset:14336
  v_mfma_f32_16x16x32_bf16 v[20:23], v[40:43], v[108:111], 0
  ds_read_b128 v[88:91], v15 offset:15360
  v_mfma_f32_16x16x32_bf16 v[236:239], v[44:47], v[104:107], v[236:239]
  ds_read_b128 v[92:95], v15 offset:16384
  v_mfma_f32_16x16x32_bf16 v[24:27], v[44:47], v[108:111], 0
  s_add_u32 s34, s36, 12288
  v_mfma_f32_16x16x32_bf16 v[240:243], v[48:51], v[104:107], v[240:243]
  s_add_u32 s35, s37, 12288
  v_mfma_f32_16x16x32_bf16 v[28:31], v[48:51], v[108:111], 0
  buffer_load_dwordx4 v[184:187], v1, s[4:7], s34 offen offset:1024 sc1
  v_mfma_f32_16x16x32_bf16 v[244:247], v[52:55], v[104:107], v[244:247]
  buffer_load_dwordx4 v[188:191], v1, s[4:7], s35 offen offset:1024 sc1
  v_mfma_f32_16x16x32_bf16 v[32:35], v[52:55], v[108:111], 0
  s_waitcnt vmcnt(18) lgkmcnt(5)
  v_mfma_f32_16x16x32_bf16 v[228:231], v[56:59], v[112:115], v[228:231]
  ds_read_b128 v[36:39], v15 offset:22528
  ds_read_b128 v[40:43], v15 offset:23552
  v_mfma_f32_16x16x32_bf16 v[16:19], v[56:59], v[116:119], v[16:19]
  ds_read_b128 v[44:47], v15 offset:24576
  v_mfma_f32_16x16x32_bf16 v[232:235], v[60:63], v[112:115], v[232:235]
  ds_read_b128 v[48:51], v15 offset:25600
  v_mfma_f32_16x16x32_bf16 v[20:23], v[60:63], v[116:119], v[20:23]
  ds_read_b128 v[52:55], v15 offset:26624
  s_add_u32 s34, s36, 16384
  v_mfma_f32_16x16x32_bf16 v[236:239], v[64:67], v[112:115], v[236:239]
  s_add_u32 s35, s37, 16384
  v_mfma_f32_16x16x32_bf16 v[24:27], v[64:67], v[116:119], v[24:27]
  buffer_load_dwordx4 v[192:195], v1, s[4:7], s34 offen offset:3072 sc1
  v_mfma_f32_16x16x32_bf16 v[240:243], v[68:71], v[112:115], v[240:243]
  buffer_load_dwordx4 v[196:199], v1, s[4:7], s35 offen offset:3072 sc1
  s_add_u32 s34, s36, 24576
  v_mfma_f32_16x16x32_bf16 v[28:31], v[68:71], v[116:119], v[28:31]
  s_add_u32 s35, s37, 24576
  v_mfma_f32_16x16x32_bf16 v[244:247], v[72:75], v[112:115], v[244:247]
  buffer_load_dwordx4 v[200:203], v1, s[4:7], s34 offen offset:1024 sc1
  v_mfma_f32_16x16x32_bf16 v[32:35], v[72:75], v[116:119], v[32:35]
  buffer_load_dwordx4 v[204:207], v1, s[4:7], s35 offen offset:1024 sc1
  s_waitcnt vmcnt(20) lgkmcnt(5)
  v_mfma_f32_16x16x32_bf16 v[228:231], v[76:79], v[120:123], v[228:231]
  ds_read_b128 v[56:59], v2 offset:0
  v_mfma_f32_16x16x32_bf16 v[16:19], v[76:79], v[124:127], v[16:19]
  ds_read_b128 v[60:63], v2 offset:1024
  v_mfma_f32_16x16x32_bf16 v[232:235], v[80:83], v[120:123], v[232:235]
  ds_read_b128 v[64:67], v2 offset:2048
  v_mfma_f32_16x16x32_bf16 v[20:23], v[80:83], v[124:127], v[20:23]
  ds_read_b128 v[68:71], v2 offset:3072
  v_mfma_f32_16x16x32_bf16 v[236:239], v[84:87], v[120:123], v[236:239]
  ds_read_b128 v[72:75], v2 offset:4096
  v_mfma_f32_16x16x32_bf16 v[24:27], v[84:87], v[124:127], v[24:27]
  s_add_u32 s34, s36, 28672
  v_mfma_f32_16x16x32_bf16 v[240:243], v[88:91], v[120:123], v[240:243]
  s_add_u32 s35, s37, 28672
  v_mfma_f32_16x16x32_bf16 v[28:31], v[88:91], v[124:127], v[28:31]
  buffer_load_dwordx4 v[208:211], v1, s[4:7], s34 offen offset:3072 sc1
  v_mfma_f32_16x16x32_bf16 v[244:247], v[92:95], v[120:123], v[244:247]
  buffer_load_dwordx4 v[212:215], v1, s[4:7], s35 offen offset:3072 sc1
  v_mfma_f32_16x16x32_bf16 v[32:35], v[92:95], v[124:127], v[32:35]
  s_waitcnt vmcnt(20) lgkmcnt(5)
  s_barrier
  v_mfma_f32_16x16x32_bf16 v[228:231], v[36:39], v[128:131], v[228:231]
  ds_read_b128 v[76:79], v2 offset:10240
  ds_read_b128 v[80:83], v2 offset:11264
  v_mfma_f32_16x16x32_bf16 v[16:19], v[36:39], v[132:135], v[16:19]
  ds_read_b128 v[84:87], v2 offset:12288
  ds_read_b128 v[88:91], v2 offset:13312
  v_mfma_f32_16x16x32_bf16 v[232:235], v[40:43], v[128:131], v[232:235]
  ds_read_b128 v[92:95], v2 offset:14336
  s_mul_i32 s54, s25, 240
  v_mfma_f32_16x16x32_bf16 v[20:23], v[40:43], v[132:135], v[20:23]
  s_mul_i32 s55, s3, 10
  s_add_u32 s54, s54, s55
  v_mfma_f32_16x16x32_bf16 v[236:239], v[44:47], v[128:131], v[236:239]
  s_add_u32 s55, s55, 120
  v_mfma_f32_16x16x32_bf16 v[24:27], v[44:47], v[132:135], v[24:27]
  s_lshl_b32 s54, s54, 10
  s_lshl_b32 m0, s55, 10
  v_mfma_f32_16x16x32_bf16 v[240:243], v[48:51], v[128:131], v[240:243]
  s_add_u32 s54, s54, 26017792
  buffer_load_dwordx4 v1, s[4:7], s54 offen offset:0 sc1 lds
  v_mfma_f32_16x16x32_bf16 v[28:31], v[48:51], v[132:135], v[28:31]
  buffer_load_dwordx4 v1, s[4:7], s54 offen offset:1024 sc1 lds
  buffer_load_dwordx4 v1, s[4:7], s54 offen offset:2048 sc1 lds
  v_mfma_f32_16x16x32_bf16 v[244:247], v[52:55], v[128:131], v[244:247]
  buffer_load_dwordx4 v1, s[4:7], s54 offen offset:3072 sc1 lds
  s_add_u32 m0, m0, 4096
  v_mfma_f32_16x16x32_bf16 v[32:35], v[52:55], v[132:135], v[32:35]
  s_add_u32 s54, s54, 4096
  s_waitcnt vmcnt(22) lgkmcnt(5)
  v_mfma_f32_16x16x32_bf16 v[228:231], v[56:59], v[136:139], v[228:231]
  ds_read_b128 v[36:39], v2 offset:20480
  v_mfma_f32_16x16x32_bf16 v[16:19], v[56:59], v[140:143], v[16:19]
  ds_read_b128 v[40:43], v2 offset:21504
  v_mfma_f32_16x16x32_bf16 v[232:235], v[60:63], v[136:139], v[232:235]
  ds_read_b128 v[44:47], v2 offset:22528
  v_mfma_f32_16x16x32_bf16 v[20:23], v[60:63], v[140:143], v[20:23]
  v_mfma_f32_16x16x32_bf16 v[236:239], v[64:67], v[136:139], v[236:239]
  ds_read_b128 v[48:51], v2 offset:23552
  v_mfma_f32_16x16x32_bf16 v[24:27], v[64:67], v[140:143], v[24:27]
  ds_read_b128 v[52:55], v2 offset:24576
  v_mfma_f32_16x16x32_bf16 v[240:243], v[68:71], v[136:139], v[240:243]
  v_mfma_f32_16x16x32_bf16 v[28:31], v[68:71], v[140:143], v[28:31]
  buffer_load_dwordx4 v1, s[4:7], s54 offen offset:0 sc1 lds
  v_mfma_f32_16x16x32_bf16 v[244:247], v[72:75], v[136:139], v[244:247]
  buffer_load_dwordx4 v1, s[4:7], s54 offen offset:1024 sc1 lds
  v_mfma_f32_16x16x32_bf16 v[32:35], v[72:75], v[140:143], v[32:35]
  s_waitcnt vmcnt(22) lgkmcnt(5)
  v_mfma_f32_16x16x32_bf16 v[228:231], v[76:79], v[144:147], v[228:231]
  ds_read_b128 v[56:59], v2 offset:30720
  v_mfma_f32_16x16x32_bf16 v[16:19], v[76:79], v[148:151], v[16:19]
  ds_read_b128 v[60:63], v2 offset:31744
  v_mfma_f32_16x16x32_bf16 v[232:235], v[80:83], v[144:147], v[232:235]
  ds_read_b128 v[64:67], v2 offset:32768
  v_mfma_f32_16x16x32_bf16 v[20:23], v[80:83], v[148:151], v[20:23]
  ds_read_b128 v[68:71], v2 offset:33792
  v_mfma_f32_16x16x32_bf16 v[236:239], v[84:87], v[144:147], v[236:239]
  ds_read_b128 v[72:75], v2 offset:34816
  v_mfma_f32_16x16x32_bf16 v[24:27], v[84:87], v[148:151], v[24:27]
  buffer_load_dwordx4 v1, s[4:7], s54 offen offset:2048 sc1 lds
  v_mfma_f32_16x16x32_bf16 v[240:243], v[88:91], v[144:147], v[240:243]
  buffer_load_dwordx4 v1, s[4:7], s54 offen offset:3072 sc1 lds
  v_mfma_f32_16x16x32_bf16 v[28:31], v[88:91], v[148:151], v[28:31]
  s_add_u32 m0, m0, 4096
  v_mfma_f32_16x16x32_bf16 v[244:247], v[92:95], v[144:147], v[244:247]
  s_add_u32 s54, s54, 4096
  v_mfma_f32_16x16x32_bf16 v[32:35], v[92:95], v[148:151], v[32:35]
  buffer_load_dwordx4 v1, s[4:7], s54 offen offset:0 sc1 lds
  s_waitcnt vmcnt(23) lgkmcnt(5)
  v_mfma_f32_16x16x32_bf16 v[228:231], v[36:39], v[152:155], v[228:231]
  ds_read_b128 v[76:79], v2 offset:40960
  ds_read_b128 v[80:83], v2 offset:41984
  v_mfma_f32_16x16x32_bf16 v[16:19], v[36:39], v[156:159], v[16:19]
  ds_read_b128 v[84:87], v2 offset:43008
  v_mfma_f32_16x16x32_bf16 v[232:235], v[40:43], v[152:155], v[232:235]
  ds_read_b128 v[88:91], v2 offset:44032
  v_mfma_f32_16x16x32_bf16 v[20:23], v[40:43], v[156:159], v[20:23]
  ds_read_b128 v[92:95], v2 offset:45056
  v_mfma_f32_16x16x32_bf16 v[236:239], v[44:47], v[152:155], v[236:239]
  buffer_load_dwordx4 v1, s[4:7], s54 offen offset:1024 sc1 lds
  v_mfma_f32_16x16x32_bf16 v[24:27], v[44:47], v[156:159], v[24:27]
  v_mfma_f32_16x16x32_bf16 v[240:243], v[48:51], v[152:155], v[240:243]
  s_add_u32 s34, s36, 36864
  v_mfma_f32_16x16x32_bf16 v[28:31], v[48:51], v[156:159], v[28:31]
  s_add_u32 s35, s37, 36864
  v_mfma_f32_16x16x32_bf16 v[244:247], v[52:55], v[152:155], v[244:247]
  buffer_load_dwordx4 v[104:107], v1, s[4:7], s34 offen offset:1024 sc1
  v_mfma_f32_16x16x32_bf16 v[32:35], v[52:55], v[156:159], v[32:35]
  buffer_load_dwordx4 v[108:111], v1, s[4:7], s35 offen offset:1024 sc1
  s_waitcnt vmcnt(24) lgkmcnt(5)
  s_barrier
  v_mfma_f32_16x16x32_bf16 v[228:231], v[56:59], v[160:163], v[228:231]
  ds_read_b128 v[36:39], v2 offset:51200
  v_mfma_f32_16x16x32_bf16 v[16:19], v[56:59], v[164:167], v[16:19]
  ds_read_b128 v[40:43], v2 offset:52224
  v_mfma_f32_16x16x32_bf16 v[232:235], v[60:63], v[160:163], v[232:235]
  ds_read_b128 v[44:47], v2 offset:53248
  v_mfma_f32_16x16x32_bf16 v[20:23], v[60:63], v[164:167], v[20:23]
  ds_read_b128 v[48:51], v2 offset:54272
  v_mfma_f32_16x16x32_bf16 v[236:239], v[64:67], v[160:163], v[236:239]
  ds_read_b128 v[52:55], v2 offset:55296
  v_mfma_f32_16x16x32_bf16 v[24:27], v[64:67], v[164:167], v[24:27]
  s_add_u32 s34, s36, 40960
  v_mfma_f32_16x16x32_bf16 v[240:243], v[68:71], v[160:163], v[240:243]
  s_add_u32 s35, s37, 40960
  v_mfma_f32_16x16x32_bf16 v[28:31], v[68:71], v[164:167], v[28:31]
  buffer_load_dwordx4 v[112:115], v1, s[4:7], s34 offen offset:3072 sc1
  v_mfma_f32_16x16x32_bf16 v[244:247], v[72:75], v[160:163], v[244:247]
  buffer_load_dwordx4 v[116:119], v1, s[4:7], s35 offen offset:3072 sc1
  v_mfma_f32_16x16x32_bf16 v[32:35], v[72:75], v[164:167], v[32:35]
  s_waitcnt vmcnt(24) lgkmcnt(5)
  v_mfma_f32_16x16x32_bf16 v[228:231], v[76:79], v[168:171], v[228:231]
  ds_read_b128 v[56:59], v2 offset:61440
  ds_read_b128 v[60:63], v2 offset:62464
  v_mfma_f32_16x16x32_bf16 v[16:19], v[76:79], v[172:175], v[16:19]
  ds_read_b128 v[64:67], v2 offset:63488
  ds_read_b128 v[68:71], v2 offset:64512
  v_mfma_f32_16x16x32_bf16 v[232:235], v[80:83], v[168:171], v[232:235]
  ds_read_b128 v[72:75], v3 offset:0
  s_add_u32 s34, s36, 0
  v_mfma_f32_16x16x32_bf16 v[20:23], v[80:83], v[172:175], v[20:23]
  s_add_u32 s35, s37, 0
  buffer_load_dwordx4 v[120:123], v1, s[4:7], s34 offen offset:2048 sc1
  v_mfma_f32_16x16x32_bf16 v[236:239], v[84:87], v[168:171], v[236:239]
  buffer_load_dwordx4 v[124:127], v1, s[4:7], s35 offen offset:2048 sc1
  s_add_u32 s34, s36, 8192
  v_mfma_f32_16x16x32_bf16 v[24:27], v[84:87], v[172:175], v[24:27]
  s_add_u32 s35, s37, 8192
  buffer_load_dwordx4 v[128:131], v1, s[4:7], s34 offen offset:0 sc1
  v_mfma_f32_16x16x32_bf16 v[240:243], v[88:91], v[168:171], v[240:243]
  buffer_load_dwordx4 v[132:135], v1, s[4:7], s35 offen offset:0 sc1
  s_mul_i32 s54, s25, 240
  v_mfma_f32_16x16x32_bf16 v[28:31], v[88:91], v[172:175], v[28:31]
  s_mul_i32 s55, s3, 10
  s_add_u32 s54, s54, s55
  v_mfma_f32_16x16x32_bf16 v[244:247], v[92:95], v[168:171], v[244:247]
  s_add_u32 s55, s55, 0
  s_lshl_b32 s54, s54, 10
  v_mfma_f32_16x16x32_bf16 v[32:35], v[92:95], v[172:175], v[32:35]
  s_lshl_b32 m0, s55, 10
  s_add_u32 s54, s54, 26058752
  s_waitcnt vmcnt(26) lgkmcnt(5)
  v_mfma_f32_16x16x32_bf16 v[228:231], v[36:39], v[176:179], v[228:231]
  ds_read_b128 v[76:79], v3 offset:6144
  v_mfma_f32_16x16x32_bf16 v[16:19], v[36:39], v[180:183], v[16:19]
  ds_read_b128 v[80:83], v3 offset:7168
  v_mfma_f32_16x16x32_bf16 v[232:235], v[40:43], v[176:179], v[232:235]
  ds_read_b128 v[84:87], v3 offset:8192
  v_mfma_f32_16x16x32_bf16 v[20:23], v[40:43], v[180:183], v[20:23]
  v_mfma_f32_16x16x32_bf16 v[236:239], v[44:47], v[176:179], v[236:239]
  ds_read_b128 v[88:91], v3 offset:9216
  v_mfma_f32_16x16x32_bf16 v[24:27], v[44:47], v[180:183], v[24:27]
  ds_read_b128 v[92:95], v3 offset:10240
  v_mfma_f32_16x16x32_bf16 v[240:243], v[48:51], v[176:179], v[240:243]
  v_mfma_f32_16x16x32_bf16 v[28:31], v[48:51], v[180:183], v[28:31]
  buffer_load_dwordx4 v1, s[4:7], s54 offen offset:0 sc1 lds
  v_mfma_f32_16x16x32_bf16 v[244:247], v[52:55], v[176:179], v[244:247]
  buffer_load_dwordx4 v1, s[4:7], s54 offen offset:1024 sc1 lds
  v_mfma_f32_16x16x32_bf16 v[32:35], v[52:55], v[180:183], v[32:35]
  s_waitcnt vmcnt(26) lgkmcnt(5)
  v_mfma_f32_16x16x32_bf16 v[228:231], v[56:59], v[184:187], v[228:231]
  ds_read_b128 v[36:39], v3 offset:16384
  v_mfma_f32_16x16x32_bf16 v[16:19], v[56:59], v[188:191], v[16:19]
  ds_read_b128 v[40:43], v3 offset:17408
  v_mfma_f32_16x16x32_bf16 v[232:235], v[60:63], v[184:187], v[232:235]
  ds_read_b128 v[44:47], v3 offset:18432
  v_mfma_f32_16x16x32_bf16 v[20:23], v[60:63], v[188:191], v[20:23]
  ds_read_b128 v[48:51], v3 offset:19456
  v_mfma_f32_16x16x32_bf16 v[236:239], v[64:67], v[184:187], v[236:239]
  ds_read_b128 v[52:55], v3 offset:20480
  v_mfma_f32_16x16x32_bf16 v[24:27], v[64:67], v[188:191], v[24:27]
  buffer_load_dwordx4 v1, s[4:7], s54 offen offset:2048 sc1 lds
  v_mfma_f32_16x16x32_bf16 v[240:243], v[68:71], v[184:187], v[240:243]
  buffer_load_dwordx4 v1, s[4:7], s54 offen offset:3072 sc1 lds
  v_mfma_f32_16x16x32_bf16 v[28:31], v[68:71], v[188:191], v[28:31]
  s_add_u32 m0, m0, 4096
  v_mfma_f32_16x16x32_bf16 v[244:247], v[72:75], v[184:187], v[244:247]
  s_add_u32 s54, s54, 4096
  v_mfma_f32_16x16x32_bf16 v[32:35], v[72:75], v[188:191], v[32:35]
  buffer_load_dwordx4 v1, s[4:7], s54 offen offset:0 sc1 lds
  s_waitcnt vmcnt(27) lgkmcnt(5)
  v_mfma_f32_16x16x32_bf16 v[228:231], v[76:79], v[192:195], v[228:231]
  ds_read_b128 v[56:59], v3 offset:26624
  v_mfma_f32_16x16x32_bf16 v[16:19], v[76:79], v[196:199], v[16:19]
  ds_read_b128 v[60:63], v3 offset:27648
  v_mfma_f32_16x16x32_bf16 v[232:235], v[80:83], v[192:195], v[232:235]
  ds_read_b128 v[64:67], v3 offset:28672
  v_mfma_f32_16x16x32_bf16 v[20:23], v[80:83], v[196:199], v[20:23]
  ds_read_b128 v[68:71], v3 offset:29696
  v_mfma_f32_16x16x32_bf16 v[236:239], v[84:87], v[192:195], v[236:239]
  ds_read_b128 v[72:75], v3 offset:30720
  v_mfma_f32_16x16x32_bf16 v[24:27], v[84:87], v[196:199], v[24:27]
  buffer_load_dwordx4 v1, s[4:7], s54 offen offset:1024 sc1 lds
  v_mfma_f32_16x16x32_bf16 v[240:243], v[88:91], v[192:195], v[240:243]
  buffer_load_dwordx4 v1, s[4:7], s54 offen offset:2048 sc1 lds
  v_mfma_f32_16x16x32_bf16 v[28:31], v[88:91], v[196:199], v[28:31]
  buffer_load_dwordx4 v1, s[4:7], s54 offen offset:3072 sc1 lds
  v_mfma_f32_16x16x32_bf16 v[244:247], v[92:95], v[192:195], v[244:247]
  s_add_u32 m0, m0, 4096
  v_mfma_f32_16x16x32_bf16 v[32:35], v[92:95], v[196:199], v[32:35]
  s_add_u32 s54, s54, 4096
  s_waitcnt vmcnt(28) lgkmcnt(5)
  v_mfma_f32_16x16x32_bf16 v[228:231], v[36:39], v[200:203], v[228:231]
  ds_read_b128 v[76:79], v3 offset:36864
  v_mfma_f32_16x16x32_bf16 v[16:19], v[36:39], v[204:207], v[16:19]
  ds_read_b128 v[80:83], v3 offset:37888
  v_mfma_f32_16x16x32_bf16 v[232:235], v[40:43], v[200:203], v[232:235]
  ds_read_b128 v[84:87], v3 offset:38912
  v_mfma_f32_16x16x32_bf16 v[20:23], v[40:43], v[204:207], v[20:23]
  ds_read_b128 v[88:91], v3 offset:39936
  v_mfma_f32_16x16x32_bf16 v[236:239], v[44:47], v[200:203], v[236:239]
  v_mfma_f32_16x16x32_bf16 v[24:27], v[44:47], v[204:207], v[24:27]
  ds_read_b128 v[92:95], v3 offset:40960
  v_mfma_f32_16x16x32_bf16 v[240:243], v[48:51], v[200:203], v[240:243]
  buffer_load_dwordx4 v1, s[4:7], s54 offen offset:0 sc1 lds
  v_mfma_f32_16x16x32_bf16 v[28:31], v[48:51], v[204:207], v[28:31]
  buffer_load_dwordx4 v1, s[4:7], s54 offen offset:1024 sc1 lds
  v_mfma_f32_16x16x32_bf16 v[244:247], v[52:55], v[200:203], v[244:247]
  v_mfma_f32_16x16x32_bf16 v[32:35], v[52:55], v[204:207], v[32:35]
  s_waitcnt vmcnt(28) lgkmcnt(5)
  v_mfma_f32_16x16x32_bf16 v[228:231], v[56:59], v[208:211], v[228:231]
  ds_read_b128 v[36:39], v3 offset:47104
  ds_read_b128 v[40:43], v3 offset:48128
  v_mfma_f32_16x16x32_bf16 v[16:19], v[56:59], v[212:215], v[16:19]
  ds_read_b128 v[44:47], v3 offset:49152
  v_mfma_f32_16x16x32_bf16 v[232:235], v[60:63], v[208:211], v[232:235]
  ds_read_b128 v[48:51], v3 offset:50176
  v_mfma_f32_16x16x32_bf16 v[20:23], v[60:63], v[212:215], v[20:23]
  ds_read_b128 v[52:55], v3 offset:51200
  s_add_u32 s34, s36, 12288
  v_mfma_f32_16x16x32_bf16 v[236:239], v[64:67], v[208:211], v[236:239]
  s_add_u32 s35, s37, 12288
  v_mfma_f32_16x16x32_bf16 v[24:27], v[64:67], v[212:215], v[24:27]
  buffer_load_dwordx4 v[136:139], v1, s[4:7], s34 offen offset:2048 sc1
  v_mfma_f32_16x16x32_bf16 v[240:243], v[68:71], v[208:211], v[240:243]
  buffer_load_dwordx4 v[140:143], v1, s[4:7], s35 offen offset:2048 sc1
  s_add_u32 s34, s36, 20480
  v_mfma_f32_16x16x32_bf16 v[28:31], v[68:71], v[212:215], v[28:31]
  s_add_u32 s35, s37, 20480
  v_mfma_f32_16x16x32_bf16 v[244:247], v[72:75], v[208:211], v[244:247]
  buffer_load_dwordx4 v[144:147], v1, s[4:7], s34 offen offset:0 sc1
  v_mfma_f32_16x16x32_bf16 v[32:35], v[72:75], v[212:215], v[32:35]
  buffer_load_dwordx4 v[148:151], v1, s[4:7], s35 offen offset:0 sc1
  s_waitcnt vmcnt(20) lgkmcnt(5)
  s_waitcnt vmcnt(22)
  s_barrier
  v_mfma_f32_16x16x32_bf16 v[228:231], v[76:79], v[104:107], v[228:231]
  ds_read_b128 v[56:59], v3 offset:57344
  v_mfma_f32_16x16x32_bf16 v[16:19], v[76:79], v[108:111], v[16:19]
  ds_read_b128 v[60:63], v3 offset:58368
  v_mfma_f32_16x16x32_bf16 v[232:235], v[80:83], v[104:107], v[232:235]
  ds_read_b128 v[64:67], v3 offset:59392
  v_mfma_f32_16x16x32_bf16 v[20:23], v[80:83], v[108:111], v[20:23]
  ds_read_b128 v[68:71], v3 offset:60416
  v_mfma_f32_16x16x32_bf16 v[236:239], v[84:87], v[104:107], v[236:239]
  ds_read_b128 v[72:75], v3 offset:61440
  v_mfma_f32_16x16x32_bf16 v[24:27], v[84:87], v[108:111], v[24:27]
  s_add_u32 s34, s36, 24576
  v_mfma_f32_16x16x32_bf16 v[240:243], v[88:91], v[104:107], v[240:243]
  s_add_u32 s35, s37, 24576
  v_mfma_f32_16x16x32_bf16 v[28:31], v[88:91], v[108:111], v[28:31]
  buffer_load_dwordx4 v[152:155], v1, s[4:7], s34 offen offset:2048 sc1
  v_mfma_f32_16x16x32_bf16 v[244:247], v[92:95], v[104:107], v[244:247]
  buffer_load_dwordx4 v[156:159], v1, s[4:7], s35 offen offset:2048 sc1
  v_mfma_f32_16x16x32_bf16 v[32:35], v[92:95], v[108:111], v[32:35]
  s_waitcnt vmcnt(20) lgkmcnt(5)
  v_mfma_f32_16x16x32_bf16 v[228:231], v[36:39], v[112:115], v[228:231]
  ds_read_b128 v[76:79], v15 offset:2048
  v_mfma_f32_16x16x32_bf16 v[16:19], v[36:39], v[116:119], v[16:19]
  ds_read_b128 v[80:83], v15 offset:3072
  v_mfma_f32_16x16x32_bf16 v[232:235], v[40:43], v[112:115], v[232:235]
  ds_read_b128 v[84:87], v15 offset:4096
  v_mfma_f32_16x16x32_bf16 v[20:23], v[40:43], v[116:119], v[20:23]
  ds_read_b128 v[88:91], v15 offset:5120
  v_mfma_f32_16x16x32_bf16 v[236:239], v[44:47], v[112:115], v[236:239]
  ds_read_b128 v[92:95], v15 offset:6144
  v_mfma_f32_16x16x32_bf16 v[24:27], v[44:47], v[116:119], v[24:27]
  s_add_u32 s34, s36, 32768
  v_mfma_f32_16x16x32_bf16 v[240:243], v[48:51], v[112:115], v[240:243]
  s_add_u32 s35, s37, 32768
  v_mfma_f32_16x16x32_bf16 v[28:31], v[48:51], v[116:119], v[28:31]
  buffer_load_dwordx4 v[160:163], v1, s[4:7], s34 offen offset:0 sc1
  v_mfma_f32_16x16x32_bf16 v[244:247], v[52:55], v[112:115], v[244:247]
  buffer_load_dwordx4 v[164:167], v1, s[4:7], s35 offen offset:0 sc1
  v_mfma_f32_16x16x32_bf16 v[32:35], v[52:55], v[116:119], v[32:35]
  s_waitcnt vmcnt(20) lgkmcnt(5)
  v_mfma_f32_16x16x32_bf16 v[228:231], v[56:59], v[120:123], v[228:231]
  ds_read_b128 v[36:39], v15 offset:12288
  ds_read_b128 v[40:43], v15 offset:13312
  v_mfma_f32_16x16x32_bf16 v[16:19], v[56:59], v[124:127], v[16:19]
  ds_read_b128 v[44:47], v15 offset:14336
  v_mfma_f32_16x16x32_bf16 v[232:235], v[60:63], v[120:123], v[232:235]
  ds_read_b128 v[48:51], v15 offset:15360
  v_mfma_f32_16x16x32_bf16 v[20:23], v[60:63], v[124:127], v[20:23]
  ds_read_b128 v[52:55], v15 offset:16384
  s_add_u32 s34, s36, 36864
  v_mfma_f32_16x16x32_bf16 v[236:239], v[64:67], v[120:123], v[236:239]
  s_add_u32 s35, s37, 36864
  v_mfma_f32_16x16x32_bf16 v[24:27], v[64:67], v[124:127], v[24:27]
  buffer_load_dwordx4 v[168:171], v1, s[4:7], s34 offen offset:2048 sc1
  v_mfma_f32_16x16x32_bf16 v[240:243], v[68:71], v[120:123], v[240:243]
  buffer_load_dwordx4 v[172:175], v1, s[4:7], s35 offen offset:2048 sc1
  s_add_u32 s34, s36, 45056
  v_mfma_f32_16x16x32_bf16 v[28:31], v[68:71], v[124:127], v[28:31]
  s_add_u32 s35, s37, 45056
  v_mfma_f32_16x16x32_bf16 v[244:247], v[72:75], v[120:123], v[244:247]
  buffer_load_dwordx4 v[176:179], v1, s[4:7], s34 offen offset:0 sc1
  v_mfma_f32_16x16x32_bf16 v[32:35], v[72:75], v[124:127], v[32:35]
  buffer_load_dwordx4 v[180:183], v1, s[4:7], s35 offen offset:0 sc1
  s_waitcnt vmcnt(22) lgkmcnt(5)
  v_mfma_f32_16x16x32_bf16 v[228:231], v[76:79], v[128:131], v[228:231]
  ds_read_b128 v[56:59], v15 offset:22528
  v_mfma_f32_16x16x32_bf16 v[16:19], v[76:79], v[132:135], v[16:19]
  v_mfma_f32_16x16x32_bf16 v[232:235], v[80:83], v[128:131], v[232:235]
  ds_read_b128 v[60:63], v15 offset:23552
  v_mfma_f32_16x16x32_bf16 v[20:23], v[80:83], v[132:135], v[20:23]
  v_mfma_f32_16x16x32_bf16 v[236:239], v[84:87], v[128:131], v[236:239]
  ds_read_b128 v[64:67], v15 offset:24576
  v_mfma_f32_16x16x32_bf16 v[24:27], v[84:87], v[132:135], v[24:27]
  v_mfma_f32_16x16x32_bf16 v[240:243], v[88:91], v[128:131], v[240:243]
  ds_read_b128 v[68:71], v15 offset:25600
  v_mfma_f32_16x16x32_bf16 v[28:31], v[88:91], v[132:135], v[28:31]
  v_mfma_f32_16x16x32_bf16 v[244:247], v[92:95], v[128:131], v[244:247]
  ds_read_b128 v[72:75], v15 offset:26624
  v_mfma_f32_16x16x32_bf16 v[32:35], v[92:95], v[132:135], v[32:35]
  s_waitcnt vmcnt(10) lgkmcnt(5)
  s_waitcnt vmcnt(12)
  s_barrier
  v_mfma_f32_16x16x32_bf16 v[228:231], v[36:39], v[136:139], v[228:231]
  ds_read_b128 v[76:79], v2 offset:0
  v_mfma_f32_16x16x32_bf16 v[16:19], v[36:39], v[140:143], v[16:19]
  v_mfma_f32_16x16x32_bf16 v[232:235], v[40:43], v[136:139], v[232:235]
  ds_read_b128 v[80:83], v2 offset:1024
  v_mfma_f32_16x16x32_bf16 v[20:23], v[40:43], v[140:143], v[20:23]
  v_mfma_f32_16x16x32_bf16 v[236:239], v[44:47], v[136:139], v[236:239]
  ds_read_b128 v[84:87], v2 offset:2048
  v_mfma_f32_16x16x32_bf16 v[24:27], v[44:47], v[140:143], v[24:27]
  v_mfma_f32_16x16x32_bf16 v[240:243], v[48:51], v[136:139], v[240:243]
  ds_read_b128 v[88:91], v2 offset:3072
  v_mfma_f32_16x16x32_bf16 v[28:31], v[48:51], v[140:143], v[28:31]
  v_mfma_f32_16x16x32_bf16 v[244:247], v[52:55], v[136:139], v[244:247]
  ds_read_b128 v[92:95], v2 offset:4096
  v_mfma_f32_16x16x32_bf16 v[32:35], v[52:55], v[140:143], v[32:35]
  s_waitcnt vmcnt(8) lgkmcnt(5)
  v_mfma_f32_16x16x32_bf16 v[228:231], v[56:59], v[144:147], v[228:231]
  ds_read_b128 v[36:39], v2 offset:10240
  v_mfma_f32_16x16x32_bf16 v[16:19], v[56:59], v[148:151], v[16:19]
  v_mfma_f32_16x16x32_bf16 v[232:235], v[60:63], v[144:147], v[232:235]
  ds_read_b128 v[40:43], v2 offset:11264
  v_mfma_f32_16x16x32_bf16 v[20:23], v[60:63], v[148:151], v[20:23]
  v_mfma_f32_16x16x32_bf16 v[236:239], v[64:67], v[144:147], v[236:239]
  ds_read_b128 v[44:47], v2 offset:12288
  v_mfma_f32_16x16x32_bf16 v[24:27], v[64:67], v[148:151], v[24:27]
  v_mfma_f32_16x16x32_bf16 v[240:243], v[68:71], v[144:147], v[240:243]
  ds_read_b128 v[48:51], v2 offset:13312
  v_mfma_f32_16x16x32_bf16 v[28:31], v[68:71], v[148:151], v[28:31]
  v_mfma_f32_16x16x32_bf16 v[244:247], v[72:75], v[144:147], v[244:247]
  ds_read_b128 v[52:55], v2 offset:14336
  v_mfma_f32_16x16x32_bf16 v[32:35], v[72:75], v[148:151], v[32:35]
  s_waitcnt vmcnt(6) lgkmcnt(5)
  v_mfma_f32_16x16x32_bf16 v[228:231], v[76:79], v[152:155], v[228:231]
  ds_read_b128 v[56:59], v2 offset:20480
  v_mfma_f32_16x16x32_bf16 v[16:19], v[76:79], v[156:159], v[16:19]
  v_mfma_f32_16x16x32_bf16 v[232:235], v[80:83], v[152:155], v[232:235]
  ds_read_b128 v[60:63], v2 offset:21504
  v_mfma_f32_16x16x32_bf16 v[20:23], v[80:83], v[156:159], v[20:23]
  v_mfma_f32_16x16x32_bf16 v[236:239], v[84:87], v[152:155], v[236:239]
  ds_read_b128 v[64:67], v2 offset:22528
  v_mfma_f32_16x16x32_bf16 v[24:27], v[84:87], v[156:159], v[24:27]
  v_mfma_f32_16x16x32_bf16 v[240:243], v[88:91], v[152:155], v[240:243]
  ds_read_b128 v[68:71], v2 offset:23552
  v_mfma_f32_16x16x32_bf16 v[28:31], v[88:91], v[156:159], v[28:31]
  v_mfma_f32_16x16x32_bf16 v[244:247], v[92:95], v[152:155], v[244:247]
  ds_read_b128 v[72:75], v2 offset:24576
  v_mfma_f32_16x16x32_bf16 v[32:35], v[92:95], v[156:159], v[32:35]
  s_waitcnt vmcnt(4) lgkmcnt(5)
  v_mfma_f32_16x16x32_bf16 v[228:231], v[36:39], v[160:163], v[228:231]
  ds_read_b128 v[76:79], v2 offset:30720
  v_mfma_f32_16x16x32_bf16 v[16:19], v[36:39], v[164:167], v[16:19]
  v_mfma_f32_16x16x32_bf16 v[232:235], v[40:43], v[160:163], v[232:235]
  ds_read_b128 v[80:83], v2 offset:31744
  v_mfma_f32_16x16x32_bf16 v[20:23], v[40:43], v[164:167], v[20:23]
  v_mfma_f32_16x16x32_bf16 v[236:239], v[44:47], v[160:163], v[236:239]
  ds_read_b128 v[84:87], v2 offset:32768
  v_mfma_f32_16x16x32_bf16 v[24:27], v[44:47], v[164:167], v[24:27]
  v_mfma_f32_16x16x32_bf16 v[240:243], v[48:51], v[160:163], v[240:243]
  ds_read_b128 v[88:91], v2 offset:33792
  v_mfma_f32_16x16x32_bf16 v[28:31], v[48:51], v[164:167], v[28:31]
  v_mfma_f32_16x16x32_bf16 v[244:247], v[52:55], v[160:163], v[244:247]
  ds_read_b128 v[92:95], v2 offset:34816
  v_mfma_f32_16x16x32_bf16 v[32:35], v[52:55], v[164:167], v[32:35]
  s_waitcnt vmcnt(2) lgkmcnt(5)
  v_mfma_f32_16x16x32_bf16 v[228:231], v[56:59], v[168:171], v[228:231]
  v_mfma_f32_16x16x32_bf16 v[16:19], v[56:59], v[172:175], v[16:19]
  v_mfma_f32_16x16x32_bf16 v[232:235], v[60:63], v[168:171], v[232:235]
  v_mfma_f32_16x16x32_bf16 v[20:23], v[60:63], v[172:175], v[20:23]
  v_mfma_f32_16x16x32_bf16 v[236:239], v[64:67], v[168:171], v[236:239]
  v_mfma_f32_16x16x32_bf16 v[24:27], v[64:67], v[172:175], v[24:27]
  v_mfma_f32_16x16x32_bf16 v[240:243], v[68:71], v[168:171], v[240:243]
  v_mfma_f32_16x16x32_bf16 v[28:31], v[68:71], v[172:175], v[28:31]
  v_mfma_f32_16x16x32_bf16 v[244:247], v[72:75], v[168:171], v[244:247]
  v_mfma_f32_16x16x32_bf16 v[32:35], v[72:75], v[172:175], v[32:35]
  s_waitcnt vmcnt(0) lgkmcnt(0)
  v_mfma_f32_16x16x32_bf16 v[228:231], v[76:79], v[176:179], v[228:231]
  v_mfma_f32_16x16x32_bf16 v[16:19], v[76:79], v[180:183], v[16:19]
  v_mfma_f32_16x16x32_bf16 v[232:235], v[80:83], v[176:179], v[232:235]
  v_mfma_f32_16x16x32_bf16 v[20:23], v[80:83], v[180:183], v[20:23]
  v_mfma_f32_16x16x32_bf16 v[236:239], v[84:87], v[176:179], v[236:239]
  v_mfma_f32_16x16x32_bf16 v[24:27], v[84:87], v[180:183], v[24:27]
  v_mfma_f32_16x16x32_bf16 v[240:243], v[88:91], v[176:179], v[240:243]
  v_mfma_f32_16x16x32_bf16 v[28:31], v[88:91], v[180:183], v[28:31]
  v_mfma_f32_16x16x32_bf16 v[244:247], v[92:95], v[176:179], v[244:247]
  v_mfma_f32_16x16x32_bf16 v[32:35], v[92:95], v[180:183], v[32:35]
  s_barrier
  ds_write_b128 v9, v[16:19] offset:0
  ds_write_b128 v9, v[20:23] offset:1024
  s_nop 0
  ds_write_b128 v9, v[24:27] offset:2048
  s_nop 0
  ds_write_b128 v9, v[28:31] offset:3072
  s_nop 0
  ds_write_b128 v9, v[32:35] offset:4096
  s_waitcnt lgkmcnt(0)
  s_barrier
  ds_read_b128 v[104:107], v10 offset:0
  ds_read_b128 v[108:111], v10 offset:1024
  ds_read_b128 v[112:115], v10 offset:2048
  ds_read_b128 v[116:119], v10 offset:3072
  ds_read_b128 v[120:123], v10 offset:4096
  s_waitcnt lgkmcnt(4)
  v_pk_add_f32 v[228:229], v[228:229], v[104:105]
  v_pk_add_f32 v[230:231], v[230:231], v[106:107]
  s_waitcnt lgkmcnt(3)
  v_pk_add_f32 v[232:233], v[232:233], v[108:109]
  v_pk_add_f32 v[234:235], v[234:235], v[110:111]
  s_waitcnt lgkmcnt(2)
  v_pk_add_f32 v[236:237], v[236:237], v[112:113]
  v_pk_add_f32 v[238:239], v[238:239], v[114:115]
  s_waitcnt lgkmcnt(1)
  v_pk_add_f32 v[240:241], v[240:241], v[116:117]
  v_pk_add_f32 v[242:243], v[242:243], v[118:119]
  s_waitcnt lgkmcnt(0)
  v_pk_add_f32 v[244:245], v[244:245], v[120:121]
  v_pk_add_f32 v[246:247], v[246:247], v[122:123]
  v_cvt_pk_bf16_f32 v128, v228, v229
  v_cvt_pk_bf16_f32 v129, v230, v231
  v_cvt_pk_bf16_f32 v130, v232, v233
  v_cvt_pk_bf16_f32 v131, v234, v235
  s_nop 0
  v_permlane16_swap_b32 v128, v130
  v_permlane16_swap_b32 v129, v131
  buffer_store_dwordx4 v[128:131], v5, s[8:11], s32 offen offset:0
  v_cvt_pk_bf16_f32 v132, v236, v237
  v_cvt_pk_bf16_f32 v133, v238, v239
  v_cvt_pk_bf16_f32 v134, v240, v241
  v_cvt_pk_bf16_f32 v135, v242, v243
  s_nop 0
  v_permlane16_swap_b32 v132, v134
  v_permlane16_swap_b32 v133, v135
  buffer_store_dwordx4 v[132:135], v5, s[8:11], s32 offen offset:64
  v_cvt_pk_bf16_f32 v136, v244, v245
  v_cvt_pk_bf16_f32 v137, v246, v247
  buffer_store_dwordx2 v[136:137], v6, s[8:11], s32 offen offset:128
k_end:
  s_endpgm
helper:
  s_getpc_b64 s[30:31]
hlp_pc:
  s_sub_u32 s30, s30, hlp_pc-sequential_preLN__ssm_conv_s4d__mixer_s_mlp__prompt_kernel
  s_subb_u32 s31, s31, 0
  s_lshr_b32 s28, s2, 3
  s_lshl_b32 s28, s28, 11
  v_lshl_add_u32 v8, v0, 4, s28
  v_add_u32 v9, 1024, v8
  v_min_u32 v8, code_end-sequential_preLN__ssm_conv_s4d__mixer_s_mlp__prompt_kernel-16, v8
  v_min_u32 v9, code_end-sequential_preLN__ssm_conv_s4d__mixer_s_mlp__prompt_kernel-16, v9
  s_nop 0
  global_load_dwordx4 v[12:15], v8, s[30:31]
  global_load_dwordx4 v[16:19], v9, s[30:31]
  v_mov_b32 v4, -1
  v_mov_b32 v5, -1
  v_mov_b32 v6, -1
  v_mov_b32 v7, -1
  v_lshlrev_b32 v1, 4, v0
  s_cmp_ge_u32 s2, 160
  s_cbranch_scc1 hlp_b
  s_add_u32 s56, s92, 28901376
  s_addc_u32 s57, s93, 0
  s_load_dword s60, s[56:57], 0
  s_and_b32 s50, s2, 7
  s_mul_i32 s50, s50, 20
  s_lshr_b32 s51, s2, 3
  s_add_u32 s50, s50, s51
  v_lshrrev_b32 v3, 4, v0
  v_mul_u32_u24 v3, 40960, v3
  v_and_b32 v2, 15, v0
  v_lshl_add_u32 v3, v2, 4, v3
  s_lshl_b32 s28, s50, 8
  s_add_u32 s28, s28, 5242880
  s_barrier
  s_mov_b32 s44, s64
  s_mov_b32 s45, s65
  s_mov_b32 s46, 2621440
  s_mov_b32 s47, 0x20000
  v_mul_u32_u24 v2, 2560, v0
  s_lshl_b32 s42, s50, 3
  s_sub_u32 s36, s50, s51
  s_and_b32 s37, s50, 0xf0
  s_max_u32 s38, s36, s37
  s_add_u32 s36, s36, 20
  s_add_u32 s37, s37, 16
  s_min_u32 s36, s36, s37
  s_sub_u32 s36, s36, s38
  s_sub_u32 s51, s50, s38
  s_cmp_eq_u32 s36, 12
  s_cselect_b32 s37, 43, 32
  s_cmp_eq_u32 s36, 8
  s_cselect_b32 s37, 64, s37
  s_cmp_eq_u32 s36, 4
  s_cselect_b32 s37, 128, s37
  s_mul_i32 s51, s51, s37
  s_lshr_b32 s51, s51, 5
  s_add_u32 s43, s51, 0
  s_and_b32 s43, s43, 15
  s_mul_i32 s43, s43, 163840
  s_add_u32 s43, s43, s42
  buffer_load_dwordx2 v[32:33], v2, s[44:47], s43 offen
  buffer_load_dwordx2 v[34:35], v2, s[44:47], s43 offen offset:1280
  s_add_u32 s43, s51, 1
  s_and_b32 s43, s43, 15
  s_mul_i32 s43, s43, 163840
  s_add_u32 s43, s43, s42
  buffer_load_dwordx2 v[36:37], v2, s[44:47], s43 offen
  buffer_load_dwordx2 v[38:39], v2, s[44:47], s43 offen offset:1280
  s_add_u32 s43, s51, 2
  s_and_b32 s43, s43, 15
  s_mul_i32 s43, s43, 163840
  s_add_u32 s43, s43, s42
  buffer_load_dwordx2 v[40:41], v2, s[44:47], s43 offen
  buffer_load_dwordx2 v[42:43], v2, s[44:47], s43 offen offset:1280
  s_add_u32 s43, s51, 3
  s_and_b32 s43, s43, 15
  s_mul_i32 s43, s43, 163840
  s_add_u32 s43, s43, s42
  buffer_load_dwordx2 v[44:45], v2, s[44:47], s43 offen
  buffer_load_dwordx2 v[46:47], v2, s[44:47], s43 offen offset:1280
  s_add_u32 s43, s51, 4
  s_and_b32 s43, s43, 15
  s_mul_i32 s43, s43, 163840
  s_add_u32 s43, s43, s42
  buffer_load_dwordx2 v[48:49], v2, s[44:47], s43 offen
  buffer_load_dwordx2 v[50:51], v2, s[44:47], s43 offen offset:1280
  s_add_u32 s43, s51, 5
  s_and_b32 s43, s43, 15
  s_mul_i32 s43, s43, 163840
  s_add_u32 s43, s43, s42
  buffer_load_dwordx2 v[52:53], v2, s[44:47], s43 offen
  buffer_load_dwordx2 v[54:55], v2, s[44:47], s43 offen offset:1280
  s_add_u32 s43, s51, 6
  s_and_b32 s43, s43, 15
  s_mul_i32 s43, s43, 163840
  s_add_u32 s43, s43, s42
  buffer_load_dwordx2 v[56:57], v2, s[44:47], s43 offen
  buffer_load_dwordx2 v[58:59], v2, s[44:47], s43 offen offset:1280
  s_add_u32 s43, s51, 7
  s_and_b32 s43, s43, 15
  s_mul_i32 s43, s43, 163840
  s_add_u32 s43, s43, s42
  buffer_load_dwordx2 v[60:61], v2, s[44:47], s43 offen
  buffer_load_dwordx2 v[62:63], v2, s[44:47], s43 offen offset:1280
  s_add_u32 s43, s51, 8
  s_and_b32 s43, s43, 15
  s_mul_i32 s43, s43, 163840
  s_add_u32 s43, s43, s42
  buffer_load_dwordx2 v[64:65], v2, s[44:47], s43 offen
  buffer_load_dwordx2 v[66:67], v2, s[44:47], s43 offen offset:1280
  s_add_u32 s43, s51, 9
  s_and_b32 s43, s43, 15
  s_mul_i32 s43, s43, 163840
  s_add_u32 s43, s43, s42
  buffer_load_dwordx2 v[68:69], v2, s[44:47], s43 offen
  buffer_load_dwordx2 v[70:71], v2, s[44:47], s43 offen offset:1280
  s_add_u32 s43, s51, 10
  s_and_b32 s43, s43, 15
  s_mul_i32 s43, s43, 163840
  s_add_u32 s43, s43, s42
  buffer_load_dwordx2 v[72:73], v2, s[44:47], s43 offen
  buffer_load_dwordx2 v[74:75], v2, s[44:47], s43 offen offset:1280
  s_add_u32 s43, s51, 11
  s_and_b32 s43, s43, 15
  s_mul_i32 s43, s43, 163840
  s_add_u32 s43, s43, s42
  buffer_load_dwordx2 v[76:77], v2, s[44:47], s43 offen
  buffer_load_dwordx2 v[78:79], v2, s[44:47], s43 offen offset:1280
  s_add_u32 s43, s51, 12
  s_and_b32 s43, s43, 15
  s_mul_i32 s43, s43, 163840
  s_add_u32 s43, s43, s42
  buffer_load_dwordx2 v[80:81], v2, s[44:47], s43 offen
  buffer_load_dwordx2 v[82:83], v2, s[44:47], s43 offen offset:1280
  s_add_u32 s43, s51, 13
  s_and_b32 s43, s43, 15
  s_mul_i32 s43, s43, 163840
  s_add_u32 s43, s43, s42
  buffer_load_dwordx2 v[84:85], v2, s[44:47], s43 offen
  buffer_load_dwordx2 v[86:87], v2, s[44:47], s43 offen offset:1280
  s_add_u32 s43, s51, 14
  s_and_b32 s43, s43, 15
  s_mul_i32 s43, s43, 163840
  s_add_u32 s43, s43, s42
  buffer_load_dwordx2 v[88:89], v2, s[44:47], s43 offen
  buffer_load_dwordx2 v[90:91], v2, s[44:47], s43 offen offset:1280
  s_add_u32 s43, s51, 15
  s_and_b32 s43, s43, 15
  s_mul_i32 s43, s43, 163840
  s_add_u32 s43, s43, s42
  buffer_load_dwordx2 v[92:93], v2, s[44:47], s43 offen
  buffer_load_dwordx2 v[94:95], v2, s[44:47], s43 offen offset:1280
  s_waitcnt lgkmcnt(0)
  s_mul_i32 s60, s60, 0x9e3779b1
  s_add_u32 s60, s60, 0x7f4a7c15
  s_mov_b32 s42, 28327936
  buffer_load_dwordx4 v[96:99], v1, s[4:7], s42 offen offset:0 sc1
  buffer_load_dwordx4 v[100:103], v1, s[4:7], s42 offen offset:1024 sc1
  buffer_load_dwordx4 v[104:107], v1, s[4:7], s42 offen offset:2048 sc1
  buffer_load_dwordx4 v[108:111], v1, s[4:7], s42 offen offset:3072 sc1
  s_mov_b32 s42, 28332032
  buffer_load_dwordx4 v[112:115], v1, s[4:7], s42 offen offset:0 sc1
  buffer_load_dwordx4 v[116:119], v1, s[4:7], s42 offen offset:1024 sc1
  buffer_load_dwordx4 v[120:123], v1, s[4:7], s42 offen offset:2048 sc1
  buffer_load_dwordx4 v[124:127], v1, s[4:7], s42 offen offset:3072 sc1
  s_mov_b32 s42, 28336128
  buffer_load_dwordx4 v[128:131], v1, s[4:7], s42 offen offset:0 sc1
  buffer_load_dwordx4 v[132:135], v1, s[4:7], s42 offen offset:1024 sc1
  buffer_load_dwordx4 v[136:139], v1, s[4:7], s42 offen offset:2048 sc1
  buffer_load_dwordx4 v[140:143], v1, s[4:7], s42 offen offset:3072 sc1
  s_mov_b32 s42, 28340224
  buffer_load_dwordx4 v[144:147], v1, s[4:7], s42 offen offset:0 sc1
  buffer_load_dwordx4 v[148:151], v1, s[4:7], s42 offen offset:1024 sc1
  buffer_load_dwordx4 v[152:155], v1, s[4:7], s42 offen offset:2048 sc1
  buffer_load_dwordx4 v[156:159], v1, s[4:7], s42 offen offset:3072 sc1
  s_add_u32 s43, s51, 0
  s_and_b32 s43, s43, 15
  s_lshl_b32 s43, s43, 10
  s_add_u32 s43, s43, 122880
  v_add_u32 v8, s43, v1
  s_waitcnt vmcnt(46)
  ds_write_b128 v8, v[32:35]
  s_add_u32 s43, s51, 1
  s_and_b32 s43, s43, 15
  s_lshl_b32 s43, s43, 10
  s_add_u32 s43, s43, 122880
  v_add_u32 v9, s43, v1
  s_waitcnt vmcnt(44)
  ds_write_b128 v9, v[36:39]
  s_add_u32 s43, s51, 2
  s_and_b32 s43, s43, 15
  s_lshl_b32 s43, s43, 10
  s_add_u32 s43, s43, 122880
  v_add_u32 v10, s43, v1
  s_waitcnt vmcnt(42)
  ds_write_b128 v10, v[40:43]
  s_add_u32 s43, s51, 3
  s_and_b32 s43, s43, 15
  s_lshl_b32 s43, s43, 10
  s_add_u32 s43, s43, 122880
  v_add_u32 v11, s43, v1
  s_waitcnt vmcnt(40)
  ds_write_b128 v11, v[44:47]
  s_add_u32 s43, s51, 4
  s_and_b32 s43, s43, 15
  s_lshl_b32 s43, s43, 10
  s_add_u32 s43, s43, 122880
  v_add_u32 v8, s43, v1
  s_waitcnt vmcnt(38)
  ds_write_b128 v8, v[48:51]
  s_add_u32 s43, s51, 5
  s_and_b32 s43, s43, 15
  s_lshl_b32 s43, s43, 10
  s_add_u32 s43, s43, 122880
  v_add_u32 v9, s43, v1
  s_waitcnt vmcnt(36)
  ds_write_b128 v9, v[52:55]
  s_add_u32 s43, s51, 6
  s_and_b32 s43, s43, 15
  s_lshl_b32 s43, s43, 10
  s_add_u32 s43, s43, 122880
  v_add_u32 v10, s43, v1
  s_waitcnt vmcnt(34)
  ds_write_b128 v10, v[56:59]
  s_add_u32 s43, s51, 7
  s_and_b32 s43, s43, 15
  s_lshl_b32 s43, s43, 10
  s_add_u32 s43, s43, 122880
  v_add_u32 v11, s43, v1
  s_waitcnt vmcnt(32)
  ds_write_b128 v11, v[60:63]
  s_add_u32 s43, s51, 8
  s_and_b32 s43, s43, 15
  s_lshl_b32 s43, s43, 10
  s_add_u32 s43, s43, 122880
  v_add_u32 v8, s43, v1
  s_waitcnt vmcnt(30)
  ds_write_b128 v8, v[64:67]
  s_add_u32 s43, s51, 9
  s_and_b32 s43, s43, 15
  s_lshl_b32 s43, s43, 10
  s_add_u32 s43, s43, 122880
  v_add_u32 v9, s43, v1
  s_waitcnt vmcnt(28)
  ds_write_b128 v9, v[68:71]
  s_add_u32 s43, s51, 10
  s_and_b32 s43, s43, 15
  s_lshl_b32 s43, s43, 10
  s_add_u32 s43, s43, 122880
  v_add_u32 v10, s43, v1
  s_waitcnt vmcnt(26)
  ds_write_b128 v10, v[72:75]
  s_add_u32 s43, s51, 11
  s_and_b32 s43, s43, 15
  s_lshl_b32 s43, s43, 10
  s_add_u32 s43, s43, 122880
  v_add_u32 v11, s43, v1
  s_waitcnt vmcnt(24)
  ds_write_b128 v11, v[76:79]
  s_add_u32 s43, s51, 12
  s_and_b32 s43, s43, 15
  s_lshl_b32 s43, s43, 10
  s_add_u32 s43, s43, 122880
  v_add_u32 v8, s43, v1
  s_waitcnt vmcnt(22)
  ds_write_b128 v8, v[80:83]
  s_add_u32 s43, s51, 13
  s_and_b32 s43, s43, 15
  s_lshl_b32 s43, s43, 10
  s_add_u32 s43, s43, 122880
  v_add_u32 v9, s43, v1
  s_waitcnt vmcnt(20)
  ds_write_b128 v9, v[84:87]
  s_add_u32 s43, s51, 14
  s_and_b32 s43, s43, 15
  s_lshl_b32 s43, s43, 10
  s_add_u32 s43, s43, 122880
  v_add_u32 v10, s43, v1
  s_waitcnt vmcnt(18)
  ds_write_b128 v10, v[88:91]
  s_add_u32 s43, s51, 15
  s_and_b32 s43, s43, 15
  s_lshl_b32 s43, s43, 10
  s_add_u32 s43, s43, 122880
  v_add_u32 v11, s43, v1
  s_waitcnt vmcnt(16)
  ds_write_b128 v11, v[92:95]
  s_mov_b32 s61, 65536
  v_add_u32 v8, 139264, v1
sa_loop:
  v_mov_b32 v9, 0
  s_waitcnt vmcnt(15)
  v_xor_b32 v97, s60, v97
  v_xor_b32 v99, s60, v99
  v_or3_b32 v9, v9, v97, v99
  ds_write_b128 v8, v[96:99] offset:0
  s_waitcnt vmcnt(14)
  v_xor_b32 v101, s60, v101
  v_xor_b32 v103, s60, v103
  v_or3_b32 v9, v9, v101, v103
  ds_write_b128 v8, v[100:103] offset:1024
  s_waitcnt vmcnt(13)
  v_xor_b32 v105, s60, v105
  v_xor_b32 v107, s60, v107
  v_or3_b32 v9, v9, v105, v107
  ds_write_b128 v8, v[104:107] offset:2048
  s_waitcnt vmcnt(12)
  v_xor_b32 v109, s60, v109
  v_xor_b32 v111, s60, v111
  v_or3_b32 v9, v9, v109, v111
  ds_write_b128 v8, v[108:111] offset:3072
  s_waitcnt vmcnt(11)
  v_xor_b32 v113, s60, v113
  v_xor_b32 v115, s60, v115
  v_or3_b32 v9, v9, v113, v115
  ds_write_b128 v8, v[112:115] offset:4096
  s_waitcnt vmcnt(10)
  v_xor_b32 v117, s60, v117
  v_xor_b32 v119, s60, v119
  v_or3_b32 v9, v9, v117, v119
  ds_write_b128 v8, v[116:119] offset:5120
  s_waitcnt vmcnt(9)
  v_xor_b32 v121, s60, v121
  v_xor_b32 v123, s60, v123
  v_or3_b32 v9, v9, v121, v123
  ds_write_b128 v8, v[120:123] offset:6144
  s_waitcnt vmcnt(8)
  v_xor_b32 v125, s60, v125
  v_xor_b32 v127, s60, v127
  v_or3_b32 v9, v9, v125, v127
  ds_write_b128 v8, v[124:127] offset:7168
  s_waitcnt vmcnt(7)
  v_xor_b32 v129, s60, v129
  v_xor_b32 v131, s60, v131
  v_or3_b32 v9, v9, v129, v131
  ds_write_b128 v8, v[128:131] offset:8192
  s_waitcnt vmcnt(6)
  v_xor_b32 v133, s60, v133
  v_xor_b32 v135, s60, v135
  v_or3_b32 v9, v9, v133, v135
  ds_write_b128 v8, v[132:135] offset:9216
  s_waitcnt vmcnt(5)
  v_xor_b32 v137, s60, v137
  v_xor_b32 v139, s60, v139
  v_or3_b32 v9, v9, v137, v139
  ds_write_b128 v8, v[136:139] offset:10240
  s_waitcnt vmcnt(4)
  v_xor_b32 v141, s60, v141
  v_xor_b32 v143, s60, v143
  v_or3_b32 v9, v9, v141, v143
  ds_write_b128 v8, v[140:143] offset:11264
  s_waitcnt vmcnt(3)
  v_xor_b32 v145, s60, v145
  v_xor_b32 v147, s60, v147
  v_or3_b32 v9, v9, v145, v147
  ds_write_b128 v8, v[144:147] offset:12288
  s_waitcnt vmcnt(2)
  v_xor_b32 v149, s60, v149
  v_xor_b32 v151, s60, v151
  v_or3_b32 v9, v9, v149, v151
  ds_write_b128 v8, v[148:151] offset:13312
  s_waitcnt vmcnt(1)
  v_xor_b32 v153, s60, v153
  v_xor_b32 v155, s60, v155
  v_or3_b32 v9, v9, v153, v155
  ds_write_b128 v8, v[152:155] offset:14336
  s_waitcnt vmcnt(0)
  v_xor_b32 v157, s60, v157
  v_xor_b32 v159, s60, v159
  v_or3_b32 v9, v9, v157, v159
  ds_write_b128 v8, v[156:159] offset:15360
  v_cmp_ne_u32 vcc, 0, v9
  s_cbranch_vccz sa_out
  s_sub_u32 s61, s61, 1
  s_cbranch_scc1 sa_out
  s_waitcnt lgkmcnt(0)
  s_mov_b32 s42, 28327936
  buffer_load_dwordx4 v[96:99], v1, s[4:7], s42 offen offset:0 sc1
  buffer_load_dwordx4 v[100:103], v1, s[4:7], s42 offen offset:1024 sc1
  buffer_load_dwordx4 v[104:107], v1, s[4:7], s42 offen offset:2048 sc1
  buffer_load_dwordx4 v[108:111], v1, s[4:7], s42 offen offset:3072 sc1
  s_mov_b32 s42, 28332032
  buffer_load_dwordx4 v[112:115], v1, s[4:7], s42 offen offset:0 sc1
  buffer_load_dwordx4 v[116:119], v1, s[4:7], s42 offen offset:1024 sc1
  buffer_load_dwordx4 v[120:123], v1, s[4:7], s42 offen offset:2048 sc1
  buffer_load_dwordx4 v[124:127], v1, s[4:7], s42 offen offset:3072 sc1
  s_mov_b32 s42, 28336128
  buffer_load_dwordx4 v[128:131], v1, s[4:7], s42 offen offset:0 sc1
  buffer_load_dwordx4 v[132:135], v1, s[4:7], s42 offen offset:1024 sc1
  buffer_load_dwordx4 v[136:139], v1, s[4:7], s42 offen offset:2048 sc1
  buffer_load_dwordx4 v[140:143], v1, s[4:7], s42 offen offset:3072 sc1
  s_mov_b32 s42, 28340224
  buffer_load_dwordx4 v[144:147], v1, s[4:7], s42 offen offset:0 sc1
  buffer_load_dwordx4 v[148:151], v1, s[4:7], s42 offen offset:1024 sc1
  buffer_load_dwordx4 v[152:155], v1, s[4:7], s42 offen offset:2048 sc1
  buffer_load_dwordx4 v[156:159], v1, s[4:7], s42 offen offset:3072 sc1
  s_branch sa_loop
sa_out:
  s_waitcnt lgkmcnt(0)
  s_barrier
  buffer_store_dwordx4 v[4:7], v3, s[4:7], s28 offen sc1
  s_add_u32 s28, s28, 163840
  buffer_store_dwordx4 v[4:7], v3, s[4:7], s28 offen sc1
  s_add_u32 s28, s28, 163840
  buffer_store_dwordx4 v[4:7], v3, s[4:7], s28 offen sc1
  s_add_u32 s28, s28, 163840
  buffer_store_dwordx4 v[4:7], v3, s[4:7], s28 offen sc1
  s_add_u32 s28, s28, 163840
  buffer_store_dwordx4 v[4:7], v3, s[4:7], s28 offen sc1
  s_add_u32 s28, s28, 163840
  buffer_store_dwordx4 v[4:7], v3, s[4:7], s28 offen sc1
  s_add_u32 s28, s28, 163840
  buffer_store_dwordx4 v[4:7], v3, s[4:7], s28 offen sc1
  s_add_u32 s28, s28, 163840
  buffer_store_dwordx4 v[4:7], v3, s[4:7], s28 offen sc1
  s_add_u32 s28, s28, 163840
  buffer_store_dwordx4 v[4:7], v3, s[4:7], s28 offen sc1
  s_add_u32 s28, s28, 163840
  buffer_store_dwordx4 v[4:7], v3, s[4:7], s28 offen sc1
  s_add_u32 s28, s28, 163840
  buffer_store_dwordx4 v[4:7], v3, s[4:7], s28 offen sc1
  s_add_u32 s28, s28, 163840
  buffer_store_dwordx4 v[4:7], v3, s[4:7], s28 offen sc1
  s_add_u32 s28, s28, 163840
  buffer_store_dwordx4 v[4:7], v3, s[4:7], s28 offen sc1
  s_add_u32 s28, s28, 163840
  buffer_store_dwordx4 v[4:7], v3, s[4:7], s28 offen sc1
  s_add_u32 s28, s28, 163840
  buffer_store_dwordx4 v[4:7], v3, s[4:7], s28 offen sc1
  s_add_u32 s28, s28, 163840
  buffer_store_dwordx4 v[4:7], v3, s[4:7], s28 offen sc1
  s_add_u32 s28, s28, 163840
  s_mul_i32 s28, s2, 33792
  s_add_u32 s28, s28, 7864320
  buffer_store_dwordx4 v[4:7], v1, s[4:7], s28 offen offset:0 sc1
  s_barrier
  buffer_store_dwordx4 v[4:7], v1, s[4:7], s28 offen offset:1024 sc1
  buffer_store_dwordx4 v[4:7], v1, s[4:7], s28 offen offset:2048 sc1
  buffer_store_dwordx4 v[4:7], v1, s[4:7], s28 offen offset:3072 sc1
  s_add_u32 s28, s28, 4096
  buffer_store_dwordx4 v[4:7], v1, s[4:7], s28 offen offset:0 sc1
  buffer_store_dwordx4 v[4:7], v1, s[4:7], s28 offen offset:1024 sc1
  buffer_store_dwordx4 v[4:7], v1, s[4:7], s28 offen offset:2048 sc1
  buffer_store_dwordx4 v[4:7], v1, s[4:7], s28 offen offset:3072 sc1
  s_add_u32 s28, s28, 4096
  buffer_store_dwordx4 v[4:7], v1, s[4:7], s28 offen offset:0 sc1
  buffer_store_dwordx4 v[4:7], v1, s[4:7], s28 offen offset:1024 sc1
  buffer_store_dwordx4 v[4:7], v1, s[4:7], s28 offen offset:2048 sc1
  buffer_store_dwordx4 v[4:7], v1, s[4:7], s28 offen offset:3072 sc1
  s_add_u32 s28, s28, 4096
  buffer_store_dwordx4 v[4:7], v1, s[4:7], s28 offen offset:0 sc1
  buffer_store_dwordx4 v[4:7], v1, s[4:7], s28 offen offset:1024 sc1
  buffer_store_dwordx4 v[4:7], v1, s[4:7], s28 offen offset:2048 sc1
  buffer_store_dwordx4 v[4:7], v1, s[4:7], s28 offen offset:3072 sc1
  s_add_u32 s28, s28, 4096
  buffer_store_dwordx4 v[4:7], v1, s[4:7], s28 offen offset:0 sc1
  buffer_store_dwordx4 v[4:7], v1, s[4:7], s28 offen offset:1024 sc1
  buffer_store_dwordx4 v[4:7], v1, s[4:7], s28 offen offset:2048 sc1
  buffer_store_dwordx4 v[4:7], v1, s[4:7], s28 offen offset:3072 sc1
  s_add_u32 s28, s28, 4096
  buffer_store_dwordx4 v[4:7], v1, s[4:7], s28 offen offset:0 sc1
  buffer_store_dwordx4 v[4:7], v1, s[4:7], s28 offen offset:1024 sc1
  buffer_store_dwordx4 v[4:7], v1, s[4:7], s28 offen offset:2048 sc1
  buffer_store_dwordx4 v[4:7], v1, s[4:7], s28 offen offset:3072 sc1
  s_add_u32 s28, s28, 4096
  buffer_store_dwordx4 v[4:7], v1, s[4:7], s28 offen offset:0 sc1
  buffer_store_dwordx4 v[4:7], v1, s[4:7], s28 offen offset:1024 sc1
  buffer_store_dwordx4 v[4:7], v1, s[4:7], s28 offen offset:2048 sc1
  buffer_store_dwordx4 v[4:7], v1, s[4:7], s28 offen offset:3072 sc1
  s_add_u32 s28, s28, 4096
  buffer_store_dwordx4 v[4:7], v1, s[4:7], s28 offen offset:0 sc1
  buffer_store_dwordx4 v[4:7], v1, s[4:7], s28 offen offset:1024 sc1
  buffer_store_dwordx4 v[4:7], v1, s[4:7], s28 offen offset:2048 sc1
  buffer_store_dwordx4 v[4:7], v1, s[4:7], s28 offen offset:3072 sc1
  s_add_u32 s28, s28, 4096
  buffer_store_dwordx4 v[4:7], v1, s[4:7], s28 offen offset:0 sc1
  s_lshl_b32 s56, s2, 7
  s_add_u32 s56, s56, 28639232
  v_mov_b32 v8, s60
  v_mov_b32 v9, 0
  s_mov_b64 exec, 1
  s_waitcnt vmcnt(0)
  buffer_store_dword v8, v9, s[4:7], s56 offen sc1
  s_mov_b64 exec, -1
  s_branch hlp_end
hlp_b:
  s_cmp_ge_u32 s2, 234
  s_cbranch_scc1 hlp_end
  s_cmp_lt_u32 s2, 192
  s_cbranch_scc1 hlp_l
  s_barrier
hlp_l:
  s_sub_u32 s20, s2, 180
  s_and_b32 s21, s20, 7
  s_mul_i32 s21, s21, 3
  s_lshr_b32 s22, s20, 3
  s_add_u32 s21, s21, s22
  s_cmp_lt_u32 s20, 24
  s_cselect_b32 s20, s21, s20
  s_add_u32 s20, s20, 20
  s_lshl_b32 s20, s20, 1
  s_mov_b32 s22, 0
  s_mov_b32 s3, 0
hlp_lw:
  s_cmp_lt_u32 s20, 20
  s_cbranch_scc1 la_w1
  s_cmp_lt_u32 s20, 40
  s_cbranch_scc1 la_w2
  s_cmp_lt_u32 s20, 88
  s_cbranch_scc1 la_w3
  s_mov_b32 s8, s86
  s_mov_b32 s9, s87
  s_mov_b32 s10, 1966080
  s_mov_b32 s11, 0x20000
  s_sub_u32 s24, s20, 88
  s_mul_i32 s35, s24, 205
  s_lshr_b32 s35, s35, 12
  s_mul_i32 s25, s35, 20
  s_sub_u32 s24, s24, s25
  s_lshl_b32 s35, s35, 4
  s_add_u32 s35, s35, s3
  s_lshl_b32 s25, s35, 5
  s_mov_b32 s38, 4
  s_mul_i32 s25, s25, 1280
  s_mov_b32 s26, 163840
  s_add_u32 s27, s25, 655360
  s_mov_b32 s39, 20480
  s_mov_b32 s40, 20480
  s_mov_b32 s41, 20480
  s_mov_b32 s23, s39
  s_mul_i32 s41, s35, 86
  s_lshr_b32 s41, s41, 8
  s_mul_i32 s43, s41, 3
  s_sub_u32 s43, s35, s43
  s_lshl_b32 s35, s43, 4
  s_add_u32 s35, s35, s41
  s_mov_b32 s41, 87040
  s_cmp_eq_u32 s43, 2
  s_cselect_b32 s39, 4294813696, s41
  s_cmp_eq_u32 s43, 1
  s_cselect_b32 s40, 4294813696, s41
  s_cmp_eq_u32 s43, 0
  s_cselect_b32 s23, 4294813696, s41
  s_mov_b32 s28, 20480
  s_mov_b32 s29, 10240
  s_mov_b32 s31, 1280
  s_mov_b32 s32, 25853952
  s_mov_b32 s33, 5
  s_mov_b32 s34, 240
  s_mov_b32 s36, 0
  s_mov_b32 s37, 205
  s_branch la_go
la_w1:
  s_mov_b32 s8, s80
  s_mov_b32 s9, s81
  s_mov_b32 s10, 819200
  s_mov_b32 s11, 0x20000
  s_sub_u32 s24, s20, 0
  s_mov_b32 s35, s3
  s_mov_b32 s38, 5
  s_lshl_b32 s25, s3, 5
  s_mul_i32 s25, s25, 1280
  s_mov_b32 s26, 163840
  s_add_u32 s27, s25, 655360
  s_mov_b32 s39, 20480
  s_mov_b32 s40, 20480
  s_mov_b32 s41, 20480
  s_mov_b32 s23, s39
  s_mov_b32 s28, 20480
  s_mov_b32 s29, 10240
  s_mov_b32 s31, 1280
  s_mov_b32 s32, 22020096
  s_mov_b32 s33, 5
  s_mov_b32 s34, 100
  s_mov_b32 s36, 28311552
  s_mov_b32 s37, 205
  s_branch la_go
la_w2:
  s_mov_b32 s8, s82
  s_mov_b32 s9, s83
  s_mov_b32 s10, 819200
  s_mov_b32 s11, 0x20000
  s_sub_u32 s24, s20, 20
  s_mov_b32 s35, s3
  s_mov_b32 s38, 5
  s_lshr_b32 s25, s3, 1
  s_mul_i32 s25, s25, 80
  s_and_b32 s26, s3, 1
  s_lshl_b32 s26, s26, 5
  s_add_u32 s25, s25, s26
  s_mul_i32 s25, s25, 1280
  s_mov_b32 s26, 204800
  s_mul_i32 s27, s3, 204800
  s_add_u32 s27, s27, 81920
  s_lshl_b32 s35, s3, 1
  s_mov_b32 s39, 40960
  s_mov_b32 s40, 4294931456
  s_and_b32 s41, s3, 1
  s_lshl_b32 s41, s41, 1
  s_lshr_b32 s43, s3, 1
  s_add_u32 s41, s41, s43
  s_add_u32 s41, s41, 7
  s_sub_u32 s41, s41, s35
  s_mul_i32 s41, s41, 5120
  s_mov_b32 s23, s39
  s_mov_b32 s28, 10240
  s_mov_b32 s29, 102400
  s_mov_b32 s31, 1280
  s_mov_b32 s32, 23068672
  s_mov_b32 s33, 5
  s_mov_b32 s34, 100
  s_mov_b32 s36, 0
  s_mov_b32 s37, 205
  s_branch la_go
la_w3:
  s_mov_b32 s8, s84
  s_mov_b32 s9, s85
  s_mov_b32 s10, 1966080
  s_mov_b32 s11, 0x20000
  s_sub_u32 s24, s20, 40
  s_mov_b32 s35, s3
  s_mov_b32 s38, 5
  s_lshr_b32 s25, s3, 1
  s_mul_i32 s25, s25, 80
  s_and_b32 s26, s3, 1
  s_lshl_b32 s26, s26, 5
  s_add_u32 s25, s25, s26
  s_mul_i32 s25, s25, 3072
  s_mov_b32 s26, 491520
  s_mul_i32 s27, s3, 491520
  s_add_u32 s27, s27, 196608
  s_mov_b32 s39, 24576
  s_mov_b32 s40, 24576
  s_mov_b32 s41, 24576
  s_mov_b32 s23, s39
  s_mov_b32 s28, 24576
  s_mov_b32 s29, 245760
  s_mov_b32 s31, 3072
  s_mov_b32 s32, 23887872
  s_mov_b32 s33, 6
  s_mov_b32 s34, 120
  s_mov_b32 s36, 28315648
  s_mov_b32 s37, 171
la_go:
  v_lshrrev_b32 v3, 1, v0
  v_lshrrev_b32 v4, 4, v0
  v_xor_b32 v3, v3, v4
  v_and_b32 v3, 1, v3
  v_and_b32 v4, 1, v0
  v_lshl_add_u32 v3, v3, 1, v4
  s_lshl_b32 s42, s24, 6
  v_lshl_add_u32 v3, v3, 4, s42
  v_lshrrev_b32 v1, 2, v0
  v_mul_lo_u32 v1, v1, s31
  v_add_u32 v1, v1, v3
  v_bfe_u32 v2, v0, 2, 3
  v_mul_lo_u32 v2, v2, s31
  v_lshrrev_b32 v4, 5, v0
  v_mul_lo_u32 v4, v4, s29
  v_add3_u32 v2, v2, v4, v3
  s_mul_i32 s42, s3, 10240
  s_add_u32 m0, s42, s22
  s_lshl_b32 s43, s31, 4
  buffer_load_dwordx4 v1, s[8:11], s25 offen lds
  s_add_u32 m0, m0, 49088
  s_nop 0
  buffer_load_dwordx4 v1, s[8:11], s25 offen offset:64 lds
  s_sub_u32 m0, m0, 48064
  s_add_u32 s30, s25, s43
  buffer_load_dwordx4 v1, s[8:11], s30 offen lds
  s_add_u32 m0, m0, 49088
  s_nop 0
  buffer_load_dwordx4 v1, s[8:11], s30 offen offset:64 lds
  s_sub_u32 m0, m0, 48064
  s_add_u32 s25, s25, s26
  buffer_load_dwordx4 v1, s[8:11], s25 offen lds
  s_add_u32 m0, m0, 49088
  s_nop 0
  buffer_load_dwordx4 v1, s[8:11], s25 offen offset:64 lds
  s_sub_u32 m0, m0, 48064
  s_add_u32 s30, s25, s43
  buffer_load_dwordx4 v1, s[8:11], s30 offen lds
  s_add_u32 m0, m0, 49088
  s_nop 0
  buffer_load_dwordx4 v1, s[8:11], s30 offen offset:64 lds
  s_sub_u32 m0, m0, 48064
  s_add_u32 s25, s25, s26
  buffer_load_dwordx4 v1, s[8:11], s25 offen lds
  s_add_u32 m0, m0, 49088
  s_nop 0
  buffer_load_dwordx4 v1, s[8:11], s25 offen offset:64 lds
  s_sub_u32 m0, m0, 48064
  s_add_u32 s30, s25, s43
  buffer_load_dwordx4 v1, s[8:11], s30 offen lds
  s_add_u32 m0, m0, 49088
  s_nop 0
  buffer_load_dwordx4 v1, s[8:11], s30 offen offset:64 lds
  s_sub_u32 m0, m0, 48064
  s_add_u32 s25, s25, s26
  buffer_load_dwordx4 v1, s[8:11], s25 offen lds
  s_add_u32 m0, m0, 49088
  s_nop 0
  buffer_load_dwordx4 v1, s[8:11], s25 offen offset:64 lds
  s_sub_u32 m0, m0, 48064
  s_add_u32 s30, s25, s43
  buffer_load_dwordx4 v1, s[8:11], s30 offen lds
  s_add_u32 m0, m0, 49088
  s_nop 0
  buffer_load_dwordx4 v1, s[8:11], s30 offen offset:64 lds
  s_sub_u32 m0, m0, 48064
  s_add_u32 s25, s25, s26
  s_cmp_eq_u32 s38, 4
  s_cbranch_scc1 la_ld_done
  buffer_load_dwordx4 v2, s[8:11], s27 offen lds
  s_add_u32 m0, m0, 49088
  s_nop 0
  buffer_load_dwordx4 v2, s[8:11], s27 offen offset:64 lds
  s_sub_u32 m0, m0, 48064
  s_add_u32 s27, s27, s28
  buffer_load_dwordx4 v2, s[8:11], s27 offen lds
  s_add_u32 m0, m0, 49088
  s_nop 0
  buffer_load_dwordx4 v2, s[8:11], s27 offen offset:64 lds
  s_sub_u32 m0, m0, 48064
la_ld_done:
  s_add_u32 s3, s3, 1
  s_cmp_lt_u32 s3, 4
  s_cbranch_scc1 hlp_lw
hlp_end:
  s_waitcnt vmcnt(0)
  s_endpgm
wfs:
  s_cmp_eq_u32 s61, 0
  s_cbranch_scc1 wfs_b
  s_sub_u32 s61, s61, 1
  buffer_load_dword v13, v14, s[4:7], s33 offen sc1
  s_waitcnt vmcnt(0)
  v_cmp_ne_u32 vcc, s60, v13
  s_cbranch_vccnz wfs
  s_branch wfs_b
x1_0:
  s_waitcnt vmcnt(0)
  s_cmp_eq_u32 s61, 0
  s_cbranch_scc1 x1_0_b
  s_sub_u32 s61, s61, 1
  s_add_u32 s57, s30, 0
  buffer_load_dwordx4 v[136:139], v1, s[4:7], s57 offen offset:0 sc1
  s_add_u32 s57, s30, 0
  buffer_load_dwordx4 v[140:143], v1, s[4:7], s57 offen offset:1024 sc1
  v_max3_u32 v250, v144, v145, v146
  v_max3_u32 v251, v147, v148, v149
  v_max3_u32 v250, v250, v150, v151
  v_max_u32 v250, v250, v251
  v_cmp_eq_u32 vcc, -1, v250
  s_cbranch_vccz x1_0_s0
  s_add_u32 s57, s30, 4096
  buffer_load_dwordx4 v[144:147], v1, s[4:7], s57 offen offset:0 sc1
  s_add_u32 s57, s30, 4096
  buffer_load_dwordx4 v[148:151], v1, s[4:7], s57 offen offset:1024 sc1
x1_0_s0:
  v_max3_u32 v250, v152, v153, v154
  v_max3_u32 v251, v155, v156, v157
  v_max3_u32 v250, v250, v158, v159
  v_max_u32 v250, v250, v251
  v_cmp_eq_u32 vcc, -1, v250
  s_cbranch_vccz x1_0_s1
  s_add_u32 s57, s30, 8192
  buffer_load_dwordx4 v[152:155], v1, s[4:7], s57 offen offset:0 sc1
  s_add_u32 s57, s30, 8192
  buffer_load_dwordx4 v[156:159], v1, s[4:7], s57 offen offset:1024 sc1
x1_0_s1:
  v_max3_u32 v250, v160, v161, v162
  v_max3_u32 v251, v163, v164, v165
  v_max3_u32 v250, v250, v166, v167
  v_max_u32 v250, v250, v251
  v_cmp_eq_u32 vcc, -1, v250
  s_cbranch_vccz x1_0_s2
  s_add_u32 s57, s30, 12288
  buffer_load_dwordx4 v[160:163], v1, s[4:7], s57 offen offset:0 sc1
  s_add_u32 s57, s30, 12288
  buffer_load_dwordx4 v[164:167], v1, s[4:7], s57 offen offset:1024 sc1
x1_0_s2:
  s_waitcnt vmcnt(0)
  v_max3_u32 v250, v136, v137, v138
  v_max3_u32 v251, v139, v140, v141
  v_max3_u32 v250, v250, v142, v143
  v_max_u32 v250, v250, v251
  v_cmp_eq_u32 vcc, -1, v250
  s_cbranch_vccnz x1_0
  s_branch x1_0_b
x1_1:
  s_waitcnt vmcnt(0)
  s_cmp_eq_u32 s61, 0
  s_cbranch_scc1 x1_1_b
  s_sub_u32 s61, s61, 1
  s_add_u32 s57, s30, 4096
  buffer_load_dwordx4 v[144:147], v1, s[4:7], s57 offen offset:0 sc1
  s_add_u32 s57, s30, 4096
  buffer_load_dwordx4 v[148:151], v1, s[4:7], s57 offen offset:1024 sc1
  v_max3_u32 v250, v152, v153, v154
  v_max3_u32 v251, v155, v156, v157
  v_max3_u32 v250, v250, v158, v159
  v_max_u32 v250, v250, v251
  v_cmp_eq_u32 vcc, -1, v250
  s_cbranch_vccz x1_1_s0
  s_add_u32 s57, s30, 8192
  buffer_load_dwordx4 v[152:155], v1, s[4:7], s57 offen offset:0 sc1
  s_add_u32 s57, s30, 8192
  buffer_load_dwordx4 v[156:159], v1, s[4:7], s57 offen offset:1024 sc1
x1_1_s0:
  v_max3_u32 v250, v160, v161, v162
  v_max3_u32 v251, v163, v164, v165
  v_max3_u32 v250, v250, v166, v167
  v_max_u32 v250, v250, v251
  v_cmp_eq_u32 vcc, -1, v250
  s_cbranch_vccz x1_1_s1
  s_add_u32 s57, s30, 12288
  buffer_load_dwordx4 v[160:163], v1, s[4:7], s57 offen offset:0 sc1
  s_add_u32 s57, s30, 12288
  buffer_load_dwordx4 v[164:167], v1, s[4:7], s57 offen offset:1024 sc1
x1_1_s1:
  v_max3_u32 v250, v168, v169, v170
  v_max3_u32 v251, v171, v172, v173
  v_max3_u32 v250, v250, v174, v175
  v_max_u32 v250, v250, v251
  v_cmp_eq_u32 vcc, -1, v250
  s_cbranch_vccz x1_1_s2
  s_add_u32 s57, s30, 16384
  buffer_load_dwordx4 v[168:171], v1, s[4:7], s57 offen offset:0 sc1
  s_add_u32 s57, s30, 16384
  buffer_load_dwordx4 v[172:175], v1, s[4:7], s57 offen offset:1024 sc1
x1_1_s2:
  v_max3_u32 v250, v176, v177, v178
  v_max3_u32 v251, v179, v180, v181
  v_max3_u32 v250, v250, v182, v183
  v_max_u32 v250, v250, v251
  v_cmp_eq_u32 vcc, -1, v250
  s_cbranch_vccz x1_1_s3
  s_add_u32 s57, s30, 20480
  buffer_load_dwordx4 v[176:179], v1, s[4:7], s57 offen offset:0 sc1
  s_add_u32 s57, s30, 20480
  buffer_load_dwordx4 v[180:183], v1, s[4:7], s57 offen offset:1024 sc1
x1_1_s3:
  s_waitcnt vmcnt(0)
  v_max3_u32 v250, v144, v145, v146
  v_max3_u32 v251, v147, v148, v149
  v_max3_u32 v250, v250, v150, v151
  v_max_u32 v250, v250, v251
  v_cmp_eq_u32 vcc, -1, v250
  s_cbranch_vccnz x1_1
  s_branch x1_1_b
x1_2:
  s_waitcnt vmcnt(0)
  s_cmp_eq_u32 s61, 0
  s_cbranch_scc1 x1_2_b
  s_sub_u32 s61, s61, 1
  s_add_u32 s57, s30, 8192
  buffer_load_dwordx4 v[152:155], v1, s[4:7], s57 offen offset:0 sc1
  s_add_u32 s57, s30, 8192
  buffer_load_dwordx4 v[156:159], v1, s[4:7], s57 offen offset:1024 sc1
  v_max3_u32 v250, v160, v161, v162
  v_max3_u32 v251, v163, v164, v165
  v_max3_u32 v250, v250, v166, v167
  v_max_u32 v250, v250, v251
  v_cmp_eq_u32 vcc, -1, v250
  s_cbranch_vccz x1_2_s0
  s_add_u32 s57, s30, 12288
  buffer_load_dwordx4 v[160:163], v1, s[4:7], s57 offen offset:0 sc1
  s_add_u32 s57, s30, 12288
  buffer_load_dwordx4 v[164:167], v1, s[4:7], s57 offen offset:1024 sc1
x1_2_s0:
  v_max3_u32 v250, v168, v169, v170
  v_max3_u32 v251, v171, v172, v173
  v_max3_u32 v250, v250, v174, v175
  v_max_u32 v250, v250, v251
  v_cmp_eq_u32 vcc, -1, v250
  s_cbranch_vccz x1_2_s1
  s_add_u32 s57, s30, 16384
  buffer_load_dwordx4 v[168:171], v1, s[4:7], s57 offen offset:0 sc1
  s_add_u32 s57, s30, 16384
  buffer_load_dwordx4 v[172:175], v1, s[4:7], s57 offen offset:1024 sc1
x1_2_s1:
  v_max3_u32 v250, v176, v177, v178
  v_max3_u32 v251, v179, v180, v181
  v_max3_u32 v250, v250, v182, v183
  v_max_u32 v250, v250, v251
  v_cmp_eq_u32 vcc, -1, v250
  s_cbranch_vccz x1_2_s2
  s_add_u32 s57, s30, 20480
  buffer_load_dwordx4 v[176:179], v1, s[4:7], s57 offen offset:0 sc1
  s_add_u32 s57, s30, 20480
  buffer_load_dwordx4 v[180:183], v1, s[4:7], s57 offen offset:1024 sc1
x1_2_s2:
  v_max3_u32 v250, v184, v185, v186
  v_max3_u32 v251, v187, v188, v189
  v_max3_u32 v250, v250, v190, v191
  v_max_u32 v250, v250, v251
  v_cmp_eq_u32 vcc, -1, v250
  s_cbranch_vccz x1_2_s3
  s_add_u32 s57, s30, 24576
  buffer_load_dwordx4 v[184:187], v1, s[4:7], s57 offen offset:0 sc1
  s_add_u32 s57, s30, 24576
  buffer_load_dwordx4 v[188:191], v1, s[4:7], s57 offen offset:1024 sc1
x1_2_s3:
  v_max3_u32 v250, v192, v193, v194
  v_max3_u32 v251, v195, v196, v197
  v_max3_u32 v250, v250, v198, v199
  v_max_u32 v250, v250, v251
  v_cmp_eq_u32 vcc, -1, v250
  s_cbranch_vccz x1_2_s4
  s_add_u32 s57, s30, 28672
  buffer_load_dwordx4 v[192:195], v1, s[4:7], s57 offen offset:0 sc1
  s_add_u32 s57, s30, 28672
  buffer_load_dwordx4 v[196:199], v1, s[4:7], s57 offen offset:1024 sc1
x1_2_s4:
  s_waitcnt vmcnt(0)
  v_max3_u32 v250, v152, v153, v154
  v_max3_u32 v251, v155, v156, v157
  v_max3_u32 v250, v250, v158, v159
  v_max_u32 v250, v250, v251
  v_cmp_eq_u32 vcc, -1, v250
  s_cbranch_vccnz x1_2
  s_branch x1_2_b
x1_3:
  s_waitcnt vmcnt(0)
  s_cmp_eq_u32 s61, 0
  s_cbranch_scc1 x1_3_b
  s_sub_u32 s61, s61, 1
  s_add_u32 s57, s30, 12288
  buffer_load_dwordx4 v[160:163], v1, s[4:7], s57 offen offset:0 sc1
  s_add_u32 s57, s30, 12288
  buffer_load_dwordx4 v[164:167], v1, s[4:7], s57 offen offset:1024 sc1
  v_max3_u32 v250, v168, v169, v170
  v_max3_u32 v251, v171, v172, v173
  v_max3_u32 v250, v250, v174, v175
  v_max_u32 v250, v250, v251
  v_cmp_eq_u32 vcc, -1, v250
  s_cbranch_vccz x1_3_s0
  s_add_u32 s57, s30, 16384
  buffer_load_dwordx4 v[168:171], v1, s[4:7], s57 offen offset:0 sc1
  s_add_u32 s57, s30, 16384
  buffer_load_dwordx4 v[172:175], v1, s[4:7], s57 offen offset:1024 sc1
x1_3_s0:
  v_max3_u32 v250, v176, v177, v178
  v_max3_u32 v251, v179, v180, v181
  v_max3_u32 v250, v250, v182, v183
  v_max_u32 v250, v250, v251
  v_cmp_eq_u32 vcc, -1, v250
  s_cbranch_vccz x1_3_s1
  s_add_u32 s57, s30, 20480
  buffer_load_dwordx4 v[176:179], v1, s[4:7], s57 offen offset:0 sc1
  s_add_u32 s57, s30, 20480
  buffer_load_dwordx4 v[180:183], v1, s[4:7], s57 offen offset:1024 sc1
x1_3_s1:
  v_max3_u32 v250, v184, v185, v186
  v_max3_u32 v251, v187, v188, v189
  v_max3_u32 v250, v250, v190, v191
  v_max_u32 v250, v250, v251
  v_cmp_eq_u32 vcc, -1, v250
  s_cbranch_vccz x1_3_s2
  s_add_u32 s57, s30, 24576
  buffer_load_dwordx4 v[184:187], v1, s[4:7], s57 offen offset:0 sc1
  s_add_u32 s57, s30, 24576
  buffer_load_dwordx4 v[188:191], v1, s[4:7], s57 offen offset:1024 sc1
x1_3_s2:
  v_max3_u32 v250, v192, v193, v194
  v_max3_u32 v251, v195, v196, v197
  v_max3_u32 v250, v250, v198, v199
  v_max_u32 v250, v250, v251
  v_cmp_eq_u32 vcc, -1, v250
  s_cbranch_vccz x1_3_s3
  s_add_u32 s57, s30, 28672
  buffer_load_dwordx4 v[192:195], v1, s[4:7], s57 offen offset:0 sc1
  s_add_u32 s57, s30, 28672
  buffer_load_dwordx4 v[196:199], v1, s[4:7], s57 offen offset:1024 sc1
x1_3_s3:
  v_max3_u32 v250, v200, v201, v202
  v_max3_u32 v251, v203, v204, v205
  v_max3_u32 v250, v250, v206, v207
  v_max_u32 v250, v250, v251
  v_cmp_eq_u32 vcc, -1, v250
  s_cbranch_vccz x1_3_s4
  s_add_u32 s57, s30, 32768
  buffer_load_dwordx4 v[200:203], v1, s[4:7], s57 offen offset:0 sc1
  s_add_u32 s57, s30, 32768
  buffer_load_dwordx4 v[204:207], v1, s[4:7], s57 offen offset:1024 sc1
x1_3_s4:
  v_max3_u32 v250, v208, v209, v210
  v_max3_u32 v251, v211, v212, v213
  v_max3_u32 v250, v250, v214, v215
  v_max_u32 v250, v250, v251
  v_cmp_eq_u32 vcc, -1, v250
  s_cbranch_vccz x1_3_s5
  s_add_u32 s57, s30, 36864
  buffer_load_dwordx4 v[208:211], v1, s[4:7], s57 offen offset:0 sc1
  s_add_u32 s57, s30, 36864
  buffer_load_dwordx4 v[212:215], v1, s[4:7], s57 offen offset:1024 sc1
x1_3_s5:
  s_waitcnt vmcnt(0)
  v_max3_u32 v250, v160, v161, v162
  v_max3_u32 v251, v163, v164, v165
  v_max3_u32 v250, v250, v166, v167
  v_max_u32 v250, v250, v251
  v_cmp_eq_u32 vcc, -1, v250
  s_cbranch_vccnz x1_3
  s_branch x1_3_b
x1_4:
  s_waitcnt vmcnt(0)
  s_cmp_eq_u32 s61, 0
  s_cbranch_scc1 x1_4_b
  s_sub_u32 s61, s61, 1
  s_add_u32 s57, s30, 16384
  buffer_load_dwordx4 v[168:171], v1, s[4:7], s57 offen offset:0 sc1
  s_add_u32 s57, s30, 16384
  buffer_load_dwordx4 v[172:175], v1, s[4:7], s57 offen offset:1024 sc1
  v_max3_u32 v250, v176, v177, v178
  v_max3_u32 v251, v179, v180, v181
  v_max3_u32 v250, v250, v182, v183
  v_max_u32 v250, v250, v251
  v_cmp_eq_u32 vcc, -1, v250
  s_cbranch_vccz x1_4_s0
  s_add_u32 s57, s30, 20480
  buffer_load_dwordx4 v[176:179], v1, s[4:7], s57 offen offset:0 sc1
  s_add_u32 s57, s30, 20480
  buffer_load_dwordx4 v[180:183], v1, s[4:7], s57 offen offset:1024 sc1
x1_4_s0:
  v_max3_u32 v250, v184, v185, v186
  v_max3_u32 v251, v187, v188, v189
  v_max3_u32 v250, v250, v190, v191
  v_max_u32 v250, v250, v251
  v_cmp_eq_u32 vcc, -1, v250
  s_cbranch_vccz x1_4_s1
  s_add_u32 s57, s30, 24576
  buffer_load_dwordx4 v[184:187], v1, s[4:7], s57 offen offset:0 sc1
  s_add_u32 s57, s30, 24576
  buffer_load_dwordx4 v[188:191], v1, s[4:7], s57 offen offset:1024 sc1
x1_4_s1:
  v_max3_u32 v250, v192, v193, v194
  v_max3_u32 v251, v195, v196, v197
  v_max3_u32 v250, v250, v198, v199
  v_max_u32 v250, v250, v251
  v_cmp_eq_u32 vcc, -1, v250
  s_cbranch_vccz x1_4_s2
  s_add_u32 s57, s30, 28672
  buffer_load_dwordx4 v[192:195], v1, s[4:7], s57 offen offset:0 sc1
  s_add_u32 s57, s30, 28672
  buffer_load_dwordx4 v[196:199], v1, s[4:7], s57 offen offset:1024 sc1
x1_4_s2:
  v_max3_u32 v250, v200, v201, v202
  v_max3_u32 v251, v203, v204, v205
  v_max3_u32 v250, v250, v206, v207
  v_max_u32 v250, v250, v251
  v_cmp_eq_u32 vcc, -1, v250
  s_cbranch_vccz x1_4_s3
  s_add_u32 s57, s30, 32768
  buffer_load_dwordx4 v[200:203], v1, s[4:7], s57 offen offset:0 sc1
  s_add_u32 s57, s30, 32768
  buffer_load_dwordx4 v[204:207], v1, s[4:7], s57 offen offset:1024 sc1
x1_4_s3:
  v_max3_u32 v250, v208, v209, v210
  v_max3_u32 v251, v211, v212, v213
  v_max3_u32 v250, v250, v214, v215
  v_max_u32 v250, v250, v251
  v_cmp_eq_u32 vcc, -1, v250
  s_cbranch_vccz x1_4_s4
  s_add_u32 s57, s30, 36864
  buffer_load_dwordx4 v[208:211], v1, s[4:7], s57 offen offset:0 sc1
  s_add_u32 s57, s30, 36864
  buffer_load_dwordx4 v[212:215], v1, s[4:7], s57 offen offset:1024 sc1
x1_4_s4:
  s_waitcnt vmcnt(0)
  v_max3_u32 v250, v168, v169, v170
  v_max3_u32 v251, v171, v172, v173
  v_max3_u32 v250, v250, v174, v175
  v_max_u32 v250, v250, v251
  v_cmp_eq_u32 vcc, -1, v250
  s_cbranch_vccnz x1_4
  s_branch x1_4_b
x1_5:
  s_waitcnt vmcnt(0)
  s_cmp_eq_u32 s61, 0
  s_cbranch_scc1 x1_5_b
  s_sub_u32 s61, s61, 1
  s_add_u32 s57, s30, 20480
  buffer_load_dwordx4 v[176:179], v1, s[4:7], s57 offen offset:0 sc1
  s_add_u32 s57, s30, 20480
  buffer_load_dwordx4 v[180:183], v1, s[4:7], s57 offen offset:1024 sc1
  v_max3_u32 v250, v184, v185, v186
  v_max3_u32 v251, v187, v188, v189
  v_max3_u32 v250, v250, v190, v191
  v_max_u32 v250, v250, v251
  v_cmp_eq_u32 vcc, -1, v250
  s_cbranch_vccz x1_5_s0
  s_add_u32 s57, s30, 24576
  buffer_load_dwordx4 v[184:187], v1, s[4:7], s57 offen offset:0 sc1
  s_add_u32 s57, s30, 24576
  buffer_load_dwordx4 v[188:191], v1, s[4:7], s57 offen offset:1024 sc1
x1_5_s0:
  v_max3_u32 v250, v192, v193, v194
  v_max3_u32 v251, v195, v196, v197
  v_max3_u32 v250, v250, v198, v199
  v_max_u32 v250, v250, v251
  v_cmp_eq_u32 vcc, -1, v250
  s_cbranch_vccz x1_5_s1
  s_add_u32 s57, s30, 28672
  buffer_load_dwordx4 v[192:195], v1, s[4:7], s57 offen offset:0 sc1
  s_add_u32 s57, s30, 28672
  buffer_load_dwordx4 v[196:199], v1, s[4:7], s57 offen offset:1024 sc1
x1_5_s1:
  v_max3_u32 v250, v200, v201, v202
  v_max3_u32 v251, v203, v204, v205
  v_max3_u32 v250, v250, v206, v207
  v_max_u32 v250, v250, v251
  v_cmp_eq_u32 vcc, -1, v250
  s_cbranch_vccz x1_5_s2
  s_add_u32 s57, s30, 32768
  buffer_load_dwordx4 v[200:203], v1, s[4:7], s57 offen offset:0 sc1
  s_add_u32 s57, s30, 32768
  buffer_load_dwordx4 v[204:207], v1, s[4:7], s57 offen offset:1024 sc1
x1_5_s2:
  v_max3_u32 v250, v208, v209, v210
  v_max3_u32 v251, v211, v212, v213
  v_max3_u32 v250, v250, v214, v215
  v_max_u32 v250, v250, v251
  v_cmp_eq_u32 vcc, -1, v250
  s_cbranch_vccz x1_5_s3
  s_add_u32 s57, s30, 36864
  buffer_load_dwordx4 v[208:211], v1, s[4:7], s57 offen offset:0 sc1
  s_add_u32 s57, s30, 36864
  buffer_load_dwordx4 v[212:215], v1, s[4:7], s57 offen offset:1024 sc1
x1_5_s3:
  s_waitcnt vmcnt(0)
  v_max3_u32 v250, v176, v177, v178
  v_max3_u32 v251, v179, v180, v181
  v_max3_u32 v250, v250, v182, v183
  v_max_u32 v250, v250, v251
  v_cmp_eq_u32 vcc, -1, v250
  s_cbranch_vccnz x1_5
  s_branch x1_5_b
x1_6:
  s_waitcnt vmcnt(0)
  s_cmp_eq_u32 s61, 0
  s_cbranch_scc1 x1_6_b
  s_sub_u32 s61, s61, 1
  s_add_u32 s57, s30, 24576
  buffer_load_dwordx4 v[184:187], v1, s[4:7], s57 offen offset:0 sc1
  s_add_u32 s57, s30, 24576
  buffer_load_dwordx4 v[188:191], v1, s[4:7], s57 offen offset:1024 sc1
  v_max3_u32 v250, v192, v193, v194
  v_max3_u32 v251, v195, v196, v197
  v_max3_u32 v250, v250, v198, v199
  v_max_u32 v250, v250, v251
  v_cmp_eq_u32 vcc, -1, v250
  s_cbranch_vccz x1_6_s0
  s_add_u32 s57, s30, 28672
  buffer_load_dwordx4 v[192:195], v1, s[4:7], s57 offen offset:0 sc1
  s_add_u32 s57, s30, 28672
  buffer_load_dwordx4 v[196:199], v1, s[4:7], s57 offen offset:1024 sc1
x1_6_s0:
  v_max3_u32 v250, v200, v201, v202
  v_max3_u32 v251, v203, v204, v205
  v_max3_u32 v250, v250, v206, v207
  v_max_u32 v250, v250, v251
  v_cmp_eq_u32 vcc, -1, v250
  s_cbranch_vccz x1_6_s1
  s_add_u32 s57, s30, 32768
  buffer_load_dwordx4 v[200:203], v1, s[4:7], s57 offen offset:0 sc1
  s_add_u32 s57, s30, 32768
  buffer_load_dwordx4 v[204:207], v1, s[4:7], s57 offen offset:1024 sc1
x1_6_s1:
  v_max3_u32 v250, v208, v209, v210
  v_max3_u32 v251, v211, v212, v213
  v_max3_u32 v250, v250, v214, v215
  v_max_u32 v250, v250, v251
  v_cmp_eq_u32 vcc, -1, v250
  s_cbranch_vccz x1_6_s2
  s_add_u32 s57, s30, 36864
  buffer_load_dwordx4 v[208:211], v1, s[4:7], s57 offen offset:0 sc1
  s_add_u32 s57, s30, 36864
  buffer_load_dwordx4 v[212:215], v1, s[4:7], s57 offen offset:1024 sc1
x1_6_s2:
  s_waitcnt vmcnt(0)
  v_max3_u32 v250, v184, v185, v186
  v_max3_u32 v251, v187, v188, v189
  v_max3_u32 v250, v250, v190, v191
  v_max_u32 v250, v250, v251
  v_cmp_eq_u32 vcc, -1, v250
  s_cbranch_vccnz x1_6
  s_branch x1_6_b
x1_7:
  s_waitcnt vmcnt(0)
  s_cmp_eq_u32 s61, 0
  s_cbranch_scc1 x1_7_b
  s_sub_u32 s61, s61, 1
  s_add_u32 s57, s30, 28672
  buffer_load_dwordx4 v[192:195], v1, s[4:7], s57 offen offset:0 sc1
  s_add_u32 s57, s30, 28672
  buffer_load_dwordx4 v[196:199], v1, s[4:7], s57 offen offset:1024 sc1
  v_max3_u32 v250, v200, v201, v202
  v_max3_u32 v251, v203, v204, v205
  v_max3_u32 v250, v250, v206, v207
  v_max_u32 v250, v250, v251
  v_cmp_eq_u32 vcc, -1, v250
  s_cbranch_vccz x1_7_s0
  s_add_u32 s57, s30, 32768
  buffer_load_dwordx4 v[200:203], v1, s[4:7], s57 offen offset:0 sc1
  s_add_u32 s57, s30, 32768
  buffer_load_dwordx4 v[204:207], v1, s[4:7], s57 offen offset:1024 sc1
x1_7_s0:
  v_max3_u32 v250, v208, v209, v210
  v_max3_u32 v251, v211, v212, v213
  v_max3_u32 v250, v250, v214, v215
  v_max_u32 v250, v250, v251
  v_cmp_eq_u32 vcc, -1, v250
  s_cbranch_vccz x1_7_s1
  s_add_u32 s57, s30, 36864
  buffer_load_dwordx4 v[208:211], v1, s[4:7], s57 offen offset:0 sc1
  s_add_u32 s57, s30, 36864
  buffer_load_dwordx4 v[212:215], v1, s[4:7], s57 offen offset:1024 sc1
x1_7_s1:
  s_waitcnt vmcnt(0)
  v_max3_u32 v250, v192, v193, v194
  v_max3_u32 v251, v195, v196, v197
  v_max3_u32 v250, v250, v198, v199
  v_max_u32 v250, v250, v251
  v_cmp_eq_u32 vcc, -1, v250
  s_cbranch_vccnz x1_7
  s_branch x1_7_b
x1_8:
  s_waitcnt vmcnt(0)
  s_cmp_eq_u32 s61, 0
  s_cbranch_scc1 x1_8_b
  s_sub_u32 s61, s61, 1
  s_add_u32 s57, s30, 32768
  buffer_load_dwordx4 v[200:203], v1, s[4:7], s57 offen offset:0 sc1
  s_add_u32 s57, s30, 32768
  buffer_load_dwordx4 v[204:207], v1, s[4:7], s57 offen offset:1024 sc1
  v_max3_u32 v250, v208, v209, v210
  v_max3_u32 v251, v211, v212, v213
  v_max3_u32 v250, v250, v214, v215
  v_max_u32 v250, v250, v251
  v_cmp_eq_u32 vcc, -1, v250
  s_cbranch_vccz x1_8_s0
  s_add_u32 s57, s30, 36864
  buffer_load_dwordx4 v[208:211], v1, s[4:7], s57 offen offset:0 sc1
  s_add_u32 s57, s30, 36864
  buffer_load_dwordx4 v[212:215], v1, s[4:7], s57 offen offset:1024 sc1
x1_8_s0:
  s_waitcnt vmcnt(0)
  v_max3_u32 v250, v200, v201, v202
  v_max3_u32 v251, v203, v204, v205
  v_max3_u32 v250, v250, v206, v207
  v_max_u32 v250, v250, v251
  v_cmp_eq_u32 vcc, -1, v250
  s_cbranch_vccnz x1_8
  s_branch x1_8_b
x1_9:
  s_waitcnt vmcnt(0)
  s_cmp_eq_u32 s61, 0
  s_cbranch_scc1 x1_9_b
  s_sub_u32 s61, s61, 1
  s_add_u32 s57, s30, 36864
  buffer_load_dwordx4 v[208:211], v1, s[4:7], s57 offen offset:0 sc1
  s_add_u32 s57, s30, 36864
  buffer_load_dwordx4 v[212:215], v1, s[4:7], s57 offen offset:1024 sc1
  s_waitcnt vmcnt(0)
  v_max3_u32 v250, v208, v209, v210
  v_max3_u32 v251, v211, v212, v213
  v_max3_u32 v250, v250, v214, v215
  v_max_u32 v250, v250, v251
  v_cmp_eq_u32 vcc, -1, v250
  s_cbranch_vccnz x1_9
  s_branch x1_9_b
x2_0:
  s_waitcnt vmcnt(0)
  s_cmp_eq_u32 s61, 0
  s_cbranch_scc1 x2_0_b
  s_sub_u32 s61, s61, 1
  s_add_u32 s57, s30, 0
  buffer_load_dwordx4 v[136:139], v5, s[4:7], s57 offen offset:0 sc1
  s_add_u32 s57, s30, 0
  buffer_load_dwordx4 v[140:143], v6, s[4:7], s57 offen offset:0 sc1
  v_max3_u32 v250, v144, v145, v146
  v_max3_u32 v251, v147, v148, v149
  v_max3_u32 v250, v250, v150, v151
  v_max_u32 v250, v250, v251
  v_cmp_eq_u32 vcc, -1, v250
  s_cbranch_vccz x2_0_s0
  s_add_u32 s57, s30, 0
  buffer_load_dwordx4 v[144:147], v5, s[4:7], s57 offen offset:1024 sc1
  s_add_u32 s57, s30, 0
  buffer_load_dwordx4 v[148:151], v6, s[4:7], s57 offen offset:1024 sc1
x2_0_s0:
  v_max3_u32 v250, v152, v153, v154
  v_max3_u32 v251, v155, v156, v157
  v_max3_u32 v250, v250, v158, v159
  v_max_u32 v250, v250, v251
  v_cmp_eq_u32 vcc, -1, v250
  s_cbranch_vccz x2_0_s1
  s_add_u32 s57, s30, 0
  buffer_load_dwordx4 v[152:155], v5, s[4:7], s57 offen offset:2048 sc1
  s_add_u32 s57, s30, 0
  buffer_load_dwordx4 v[156:159], v6, s[4:7], s57 offen offset:2048 sc1
x2_0_s1:
  v_max3_u32 v250, v160, v161, v162
  v_max3_u32 v251, v163, v164, v165
  v_max3_u32 v250, v250, v166, v167
  v_max_u32 v250, v250, v251
  v_cmp_eq_u32 vcc, -1, v250
  s_cbranch_vccz x2_0_s2
  s_add_u32 s57, s30, 0
  buffer_load_dwordx4 v[160:163], v5, s[4:7], s57 offen offset:3072 sc1
  s_add_u32 s57, s30, 0
  buffer_load_dwordx4 v[164:167], v6, s[4:7], s57 offen offset:3072 sc1
x2_0_s2:
  s_waitcnt vmcnt(0)
  v_max3_u32 v250, v136, v137, v138
  v_max3_u32 v251, v139, v140, v141
  v_max3_u32 v250, v250, v142, v143
  v_max_u32 v250, v250, v251
  v_cmp_eq_u32 vcc, -1, v250
  s_cbranch_vccnz x2_0
  s_branch x2_0_b
x2_1:
  s_waitcnt vmcnt(0)
  s_cmp_eq_u32 s61, 0
  s_cbranch_scc1 x2_1_b
  s_sub_u32 s61, s61, 1
  s_add_u32 s57, s30, 0
  buffer_load_dwordx4 v[144:147], v5, s[4:7], s57 offen offset:1024 sc1
  s_add_u32 s57, s30, 0
  buffer_load_dwordx4 v[148:151], v6, s[4:7], s57 offen offset:1024 sc1
  v_max3_u32 v250, v152, v153, v154
  v_max3_u32 v251, v155, v156, v157
  v_max3_u32 v250, v250, v158, v159
  v_max_u32 v250, v250, v251
  v_cmp_eq_u32 vcc, -1, v250
  s_cbranch_vccz x2_1_s0
  s_add_u32 s57, s30, 0
  buffer_load_dwordx4 v[152:155], v5, s[4:7], s57 offen offset:2048 sc1
  s_add_u32 s57, s30, 0
  buffer_load_dwordx4 v[156:159], v6, s[4:7], s57 offen offset:2048 sc1
x2_1_s0:
  v_max3_u32 v250, v160, v161, v162
  v_max3_u32 v251, v163, v164, v165
  v_max3_u32 v250, v250, v166, v167
  v_max_u32 v250, v250, v251
  v_cmp_eq_u32 vcc, -1, v250
  s_cbranch_vccz x2_1_s1
  s_add_u32 s57, s30, 0
  buffer_load_dwordx4 v[160:163], v5, s[4:7], s57 offen offset:3072 sc1
  s_add_u32 s57, s30, 0
  buffer_load_dwordx4 v[164:167], v6, s[4:7], s57 offen offset:3072 sc1
x2_1_s1:
  v_max3_u32 v250, v168, v169, v170
  v_max3_u32 v251, v171, v172, v173
  v_max3_u32 v250, v250, v174, v175
  v_max_u32 v250, v250, v251
  v_cmp_eq_u32 vcc, -1, v250
  s_cbranch_vccz x2_1_s2
  s_add_u32 s57, s30, 4096
  buffer_load_dwordx4 v[168:171], v7, s[4:7], s57 offen offset:0 sc1
  s_add_u32 s57, s30, 4096
  buffer_load_dwordx4 v[172:175], v8, s[4:7], s57 offen offset:0 sc1
x2_1_s2:
  v_max3_u32 v250, v176, v177, v178
  v_max3_u32 v251, v179, v180, v181
  v_max3_u32 v250, v250, v182, v183
  v_max_u32 v250, v250, v251
  v_cmp_eq_u32 vcc, -1, v250
  s_cbranch_vccz x2_1_s3
  s_add_u32 s57, s30, 4096
  buffer_load_dwordx4 v[176:179], v7, s[4:7], s57 offen offset:1024 sc1
  s_add_u32 s57, s30, 4096
  buffer_load_dwordx4 v[180:183], v8, s[4:7], s57 offen offset:1024 sc1
x2_1_s3:
  s_waitcnt vmcnt(0)
  v_max3_u32 v250, v144, v145, v146
  v_max3_u32 v251, v147, v148, v149
  v_max3_u32 v250, v250, v150, v151
  v_max_u32 v250, v250, v251
  v_cmp_eq_u32 vcc, -1, v250
  s_cbranch_vccnz x2_1
  s_branch x2_1_b
x2_2:
  s_waitcnt vmcnt(0)
  s_cmp_eq_u32 s61, 0
  s_cbranch_scc1 x2_2_b
  s_sub_u32 s61, s61, 1
  s_add_u32 s57, s30, 0
  buffer_load_dwordx4 v[152:155], v5, s[4:7], s57 offen offset:2048 sc1
  s_add_u32 s57, s30, 0
  buffer_load_dwordx4 v[156:159], v6, s[4:7], s57 offen offset:2048 sc1
  v_max3_u32 v250, v160, v161, v162
  v_max3_u32 v251, v163, v164, v165
  v_max3_u32 v250, v250, v166, v167
  v_max_u32 v250, v250, v251
  v_cmp_eq_u32 vcc, -1, v250
  s_cbranch_vccz x2_2_s0
  s_add_u32 s57, s30, 0
  buffer_load_dwordx4 v[160:163], v5, s[4:7], s57 offen offset:3072 sc1
  s_add_u32 s57, s30, 0
  buffer_load_dwordx4 v[164:167], v6, s[4:7], s57 offen offset:3072 sc1
x2_2_s0:
  v_max3_u32 v250, v168, v169, v170
  v_max3_u32 v251, v171, v172, v173
  v_max3_u32 v250, v250, v174, v175
  v_max_u32 v250, v250, v251
  v_cmp_eq_u32 vcc, -1, v250
  s_cbranch_vccz x2_2_s1
  s_add_u32 s57, s30, 4096
  buffer_load_dwordx4 v[168:171], v7, s[4:7], s57 offen offset:0 sc1
  s_add_u32 s57, s30, 4096
  buffer_load_dwordx4 v[172:175], v8, s[4:7], s57 offen offset:0 sc1
x2_2_s1:
  v_max3_u32 v250, v176, v177, v178
  v_max3_u32 v251, v179, v180, v181
  v_max3_u32 v250, v250, v182, v183
  v_max_u32 v250, v250, v251
  v_cmp_eq_u32 vcc, -1, v250
  s_cbranch_vccz x2_2_s2
  s_add_u32 s57, s30, 4096
  buffer_load_dwordx4 v[176:179], v7, s[4:7], s57 offen offset:1024 sc1
  s_add_u32 s57, s30, 4096
  buffer_load_dwordx4 v[180:183], v8, s[4:7], s57 offen offset:1024 sc1
x2_2_s2:
  v_max3_u32 v250, v184, v185, v186
  v_max3_u32 v251, v187, v188, v189
  v_max3_u32 v250, v250, v190, v191
  v_max_u32 v250, v250, v251
  v_cmp_eq_u32 vcc, -1, v250
  s_cbranch_vccz x2_2_s3
  s_add_u32 s57, s30, 4096
  buffer_load_dwordx4 v[184:187], v7, s[4:7], s57 offen offset:2048 sc1
  s_add_u32 s57, s30, 4096
  buffer_load_dwordx4 v[188:191], v8, s[4:7], s57 offen offset:2048 sc1
x2_2_s3:
  v_max3_u32 v250, v192, v193, v194
  v_max3_u32 v251, v195, v196, v197
  v_max3_u32 v250, v250, v198, v199
  v_max_u32 v250, v250, v251
  v_cmp_eq_u32 vcc, -1, v250
  s_cbranch_vccz x2_2_s4
  s_add_u32 s57, s30, 4096
  buffer_load_dwordx4 v[192:195], v7, s[4:7], s57 offen offset:3072 sc1
  s_add_u32 s57, s30, 4096
  buffer_load_dwordx4 v[196:199], v8, s[4:7], s57 offen offset:3072 sc1
x2_2_s4:
  s_waitcnt vmcnt(0)
  v_max3_u32 v250, v152, v153, v154
  v_max3_u32 v251, v155, v156, v157
  v_max3_u32 v250, v250, v158, v159
  v_max_u32 v250, v250, v251
  v_cmp_eq_u32 vcc, -1, v250
  s_cbranch_vccnz x2_2
  s_branch x2_2_b
x2_3:
  s_waitcnt vmcnt(0)
  s_cmp_eq_u32 s61, 0
  s_cbranch_scc1 x2_3_b
  s_sub_u32 s61, s61, 1
  s_add_u32 s57, s30, 0
  buffer_load_dwordx4 v[160:163], v5, s[4:7], s57 offen offset:3072 sc1
  s_add_u32 s57, s30, 0
  buffer_load_dwordx4 v[164:167], v6, s[4:7], s57 offen offset:3072 sc1
  v_max3_u32 v250, v168, v169, v170
  v_max3_u32 v251, v171, v172, v173
  v_max3_u32 v250, v250, v174, v175
  v_max_u32 v250, v250, v251
  v_cmp_eq_u32 vcc, -1, v250
  s_cbranch_vccz x2_3_s0
  s_add_u32 s57, s30, 4096
  buffer_load_dwordx4 v[168:171], v7, s[4:7], s57 offen offset:0 sc1
  s_add_u32 s57, s30, 4096
  buffer_load_dwordx4 v[172:175], v8, s[4:7], s57 offen offset:0 sc1
x2_3_s0:
  v_max3_u32 v250, v176, v177, v178
  v_max3_u32 v251, v179, v180, v181
  v_max3_u32 v250, v250, v182, v183
  v_max_u32 v250, v250, v251
  v_cmp_eq_u32 vcc, -1, v250
  s_cbranch_vccz x2_3_s1
  s_add_u32 s57, s30, 4096
  buffer_load_dwordx4 v[176:179], v7, s[4:7], s57 offen offset:1024 sc1
  s_add_u32 s57, s30, 4096
  buffer_load_dwordx4 v[180:183], v8, s[4:7], s57 offen offset:1024 sc1
x2_3_s1:
  v_max3_u32 v250, v184, v185, v186
  v_max3_u32 v251, v187, v188, v189
  v_max3_u32 v250, v250, v190, v191
  v_max_u32 v250, v250, v251
  v_cmp_eq_u32 vcc, -1, v250
  s_cbranch_vccz x2_3_s2
  s_add_u32 s57, s30, 4096
  buffer_load_dwordx4 v[184:187], v7, s[4:7], s57 offen offset:2048 sc1
  s_add_u32 s57, s30, 4096
  buffer_load_dwordx4 v[188:191], v8, s[4:7], s57 offen offset:2048 sc1
x2_3_s2:
  v_max3_u32 v250, v192, v193, v194
  v_max3_u32 v251, v195, v196, v197
  v_max3_u32 v250, v250, v198, v199
  v_max_u32 v250, v250, v251
  v_cmp_eq_u32 vcc, -1, v250
  s_cbranch_vccz x2_3_s3
  s_add_u32 s57, s30, 4096
  buffer_load_dwordx4 v[192:195], v7, s[4:7], s57 offen offset:3072 sc1
  s_add_u32 s57, s30, 4096
  buffer_load_dwordx4 v[196:199], v8, s[4:7], s57 offen offset:3072 sc1
x2_3_s3:
  v_max3_u32 v250, v200, v201, v202
  v_max3_u32 v251, v203, v204, v205
  v_max3_u32 v250, v250, v206, v207
  v_max_u32 v250, v250, v251
  v_cmp_eq_u32 vcc, -1, v250
  s_cbranch_vccz x2_3_s4
  s_add_u32 s57, s31, 0
  buffer_load_dwordx4 v[200:203], v5, s[4:7], s57 offen offset:0 sc1
  s_add_u32 s57, s31, 0
  buffer_load_dwordx4 v[204:207], v6, s[4:7], s57 offen offset:0 sc1
x2_3_s4:
  v_max3_u32 v250, v208, v209, v210
  v_max3_u32 v251, v211, v212, v213
  v_max3_u32 v250, v250, v214, v215
  v_max_u32 v250, v250, v251
  v_cmp_eq_u32 vcc, -1, v250
  s_cbranch_vccz x2_3_s5
  s_add_u32 s57, s31, 0
  buffer_load_dwordx4 v[208:211], v7, s[4:7], s57 offen offset:1024 sc1
  s_add_u32 s57, s31, 0
  buffer_load_dwordx4 v[212:215], v8, s[4:7], s57 offen offset:1024 sc1
x2_3_s5:
  s_waitcnt vmcnt(0)
  v_max3_u32 v250, v160, v161, v162
  v_max3_u32 v251, v163, v164, v165
  v_max3_u32 v250, v250, v166, v167
  v_max_u32 v250, v250, v251
  v_cmp_eq_u32 vcc, -1, v250
  s_cbranch_vccnz x2_3
  s_branch x2_3_b
x2_4:
  s_waitcnt vmcnt(0)
  s_cmp_eq_u32 s61, 0
  s_cbranch_scc1 x2_4_b
  s_sub_u32 s61, s61, 1
  s_add_u32 s57, s30, 4096
  buffer_load_dwordx4 v[168:171], v7, s[4:7], s57 offen offset:0 sc1
  s_add_u32 s57, s30, 4096
  buffer_load_dwordx4 v[172:175], v8, s[4:7], s57 offen offset:0 sc1
  v_max3_u32 v250, v176, v177, v178
  v_max3_u32 v251, v179, v180, v181
  v_max3_u32 v250, v250, v182, v183
  v_max_u32 v250, v250, v251
  v_cmp_eq_u32 vcc, -1, v250
  s_cbranch_vccz x2_4_s0
  s_add_u32 s57, s30, 4096
  buffer_load_dwordx4 v[176:179], v7, s[4:7], s57 offen offset:1024 sc1
  s_add_u32 s57, s30, 4096
  buffer_load_dwordx4 v[180:183], v8, s[4:7], s57 offen offset:1024 sc1
x2_4_s0:
  v_max3_u32 v250, v184, v185, v186
  v_max3_u32 v251, v187, v188, v189
  v_max3_u32 v250, v250, v190, v191
  v_max_u32 v250, v250, v251
  v_cmp_eq_u32 vcc, -1, v250
  s_cbranch_vccz x2_4_s1
  s_add_u32 s57, s30, 4096
  buffer_load_dwordx4 v[184:187], v7, s[4:7], s57 offen offset:2048 sc1
  s_add_u32 s57, s30, 4096
  buffer_load_dwordx4 v[188:191], v8, s[4:7], s57 offen offset:2048 sc1
x2_4_s1:
  v_max3_u32 v250, v192, v193, v194
  v_max3_u32 v251, v195, v196, v197
  v_max3_u32 v250, v250, v198, v199
  v_max_u32 v250, v250, v251
  v_cmp_eq_u32 vcc, -1, v250
  s_cbranch_vccz x2_4_s2
  s_add_u32 s57, s30, 4096
  buffer_load_dwordx4 v[192:195], v7, s[4:7], s57 offen offset:3072 sc1
  s_add_u32 s57, s30, 4096
  buffer_load_dwordx4 v[196:199], v8, s[4:7], s57 offen offset:3072 sc1
x2_4_s2:
  v_max3_u32 v250, v200, v201, v202
  v_max3_u32 v251, v203, v204, v205
  v_max3_u32 v250, v250, v206, v207
  v_max_u32 v250, v250, v251
  v_cmp_eq_u32 vcc, -1, v250
  s_cbranch_vccz x2_4_s3
  s_add_u32 s57, s31, 0
  buffer_load_dwordx4 v[200:203], v5, s[4:7], s57 offen offset:0 sc1
  s_add_u32 s57, s31, 0
  buffer_load_dwordx4 v[204:207], v6, s[4:7], s57 offen offset:0 sc1
x2_4_s3:
  v_max3_u32 v250, v208, v209, v210
  v_max3_u32 v251, v211, v212, v213
  v_max3_u32 v250, v250, v214, v215
  v_max_u32 v250, v250, v251
  v_cmp_eq_u32 vcc, -1, v250
  s_cbranch_vccz x2_4_s4
  s_add_u32 s57, s31, 0
  buffer_load_dwordx4 v[208:211], v7, s[4:7], s57 offen offset:1024 sc1
  s_add_u32 s57, s31, 0
  buffer_load_dwordx4 v[212:215], v8, s[4:7], s57 offen offset:1024 sc1
x2_4_s4:
  s_waitcnt vmcnt(0)
  v_max3_u32 v250, v168, v169, v170
  v_max3_u32 v251, v171, v172, v173
  v_max3_u32 v250, v250, v174, v175
  v_max_u32 v250, v250, v251
  v_cmp_eq_u32 vcc, -1, v250
  s_cbranch_vccnz x2_4
  s_branch x2_4_b
x2_5:
  s_waitcnt vmcnt(0)
  s_cmp_eq_u32 s61, 0
  s_cbranch_scc1 x2_5_b
  s_sub_u32 s61, s61, 1
  s_add_u32 s57, s30, 4096
  buffer_load_dwordx4 v[176:179], v7, s[4:7], s57 offen offset:1024 sc1
  s_add_u32 s57, s30, 4096
  buffer_load_dwordx4 v[180:183], v8, s[4:7], s57 offen offset:1024 sc1
  v_max3_u32 v250, v184, v185, v186
  v_max3_u32 v251, v187, v188, v189
  v_max3_u32 v250, v250, v190, v191
  v_max_u32 v250, v250, v251
  v_cmp_eq_u32 vcc, -1, v250
  s_cbranch_vccz x2_5_s0
  s_add_u32 s57, s30, 4096
  buffer_load_dwordx4 v[184:187], v7, s[4:7], s57 offen offset:2048 sc1
  s_add_u32 s57, s30, 4096
  buffer_load_dwordx4 v[188:191], v8, s[4:7], s57 offen offset:2048 sc1
x2_5_s0:
  v_max3_u32 v250, v192, v193, v194
  v_max3_u32 v251, v195, v196, v197
  v_max3_u32 v250, v250, v198, v199
  v_max_u32 v250, v250, v251
  v_cmp_eq_u32 vcc, -1, v250
  s_cbranch_vccz x2_5_s1
  s_add_u32 s57, s30, 4096
  buffer_load_dwordx4 v[192:195], v7, s[4:7], s57 offen offset:3072 sc1
  s_add_u32 s57, s30, 4096
  buffer_load_dwordx4 v[196:199], v8, s[4:7], s57 offen offset:3072 sc1
x2_5_s1:
  v_max3_u32 v250, v200, v201, v202
  v_max3_u32 v251, v203, v204, v205
  v_max3_u32 v250, v250, v206, v207
  v_max_u32 v250, v250, v251
  v_cmp_eq_u32 vcc, -1, v250
  s_cbranch_vccz x2_5_s2
  s_add_u32 s57, s31, 0
  buffer_load_dwordx4 v[200:203], v5, s[4:7], s57 offen offset:0 sc1
  s_add_u32 s57, s31, 0
  buffer_load_dwordx4 v[204:207], v6, s[4:7], s57 offen offset:0 sc1
x2_5_s2:
  v_max3_u32 v250, v208, v209, v210
  v_max3_u32 v251, v211, v212, v213
  v_max3_u32 v250, v250, v214, v215
  v_max_u32 v250, v250, v251
  v_cmp_eq_u32 vcc, -1, v250
  s_cbranch_vccz x2_5_s3
  s_add_u32 s57, s31, 0
  buffer_load_dwordx4 v[208:211], v7, s[4:7], s57 offen offset:1024 sc1
  s_add_u32 s57, s31, 0
  buffer_load_dwordx4 v[212:215], v8, s[4:7], s57 offen offset:1024 sc1
x2_5_s3:
  s_waitcnt vmcnt(0)
  v_max3_u32 v250, v176, v177, v178
  v_max3_u32 v251, v179, v180, v181
  v_max3_u32 v250, v250, v182, v183
  v_max_u32 v250, v250, v251
  v_cmp_eq_u32 vcc, -1, v250
  s_cbranch_vccnz x2_5
  s_branch x2_5_b
x2_6:
  s_waitcnt vmcnt(0)
  s_cmp_eq_u32 s61, 0
  s_cbranch_scc1 x2_6_b
  s_sub_u32 s61, s61, 1
  s_add_u32 s57, s30, 4096
  buffer_load_dwordx4 v[184:187], v7, s[4:7], s57 offen offset:2048 sc1
  s_add_u32 s57, s30, 4096
  buffer_load_dwordx4 v[188:191], v8, s[4:7], s57 offen offset:2048 sc1
  v_max3_u32 v250, v192, v193, v194
  v_max3_u32 v251, v195, v196, v197
  v_max3_u32 v250, v250, v198, v199
  v_max_u32 v250, v250, v251
  v_cmp_eq_u32 vcc, -1, v250
  s_cbranch_vccz x2_6_s0
  s_add_u32 s57, s30, 4096
  buffer_load_dwordx4 v[192:195], v7, s[4:7], s57 offen offset:3072 sc1
  s_add_u32 s57, s30, 4096
  buffer_load_dwordx4 v[196:199], v8, s[4:7], s57 offen offset:3072 sc1
x2_6_s0:
  v_max3_u32 v250, v200, v201, v202
  v_max3_u32 v251, v203, v204, v205
  v_max3_u32 v250, v250, v206, v207
  v_max_u32 v250, v250, v251
  v_cmp_eq_u32 vcc, -1, v250
  s_cbranch_vccz x2_6_s1
  s_add_u32 s57, s31, 0
  buffer_load_dwordx4 v[200:203], v5, s[4:7], s57 offen offset:0 sc1
  s_add_u32 s57, s31, 0
  buffer_load_dwordx4 v[204:207], v6, s[4:7], s57 offen offset:0 sc1
x2_6_s1:
  v_max3_u32 v250, v208, v209, v210
  v_max3_u32 v251, v211, v212, v213
  v_max3_u32 v250, v250, v214, v215
  v_max_u32 v250, v250, v251
  v_cmp_eq_u32 vcc, -1, v250
  s_cbranch_vccz x2_6_s2
  s_add_u32 s57, s31, 0
  buffer_load_dwordx4 v[208:211], v7, s[4:7], s57 offen offset:1024 sc1
  s_add_u32 s57, s31, 0
  buffer_load_dwordx4 v[212:215], v8, s[4:7], s57 offen offset:1024 sc1
x2_6_s2:
  s_waitcnt vmcnt(0)
  v_max3_u32 v250, v184, v185, v186
  v_max3_u32 v251, v187, v188, v189
  v_max3_u32 v250, v250, v190, v191
  v_max_u32 v250, v250, v251
  v_cmp_eq_u32 vcc, -1, v250
  s_cbranch_vccnz x2_6
  s_branch x2_6_b
x2_7:
  s_waitcnt vmcnt(0)
  s_cmp_eq_u32 s61, 0
  s_cbranch_scc1 x2_7_b
  s_sub_u32 s61, s61, 1
  s_add_u32 s57, s30, 4096
  buffer_load_dwordx4 v[192:195], v7, s[4:7], s57 offen offset:3072 sc1
  s_add_u32 s57, s30, 4096
  buffer_load_dwordx4 v[196:199], v8, s[4:7], s57 offen offset:3072 sc1
  v_max3_u32 v250, v200, v201, v202
  v_max3_u32 v251, v203, v204, v205
  v_max3_u32 v250, v250, v206, v207
  v_max_u32 v250, v250, v251
  v_cmp_eq_u32 vcc, -1, v250
  s_cbranch_vccz x2_7_s0
  s_add_u32 s57, s31, 0
  buffer_load_dwordx4 v[200:203], v5, s[4:7], s57 offen offset:0 sc1
  s_add_u32 s57, s31, 0
  buffer_load_dwordx4 v[204:207], v6, s[4:7], s57 offen offset:0 sc1
x2_7_s0:
  v_max3_u32 v250, v208, v209, v210
  v_max3_u32 v251, v211, v212, v213
  v_max3_u32 v250, v250, v214, v215
  v_max_u32 v250, v250, v251
  v_cmp_eq_u32 vcc, -1, v250
  s_cbranch_vccz x2_7_s1
  s_add_u32 s57, s31, 0
  buffer_load_dwordx4 v[208:211], v7, s[4:7], s57 offen offset:1024 sc1
  s_add_u32 s57, s31, 0
  buffer_load_dwordx4 v[212:215], v8, s[4:7], s57 offen offset:1024 sc1
x2_7_s1:
  s_waitcnt vmcnt(0)
  v_max3_u32 v250, v192, v193, v194
  v_max3_u32 v251, v195, v196, v197
  v_max3_u32 v250, v250, v198, v199
  v_max_u32 v250, v250, v251
  v_cmp_eq_u32 vcc, -1, v250
  s_cbranch_vccnz x2_7
  s_branch x2_7_b
x2_8:
  s_waitcnt vmcnt(0)
  s_cmp_eq_u32 s61, 0
  s_cbranch_scc1 x2_8_b
  s_sub_u32 s61, s61, 1
  s_add_u32 s57, s31, 0
  buffer_load_dwordx4 v[200:203], v5, s[4:7], s57 offen offset:0 sc1
  s_add_u32 s57, s31, 0
  buffer_load_dwordx4 v[204:207], v6, s[4:7], s57 offen offset:0 sc1
  v_max3_u32 v250, v208, v209, v210
  v_max3_u32 v251, v211, v212, v213
  v_max3_u32 v250, v250, v214, v215
  v_max_u32 v250, v250, v251
  v_cmp_eq_u32 vcc, -1, v250
  s_cbranch_vccz x2_8_s0
  s_add_u32 s57, s31, 0
  buffer_load_dwordx4 v[208:211], v7, s[4:7], s57 offen offset:1024 sc1
  s_add_u32 s57, s31, 0
  buffer_load_dwordx4 v[212:215], v8, s[4:7], s57 offen offset:1024 sc1
x2_8_s0:
  s_waitcnt vmcnt(0)
  v_max3_u32 v250, v200, v201, v202
  v_max3_u32 v251, v203, v204, v205
  v_max3_u32 v250, v250, v206, v207
  v_max_u32 v250, v250, v251
  v_cmp_eq_u32 vcc, -1, v250
  s_cbranch_vccnz x2_8
  s_branch x2_8_b
x2_9:
  s_waitcnt vmcnt(0)
  s_cmp_eq_u32 s61, 0
  s_cbranch_scc1 x2_9_b
  s_sub_u32 s61, s61, 1
  s_add_u32 s57, s31, 0
  buffer_load_dwordx4 v[208:211], v7, s[4:7], s57 offen offset:1024 sc1
  s_add_u32 s57, s31, 0
  buffer_load_dwordx4 v[212:215], v8, s[4:7], s57 offen offset:1024 sc1
  s_waitcnt vmcnt(0)
  v_max3_u32 v250, v208, v209, v210
  v_max3_u32 v251, v211, v212, v213
  v_max3_u32 v250, v250, v214, v215
  v_max_u32 v250, v250, v251
  v_cmp_eq_u32 vcc, -1, v250
  s_cbranch_vccnz x2_9
  s_branch x2_9_b
ps3:
  s_waitcnt vmcnt(0)
  s_cmp_eq_u32 s61, 0
  s_cbranch_scc1 ps3_b
  s_sub_u32 s61, s61, 1
  buffer_load_dwordx2 v[208:209], v7, s[4:7], s29 offen offset:0 sc1
  buffer_load_dwordx2 v[210:211], v7, s[4:7], s29 offen offset:128 sc1
  buffer_load_dwordx2 v[212:213], v7, s[4:7], s29 offen offset:1024 sc1
  buffer_load_dwordx2 v[214:215], v7, s[4:7], s29 offen offset:1152 sc1
  s_waitcnt vmcnt(0)
  v_max3_u32 v250, v208, v209, v210
  v_max3_u32 v251, v211, v212, v213
  v_max3_u32 v250, v250, v214, v215
  v_max_u32 v250, v250, v251
  v_cmp_eq_u32 vcc, -1, v250
  s_cbranch_vccnz ps3
  s_branch ps3_b
x3_0:
  s_waitcnt vmcnt(0)
  s_cmp_eq_u32 s61, 0
  s_cbranch_scc1 x3_0_b
  s_sub_u32 s61, s61, 1
  s_add_u32 s57, s30, 0
  buffer_load_dwordx4 v[136:139], v1, s[4:7], s57 offen offset:0 sc1
  s_add_u32 s57, s31, 0
  buffer_load_dwordx4 v[140:143], v1, s[4:7], s57 offen offset:0 sc1
  v_max3_u32 v250, v144, v145, v146
  v_max3_u32 v251, v147, v148, v149
  v_max3_u32 v250, v250, v150, v151
  v_max_u32 v250, v250, v251
  v_cmp_eq_u32 vcc, -1, v250
  s_cbranch_vccz x3_0_s0
  s_add_u32 s57, s30, 0
  buffer_load_dwordx4 v[144:147], v1, s[4:7], s57 offen offset:1024 sc1
  s_add_u32 s57, s31, 0
  buffer_load_dwordx4 v[148:151], v1, s[4:7], s57 offen offset:1024 sc1
x3_0_s0:
  v_max3_u32 v250, v152, v153, v154
  v_max3_u32 v251, v155, v156, v157
  v_max3_u32 v250, v250, v158, v159
  v_max_u32 v250, v250, v251
  v_cmp_eq_u32 vcc, -1, v250
  s_cbranch_vccz x3_0_s1
  s_add_u32 s57, s30, 0
  buffer_load_dwordx4 v[152:155], v1, s[4:7], s57 offen offset:2048 sc1
  s_add_u32 s57, s31, 0
  buffer_load_dwordx4 v[156:159], v1, s[4:7], s57 offen offset:2048 sc1
x3_0_s1:
  s_waitcnt vmcnt(0)
  v_max3_u32 v250, v136, v137, v138
  v_max3_u32 v251, v139, v140, v141
  v_max3_u32 v250, v250, v142, v143
  v_max_u32 v250, v250, v251
  v_cmp_eq_u32 vcc, -1, v250
  s_cbranch_vccnz x3_0
  s_branch x3_0_b
x3_1:
  s_waitcnt vmcnt(0)
  s_cmp_eq_u32 s61, 0
  s_cbranch_scc1 x3_1_b
  s_sub_u32 s61, s61, 1
  s_add_u32 s57, s30, 0
  buffer_load_dwordx4 v[144:147], v1, s[4:7], s57 offen offset:1024 sc1
  s_add_u32 s57, s31, 0
  buffer_load_dwordx4 v[148:151], v1, s[4:7], s57 offen offset:1024 sc1
  v_max3_u32 v250, v152, v153, v154
  v_max3_u32 v251, v155, v156, v157
  v_max3_u32 v250, v250, v158, v159
  v_max_u32 v250, v250, v251
  v_cmp_eq_u32 vcc, -1, v250
  s_cbranch_vccz x3_1_s0
  s_add_u32 s57, s30, 0
  buffer_load_dwordx4 v[152:155], v1, s[4:7], s57 offen offset:2048 sc1
  s_add_u32 s57, s31, 0
  buffer_load_dwordx4 v[156:159], v1, s[4:7], s57 offen offset:2048 sc1
x3_1_s0:
  v_max3_u32 v250, v160, v161, v162
  v_max3_u32 v251, v163, v164, v165
  v_max3_u32 v250, v250, v166, v167
  v_max_u32 v250, v250, v251
  v_cmp_eq_u32 vcc, -1, v250
  s_cbranch_vccz x3_1_s1
  s_add_u32 s57, s30, 0
  buffer_load_dwordx4 v[160:163], v1, s[4:7], s57 offen offset:3072 sc1
  s_add_u32 s57, s31, 0
  buffer_load_dwordx4 v[164:167], v1, s[4:7], s57 offen offset:3072 sc1
x3_1_s1:
  v_max3_u32 v250, v168, v169, v170
  v_max3_u32 v251, v171, v172, v173
  v_max3_u32 v250, v250, v174, v175
  v_max_u32 v250, v250, v251
  v_cmp_eq_u32 vcc, -1, v250
  s_cbranch_vccz x3_1_s2
  s_add_u32 s57, s30, 4096
  buffer_load_dwordx4 v[168:171], v1, s[4:7], s57 offen offset:0 sc1
  s_add_u32 s57, s31, 4096
  buffer_load_dwordx4 v[172:175], v1, s[4:7], s57 offen offset:0 sc1
x3_1_s2:
  v_max3_u32 v250, v176, v177, v178
  v_max3_u32 v251, v179, v180, v181
  v_max3_u32 v250, v250, v182, v183
  v_max_u32 v250, v250, v251
  v_cmp_eq_u32 vcc, -1, v250
  s_cbranch_vccz x3_1_s3
  s_add_u32 s57, s30, 4096
  buffer_load_dwordx4 v[176:179], v1, s[4:7], s57 offen offset:1024 sc1
  s_add_u32 s57, s31, 4096
  buffer_load_dwordx4 v[180:183], v1, s[4:7], s57 offen offset:1024 sc1
x3_1_s3:
  s_waitcnt vmcnt(0)
  v_max3_u32 v250, v144, v145, v146
  v_max3_u32 v251, v147, v148, v149
  v_max3_u32 v250, v250, v150, v151
  v_max_u32 v250, v250, v251
  v_cmp_eq_u32 vcc, -1, v250
  s_cbranch_vccnz x3_1
  s_branch x3_1_b
x3_2:
  s_waitcnt vmcnt(0)
  s_cmp_eq_u32 s61, 0
  s_cbranch_scc1 x3_2_b
  s_sub_u32 s61, s61, 1
  s_add_u32 s57, s30, 0
  buffer_load_dwordx4 v[152:155], v1, s[4:7], s57 offen offset:2048 sc1
  s_add_u32 s57, s31, 0
  buffer_load_dwordx4 v[156:159], v1, s[4:7], s57 offen offset:2048 sc1
  v_max3_u32 v250, v160, v161, v162
  v_max3_u32 v251, v163, v164, v165
  v_max3_u32 v250, v250, v166, v167
  v_max_u32 v250, v250, v251
  v_cmp_eq_u32 vcc, -1, v250
  s_cbranch_vccz x3_2_s0
  s_add_u32 s57, s30, 0
  buffer_load_dwordx4 v[160:163], v1, s[4:7], s57 offen offset:3072 sc1
  s_add_u32 s57, s31, 0
  buffer_load_dwordx4 v[164:167], v1, s[4:7], s57 offen offset:3072 sc1
x3_2_s0:
  v_max3_u32 v250, v168, v169, v170
  v_max3_u32 v251, v171, v172, v173
  v_max3_u32 v250, v250, v174, v175
  v_max_u32 v250, v250, v251
  v_cmp_eq_u32 vcc, -1, v250
  s_cbranch_vccz x3_2_s1
  s_add_u32 s57, s30, 4096
  buffer_load_dwordx4 v[168:171], v1, s[4:7], s57 offen offset:0 sc1
  s_add_u32 s57, s31, 4096
  buffer_load_dwordx4 v[172:175], v1, s[4:7], s57 offen offset:0 sc1
x3_2_s1:
  v_max3_u32 v250, v176, v177, v178
  v_max3_u32 v251, v179, v180, v181
  v_max3_u32 v250, v250, v182, v183
  v_max_u32 v250, v250, v251
  v_cmp_eq_u32 vcc, -1, v250
  s_cbranch_vccz x3_2_s2
  s_add_u32 s57, s30, 4096
  buffer_load_dwordx4 v[176:179], v1, s[4:7], s57 offen offset:1024 sc1
  s_add_u32 s57, s31, 4096
  buffer_load_dwordx4 v[180:183], v1, s[4:7], s57 offen offset:1024 sc1
x3_2_s2:
  v_max3_u32 v250, v184, v185, v186
  v_max3_u32 v251, v187, v188, v189
  v_max3_u32 v250, v250, v190, v191
  v_max_u32 v250, v250, v251
  v_cmp_eq_u32 vcc, -1, v250
  s_cbranch_vccz x3_2_s3
  s_add_u32 s57, s30, 4096
  buffer_load_dwordx4 v[184:187], v1, s[4:7], s57 offen offset:2048 sc1
  s_add_u32 s57, s31, 4096
  buffer_load_dwordx4 v[188:191], v1, s[4:7], s57 offen offset:2048 sc1
x3_2_s3:
  v_max3_u32 v250, v192, v193, v194
  v_max3_u32 v251, v195, v196, v197
  v_max3_u32 v250, v250, v198, v199
  v_max_u32 v250, v250, v251
  v_cmp_eq_u32 vcc, -1, v250
  s_cbranch_vccz x3_2_s4
  s_add_u32 s57, s30, 4096
  buffer_load_dwordx4 v[192:195], v1, s[4:7], s57 offen offset:3072 sc1
  s_add_u32 s57, s31, 4096
  buffer_load_dwordx4 v[196:199], v1, s[4:7], s57 offen offset:3072 sc1
x3_2_s4:
  v_max3_u32 v250, v200, v201, v202
  v_max3_u32 v251, v203, v204, v205
  v_max3_u32 v250, v250, v206, v207
  v_max_u32 v250, v250, v251
  v_cmp_eq_u32 vcc, -1, v250
  s_cbranch_vccz x3_2_s5
  s_add_u32 s57, s30, 8192
  buffer_load_dwordx4 v[200:203], v1, s[4:7], s57 offen offset:0 sc1
  s_add_u32 s57, s31, 8192
  buffer_load_dwordx4 v[204:207], v1, s[4:7], s57 offen offset:0 sc1
x3_2_s5:
  s_waitcnt vmcnt(0)
  v_max3_u32 v250, v152, v153, v154
  v_max3_u32 v251, v155, v156, v157
  v_max3_u32 v250, v250, v158, v159
  v_max_u32 v250, v250, v251
  v_cmp_eq_u32 vcc, -1, v250
  s_cbranch_vccnz x3_2
  s_branch x3_2_b
x3_3:
  s_waitcnt vmcnt(0)
  s_cmp_eq_u32 s61, 0
  s_cbranch_scc1 x3_3_b
  s_sub_u32 s61, s61, 1
  s_add_u32 s57, s30, 0
  buffer_load_dwordx4 v[160:163], v1, s[4:7], s57 offen offset:3072 sc1
  s_add_u32 s57, s31, 0
  buffer_load_dwordx4 v[164:167], v1, s[4:7], s57 offen offset:3072 sc1
  v_max3_u32 v250, v168, v169, v170
  v_max3_u32 v251, v171, v172, v173
  v_max3_u32 v250, v250, v174, v175
  v_max_u32 v250, v250, v251
  v_cmp_eq_u32 vcc, -1, v250
  s_cbranch_vccz x3_3_s0
  s_add_u32 s57, s30, 4096
  buffer_load_dwordx4 v[168:171], v1, s[4:7], s57 offen offset:0 sc1
  s_add_u32 s57, s31, 4096
  buffer_load_dwordx4 v[172:175], v1, s[4:7], s57 offen offset:0 sc1
x3_3_s0:
  v_max3_u32 v250, v176, v177, v178
  v_max3_u32 v251, v179, v180, v181
  v_max3_u32 v250, v250, v182, v183
  v_max_u32 v250, v250, v251
  v_cmp_eq_u32 vcc, -1, v250
  s_cbranch_vccz x3_3_s1
  s_add_u32 s57, s30, 4096
  buffer_load_dwordx4 v[176:179], v1, s[4:7], s57 offen offset:1024 sc1
  s_add_u32 s57, s31, 4096
  buffer_load_dwordx4 v[180:183], v1, s[4:7], s57 offen offset:1024 sc1
x3_3_s1:
  v_max3_u32 v250, v184, v185, v186
  v_max3_u32 v251, v187, v188, v189
  v_max3_u32 v250, v250, v190, v191
  v_max_u32 v250, v250, v251
  v_cmp_eq_u32 vcc, -1, v250
  s_cbranch_vccz x3_3_s2
  s_add_u32 s57, s30, 4096
  buffer_load_dwordx4 v[184:187], v1, s[4:7], s57 offen offset:2048 sc1
  s_add_u32 s57, s31, 4096
  buffer_load_dwordx4 v[188:191], v1, s[4:7], s57 offen offset:2048 sc1
x3_3_s2:
  v_max3_u32 v250, v192, v193, v194
  v_max3_u32 v251, v195, v196, v197
  v_max3_u32 v250, v250, v198, v199
  v_max_u32 v250, v250, v251
  v_cmp_eq_u32 vcc, -1, v250
  s_cbranch_vccz x3_3_s3
  s_add_u32 s57, s30, 4096
  buffer_load_dwordx4 v[192:195], v1, s[4:7], s57 offen offset:3072 sc1
  s_add_u32 s57, s31, 4096
  buffer_load_dwordx4 v[196:199], v1, s[4:7], s57 offen offset:3072 sc1
x3_3_s3:
  v_max3_u32 v250, v200, v201, v202
  v_max3_u32 v251, v203, v204, v205
  v_max3_u32 v250, v250, v206, v207
  v_max_u32 v250, v250, v251
  v_cmp_eq_u32 vcc, -1, v250
  s_cbranch_vccz x3_3_s4
  s_add_u32 s57, s30, 8192
  buffer_load_dwordx4 v[200:203], v1, s[4:7], s57 offen offset:0 sc1
  s_add_u32 s57, s31, 8192
  buffer_load_dwordx4 v[204:207], v1, s[4:7], s57 offen offset:0 sc1
x3_3_s4:
  v_max3_u32 v250, v136, v137, v138
  v_max3_u32 v251, v139, v140, v141
  v_max3_u32 v250, v250, v142, v143
  v_max_u32 v250, v250, v251
  v_cmp_eq_u32 vcc, -1, v250
  s_cbranch_vccz x3_3_s5
  s_add_u32 s57, s30, 8192
  buffer_load_dwordx4 v[136:139], v1, s[4:7], s57 offen offset:1024 sc1
  s_add_u32 s57, s31, 8192
  buffer_load_dwordx4 v[140:143], v1, s[4:7], s57 offen offset:1024 sc1
x3_3_s5:
  v_max3_u32 v250, v144, v145, v146
  v_max3_u32 v251, v147, v148, v149
  v_max3_u32 v250, v250, v150, v151
  v_max_u32 v250, v250, v251
  v_cmp_eq_u32 vcc, -1, v250
  s_cbranch_vccz x3_3_s6
  s_add_u32 s57, s30, 8192
  buffer_load_dwordx4 v[144:147], v1, s[4:7], s57 offen offset:2048 sc1
  s_add_u32 s57, s31, 8192
  buffer_load_dwordx4 v[148:151], v1, s[4:7], s57 offen offset:2048 sc1
x3_3_s6:
  s_waitcnt vmcnt(0)
  v_max3_u32 v250, v160, v161, v162
  v_max3_u32 v251, v163, v164, v165
  v_max3_u32 v250, v250, v166, v167
  v_max_u32 v250, v250, v251
  v_cmp_eq_u32 vcc, -1, v250
  s_cbranch_vccnz x3_3
  s_branch x3_3_b
x3_4:
  s_waitcnt vmcnt(0)
  s_cmp_eq_u32 s61, 0
  s_cbranch_scc1 x3_4_b
  s_sub_u32 s61, s61, 1
  s_add_u32 s57, s30, 4096
  buffer_load_dwordx4 v[168:171], v1, s[4:7], s57 offen offset:0 sc1
  s_add_u32 s57, s31, 4096
  buffer_load_dwordx4 v[172:175], v1, s[4:7], s57 offen offset:0 sc1
  v_max3_u32 v250, v176, v177, v178
  v_max3_u32 v251, v179, v180, v181
  v_max3_u32 v250, v250, v182, v183
  v_max_u32 v250, v250, v251
  v_cmp_eq_u32 vcc, -1, v250
  s_cbranch_vccz x3_4_s0
  s_add_u32 s57, s30, 4096
  buffer_load_dwordx4 v[176:179], v1, s[4:7], s57 offen offset:1024 sc1
  s_add_u32 s57, s31, 4096
  buffer_load_dwordx4 v[180:183], v1, s[4:7], s57 offen offset:1024 sc1
x3_4_s0:
  v_max3_u32 v250, v184, v185, v186
  v_max3_u32 v251, v187, v188, v189
  v_max3_u32 v250, v250, v190, v191
  v_max_u32 v250, v250, v251
  v_cmp_eq_u32 vcc, -1, v250
  s_cbranch_vccz x3_4_s1
  s_add_u32 s57, s30, 4096
  buffer_load_dwordx4 v[184:187], v1, s[4:7], s57 offen offset:2048 sc1
  s_add_u32 s57, s31, 4096
  buffer_load_dwordx4 v[188:191], v1, s[4:7], s57 offen offset:2048 sc1
x3_4_s1:
  v_max3_u32 v250, v192, v193, v194
  v_max3_u32 v251, v195, v196, v197
  v_max3_u32 v250, v250, v198, v199
  v_max_u32 v250, v250, v251
  v_cmp_eq_u32 vcc, -1, v250
  s_cbranch_vccz x3_4_s2
  s_add_u32 s57, s30, 4096
  buffer_load_dwordx4 v[192:195], v1, s[4:7], s57 offen offset:3072 sc1
  s_add_u32 s57, s31, 4096
  buffer_load_dwordx4 v[196:199], v1, s[4:7], s57 offen offset:3072 sc1
x3_4_s2:
  v_max3_u32 v250, v200, v201, v202
  v_max3_u32 v251, v203, v204, v205
  v_max3_u32 v250, v250, v206, v207
  v_max_u32 v250, v250, v251
  v_cmp_eq_u32 vcc, -1, v250
  s_cbranch_vccz x3_4_s3
  s_add_u32 s57, s30, 8192
  buffer_load_dwordx4 v[200:203], v1, s[4:7], s57 offen offset:0 sc1
  s_add_u32 s57, s31, 8192
  buffer_load_dwordx4 v[204:207], v1, s[4:7], s57 offen offset:0 sc1
x3_4_s3:
  v_max3_u32 v250, v136, v137, v138
  v_max3_u32 v251, v139, v140, v141
  v_max3_u32 v250, v250, v142, v143
  v_max_u32 v250, v250, v251
  v_cmp_eq_u32 vcc, -1, v250
  s_cbranch_vccz x3_4_s4
  s_add_u32 s57, s30, 8192
  buffer_load_dwordx4 v[136:139], v1, s[4:7], s57 offen offset:1024 sc1
  s_add_u32 s57, s31, 8192
  buffer_load_dwordx4 v[140:143], v1, s[4:7], s57 offen offset:1024 sc1
x3_4_s4:
  v_max3_u32 v250, v144, v145, v146
  v_max3_u32 v251, v147, v148, v149
  v_max3_u32 v250, v250, v150, v151
  v_max_u32 v250, v250, v251
  v_cmp_eq_u32 vcc, -1, v250
  s_cbranch_vccz x3_4_s5
  s_add_u32 s57, s30, 8192
  buffer_load_dwordx4 v[144:147], v1, s[4:7], s57 offen offset:2048 sc1
  s_add_u32 s57, s31, 8192
  buffer_load_dwordx4 v[148:151], v1, s[4:7], s57 offen offset:2048 sc1
x3_4_s5:
  v_max3_u32 v250, v152, v153, v154
  v_max3_u32 v251, v155, v156, v157
  v_max3_u32 v250, v250, v158, v159
  v_max_u32 v250, v250, v251
  v_cmp_eq_u32 vcc, -1, v250
  s_cbranch_vccz x3_4_s6
  s_add_u32 s57, s30, 8192
  buffer_load_dwordx4 v[152:155], v1, s[4:7], s57 offen offset:3072 sc1
  s_add_u32 s57, s31, 8192
  buffer_load_dwordx4 v[156:159], v1, s[4:7], s57 offen offset:3072 sc1
x3_4_s6:
  s_waitcnt vmcnt(0)
  v_max3_u32 v250, v168, v169, v170
  v_max3_u32 v251, v171, v172, v173
  v_max3_u32 v250, v250, v174, v175
  v_max_u32 v250, v250, v251
  v_cmp_eq_u32 vcc, -1, v250
  s_cbranch_vccnz x3_4
  s_branch x3_4_b
x3_5:
  s_waitcnt vmcnt(0)
  s_cmp_eq_u32 s61, 0
  s_cbranch_scc1 x3_5_b
  s_sub_u32 s61, s61, 1
  s_add_u32 s57, s30, 4096
  buffer_load_dwordx4 v[176:179], v1, s[4:7], s57 offen offset:1024 sc1
  s_add_u32 s57, s31, 4096
  buffer_load_dwordx4 v[180:183], v1, s[4:7], s57 offen offset:1024 sc1
  v_max3_u32 v250, v184, v185, v186
  v_max3_u32 v251, v187, v188, v189
  v_max3_u32 v250, v250, v190, v191
  v_max_u32 v250, v250, v251
  v_cmp_eq_u32 vcc, -1, v250
  s_cbranch_vccz x3_5_s0
  s_add_u32 s57, s30, 4096
  buffer_load_dwordx4 v[184:187], v1, s[4:7], s57 offen offset:2048 sc1
  s_add_u32 s57, s31, 4096
  buffer_load_dwordx4 v[188:191], v1, s[4:7], s57 offen offset:2048 sc1
x3_5_s0:
  v_max3_u32 v250, v192, v193, v194
  v_max3_u32 v251, v195, v196, v197
  v_max3_u32 v250, v250, v198, v199
  v_max_u32 v250, v250, v251
  v_cmp_eq_u32 vcc, -1, v250
  s_cbranch_vccz x3_5_s1
  s_add_u32 s57, s30, 4096
  buffer_load_dwordx4 v[192:195], v1, s[4:7], s57 offen offset:3072 sc1
  s_add_u32 s57, s31, 4096
  buffer_load_dwordx4 v[196:199], v1, s[4:7], s57 offen offset:3072 sc1
x3_5_s1:
  v_max3_u32 v250, v200, v201, v202
  v_max3_u32 v251, v203, v204, v205
  v_max3_u32 v250, v250, v206, v207
  v_max_u32 v250, v250, v251
  v_cmp_eq_u32 vcc, -1, v250
  s_cbranch_vccz x3_5_s2
  s_add_u32 s57, s30, 8192
  buffer_load_dwordx4 v[200:203], v1, s[4:7], s57 offen offset:0 sc1
  s_add_u32 s57, s31, 8192
  buffer_load_dwordx4 v[204:207], v1, s[4:7], s57 offen offset:0 sc1
x3_5_s2:
  v_max3_u32 v250, v136, v137, v138
  v_max3_u32 v251, v139, v140, v141
  v_max3_u32 v250, v250, v142, v143
  v_max_u32 v250, v250, v251
  v_cmp_eq_u32 vcc, -1, v250
  s_cbranch_vccz x3_5_s3
  s_add_u32 s57, s30, 8192
  buffer_load_dwordx4 v[136:139], v1, s[4:7], s57 offen offset:1024 sc1
  s_add_u32 s57, s31, 8192
  buffer_load_dwordx4 v[140:143], v1, s[4:7], s57 offen offset:1024 sc1
x3_5_s3:
  v_max3_u32 v250, v144, v145, v146
  v_max3_u32 v251, v147, v148, v149
  v_max3_u32 v250, v250, v150, v151
  v_max_u32 v250, v250, v251
  v_cmp_eq_u32 vcc, -1, v250
  s_cbranch_vccz x3_5_s4
  s_add_u32 s57, s30, 8192
  buffer_load_dwordx4 v[144:147], v1, s[4:7], s57 offen offset:2048 sc1
  s_add_u32 s57, s31, 8192
  buffer_load_dwordx4 v[148:151], v1, s[4:7], s57 offen offset:2048 sc1
x3_5_s4:
  v_max3_u32 v250, v152, v153, v154
  v_max3_u32 v251, v155, v156, v157
  v_max3_u32 v250, v250, v158, v159
  v_max_u32 v250, v250, v251
  v_cmp_eq_u32 vcc, -1, v250
  s_cbranch_vccz x3_5_s5
  s_add_u32 s57, s30, 8192
  buffer_load_dwordx4 v[152:155], v1, s[4:7], s57 offen offset:3072 sc1
  s_add_u32 s57, s31, 8192
  buffer_load_dwordx4 v[156:159], v1, s[4:7], s57 offen offset:3072 sc1
x3_5_s5:
  v_max3_u32 v250, v160, v161, v162
  v_max3_u32 v251, v163, v164, v165
  v_max3_u32 v250, v250, v166, v167
  v_max_u32 v250, v250, v251
  v_cmp_eq_u32 vcc, -1, v250
  s_cbranch_vccz x3_5_s6
  s_add_u32 s57, s30, 12288
  buffer_load_dwordx4 v[160:163], v1, s[4:7], s57 offen offset:0 sc1
  s_add_u32 s57, s31, 12288
  buffer_load_dwordx4 v[164:167], v1, s[4:7], s57 offen offset:0 sc1
x3_5_s6:
  s_waitcnt vmcnt(0)
  v_max3_u32 v250, v176, v177, v178
  v_max3_u32 v251, v179, v180, v181
  v_max3_u32 v250, v250, v182, v183
  v_max_u32 v250, v250, v251
  v_cmp_eq_u32 vcc, -1, v250
  s_cbranch_vccnz x3_5
  s_branch x3_5_b
x3_6:
  s_waitcnt vmcnt(0)
  s_cmp_eq_u32 s61, 0
  s_cbranch_scc1 x3_6_b
  s_sub_u32 s61, s61, 1
  s_add_u32 s57, s30, 4096
  buffer_load_dwordx4 v[184:187], v1, s[4:7], s57 offen offset:2048 sc1
  s_add_u32 s57, s31, 4096
  buffer_load_dwordx4 v[188:191], v1, s[4:7], s57 offen offset:2048 sc1
  v_max3_u32 v250, v192, v193, v194
  v_max3_u32 v251, v195, v196, v197
  v_max3_u32 v250, v250, v198, v199
  v_max_u32 v250, v250, v251
  v_cmp_eq_u32 vcc, -1, v250
  s_cbranch_vccz x3_6_s0
  s_add_u32 s57, s30, 4096
  buffer_load_dwordx4 v[192:195], v1, s[4:7], s57 offen offset:3072 sc1
  s_add_u32 s57, s31, 4096
  buffer_load_dwordx4 v[196:199], v1, s[4:7], s57 offen offset:3072 sc1
x3_6_s0:
  v_max3_u32 v250, v200, v201, v202
  v_max3_u32 v251, v203, v204, v205
  v_max3_u32 v250, v250, v206, v207
  v_max_u32 v250, v250, v251
  v_cmp_eq_u32 vcc, -1, v250
  s_cbranch_vccz x3_6_s1
  s_add_u32 s57, s30, 8192
  buffer_load_dwordx4 v[200:203], v1, s[4:7], s57 offen offset:0 sc1
  s_add_u32 s57, s31, 8192
  buffer_load_dwordx4 v[204:207], v1, s[4:7], s57 offen offset:0 sc1
x3_6_s1:
  v_max3_u32 v250, v136, v137, v138
  v_max3_u32 v251, v139, v140, v141
  v_max3_u32 v250, v250, v142, v143
  v_max_u32 v250, v250, v251
  v_cmp_eq_u32 vcc, -1, v250
  s_cbranch_vccz x3_6_s2
  s_add_u32 s57, s30, 8192
  buffer_load_dwordx4 v[136:139], v1, s[4:7], s57 offen offset:1024 sc1
  s_add_u32 s57, s31, 8192
  buffer_load_dwordx4 v[140:143], v1, s[4:7], s57 offen offset:1024 sc1
x3_6_s2:
  v_max3_u32 v250, v144, v145, v146
  v_max3_u32 v251, v147, v148, v149
  v_max3_u32 v250, v250, v150, v151
  v_max_u32 v250, v250, v251
  v_cmp_eq_u32 vcc, -1, v250
  s_cbranch_vccz x3_6_s3
  s_add_u32 s57, s30, 8192
  buffer_load_dwordx4 v[144:147], v1, s[4:7], s57 offen offset:2048 sc1
  s_add_u32 s57, s31, 8192
  buffer_load_dwordx4 v[148:151], v1, s[4:7], s57 offen offset:2048 sc1
x3_6_s3:
  v_max3_u32 v250, v152, v153, v154
  v_max3_u32 v251, v155, v156, v157
  v_max3_u32 v250, v250, v158, v159
  v_max_u32 v250, v250, v251
  v_cmp_eq_u32 vcc, -1, v250
  s_cbranch_vccz x3_6_s4
  s_add_u32 s57, s30, 8192
  buffer_load_dwordx4 v[152:155], v1, s[4:7], s57 offen offset:3072 sc1
  s_add_u32 s57, s31, 8192
  buffer_load_dwordx4 v[156:159], v1, s[4:7], s57 offen offset:3072 sc1
x3_6_s4:
  v_max3_u32 v250, v160, v161, v162
  v_max3_u32 v251, v163, v164, v165
  v_max3_u32 v250, v250, v166, v167
  v_max_u32 v250, v250, v251
  v_cmp_eq_u32 vcc, -1, v250
  s_cbranch_vccz x3_6_s5
  s_add_u32 s57, s30, 12288
  buffer_load_dwordx4 v[160:163], v1, s[4:7], s57 offen offset:0 sc1
  s_add_u32 s57, s31, 12288
  buffer_load_dwordx4 v[164:167], v1, s[4:7], s57 offen offset:0 sc1
x3_6_s5:
  v_max3_u32 v250, v168, v169, v170
  v_max3_u32 v251, v171, v172, v173
  v_max3_u32 v250, v250, v174, v175
  v_max_u32 v250, v250, v251
  v_cmp_eq_u32 vcc, -1, v250
  s_cbranch_vccz x3_6_s6
  s_add_u32 s57, s30, 12288
  buffer_load_dwordx4 v[168:171], v1, s[4:7], s57 offen offset:1024 sc1
  s_add_u32 s57, s31, 12288
  buffer_load_dwordx4 v[172:175], v1, s[4:7], s57 offen offset:1024 sc1
x3_6_s6:
  s_waitcnt vmcnt(0)
  v_max3_u32 v250, v184, v185, v186
  v_max3_u32 v251, v187, v188, v189
  v_max3_u32 v250, v250, v190, v191
  v_max_u32 v250, v250, v251
  v_cmp_eq_u32 vcc, -1, v250
  s_cbranch_vccnz x3_6
  s_branch x3_6_b
x3_7:
  s_waitcnt vmcnt(0)
  s_cmp_eq_u32 s61, 0
  s_cbranch_scc1 x3_7_b
  s_sub_u32 s61, s61, 1
  s_add_u32 s57, s30, 4096
  buffer_load_dwordx4 v[192:195], v1, s[4:7], s57 offen offset:3072 sc1
  s_add_u32 s57, s31, 4096
  buffer_load_dwordx4 v[196:199], v1, s[4:7], s57 offen offset:3072 sc1
  v_max3_u32 v250, v200, v201, v202
  v_max3_u32 v251, v203, v204, v205
  v_max3_u32 v250, v250, v206, v207
  v_max_u32 v250, v250, v251
  v_cmp_eq_u32 vcc, -1, v250
  s_cbranch_vccz x3_7_s0
  s_add_u32 s57, s30, 8192
  buffer_load_dwordx4 v[200:203], v1, s[4:7], s57 offen offset:0 sc1
  s_add_u32 s57, s31, 8192
  buffer_load_dwordx4 v[204:207], v1, s[4:7], s57 offen offset:0 sc1
x3_7_s0:
  v_max3_u32 v250, v136, v137, v138
  v_max3_u32 v251, v139, v140, v141
  v_max3_u32 v250, v250, v142, v143
  v_max_u32 v250, v250, v251
  v_cmp_eq_u32 vcc, -1, v250
  s_cbranch_vccz x3_7_s1
  s_add_u32 s57, s30, 8192
  buffer_load_dwordx4 v[136:139], v1, s[4:7], s57 offen offset:1024 sc1
  s_add_u32 s57, s31, 8192
  buffer_load_dwordx4 v[140:143], v1, s[4:7], s57 offen offset:1024 sc1
x3_7_s1:
  v_max3_u32 v250, v144, v145, v146
  v_max3_u32 v251, v147, v148, v149
  v_max3_u32 v250, v250, v150, v151
  v_max_u32 v250, v250, v251
  v_cmp_eq_u32 vcc, -1, v250
  s_cbranch_vccz x3_7_s2
  s_add_u32 s57, s30, 8192
  buffer_load_dwordx4 v[144:147], v1, s[4:7], s57 offen offset:2048 sc1
  s_add_u32 s57, s31, 8192
  buffer_load_dwordx4 v[148:151], v1, s[4:7], s57 offen offset:2048 sc1
x3_7_s2:
  v_max3_u32 v250, v152, v153, v154
  v_max3_u32 v251, v155, v156, v157
  v_max3_u32 v250, v250, v158, v159
  v_max_u32 v250, v250, v251
  v_cmp_eq_u32 vcc, -1, v250
  s_cbranch_vccz x3_7_s3
  s_add_u32 s57, s30, 8192
  buffer_load_dwordx4 v[152:155], v1, s[4:7], s57 offen offset:3072 sc1
  s_add_u32 s57, s31, 8192
  buffer_load_dwordx4 v[156:159], v1, s[4:7], s57 offen offset:3072 sc1
x3_7_s3:
  v_max3_u32 v250, v160, v161, v162
  v_max3_u32 v251, v163, v164, v165
  v_max3_u32 v250, v250, v166, v167
  v_max_u32 v250, v250, v251
  v_cmp_eq_u32 vcc, -1, v250
  s_cbranch_vccz x3_7_s4
  s_add_u32 s57, s30, 12288
  buffer_load_dwordx4 v[160:163], v1, s[4:7], s57 offen offset:0 sc1
  s_add_u32 s57, s31, 12288
  buffer_load_dwordx4 v[164:167], v1, s[4:7], s57 offen offset:0 sc1
x3_7_s4:
  v_max3_u32 v250, v168, v169, v170
  v_max3_u32 v251, v171, v172, v173
  v_max3_u32 v250, v250, v174, v175
  v_max_u32 v250, v250, v251
  v_cmp_eq_u32 vcc, -1, v250
  s_cbranch_vccz x3_7_s5
  s_add_u32 s57, s30, 12288
  buffer_load_dwordx4 v[168:171], v1, s[4:7], s57 offen offset:1024 sc1
  s_add_u32 s57, s31, 12288
  buffer_load_dwordx4 v[172:175], v1, s[4:7], s57 offen offset:1024 sc1
x3_7_s5:
  v_max3_u32 v250, v176, v177, v178
  v_max3_u32 v251, v179, v180, v181
  v_max3_u32 v250, v250, v182, v183
  v_max_u32 v250, v250, v251
  v_cmp_eq_u32 vcc, -1, v250
  s_cbranch_vccz x3_7_s6
  s_add_u32 s57, s30, 12288
  buffer_load_dwordx4 v[176:179], v1, s[4:7], s57 offen offset:2048 sc1
  s_add_u32 s57, s31, 12288
  buffer_load_dwordx4 v[180:183], v1, s[4:7], s57 offen offset:2048 sc1
x3_7_s6:
  s_waitcnt vmcnt(0)
  v_max3_u32 v250, v192, v193, v194
  v_max3_u32 v251, v195, v196, v197
  v_max3_u32 v250, v250, v198, v199
  v_max_u32 v250, v250, v251
  v_cmp_eq_u32 vcc, -1, v250
  s_cbranch_vccnz x3_7
  s_branch x3_7_b
x3_8:
  s_waitcnt vmcnt(0)
  s_cmp_eq_u32 s61, 0
  s_cbranch_scc1 x3_8_b
  s_sub_u32 s61, s61, 1
  s_add_u32 s57, s30, 8192
  buffer_load_dwordx4 v[200:203], v1, s[4:7], s57 offen offset:0 sc1
  s_add_u32 s57, s31, 8192
  buffer_load_dwordx4 v[204:207], v1, s[4:7], s57 offen offset:0 sc1
  v_max3_u32 v250, v136, v137, v138
  v_max3_u32 v251, v139, v140, v141
  v_max3_u32 v250, v250, v142, v143
  v_max_u32 v250, v250, v251
  v_cmp_eq_u32 vcc, -1, v250
  s_cbranch_vccz x3_8_s0
  s_add_u32 s57, s30, 8192
  buffer_load_dwordx4 v[136:139], v1, s[4:7], s57 offen offset:1024 sc1
  s_add_u32 s57, s31, 8192
  buffer_load_dwordx4 v[140:143], v1, s[4:7], s57 offen offset:1024 sc1
x3_8_s0:
  v_max3_u32 v250, v144, v145, v146
  v_max3_u32 v251, v147, v148, v149
  v_max3_u32 v250, v250, v150, v151
  v_max_u32 v250, v250, v251
  v_cmp_eq_u32 vcc, -1, v250
  s_cbranch_vccz x3_8_s1
  s_add_u32 s57, s30, 8192
  buffer_load_dwordx4 v[144:147], v1, s[4:7], s57 offen offset:2048 sc1
  s_add_u32 s57, s31, 8192
  buffer_load_dwordx4 v[148:151], v1, s[4:7], s57 offen offset:2048 sc1
x3_8_s1:
  v_max3_u32 v250, v152, v153, v154
  v_max3_u32 v251, v155, v156, v157
  v_max3_u32 v250, v250, v158, v159
  v_max_u32 v250, v250, v251
  v_cmp_eq_u32 vcc, -1, v250
  s_cbranch_vccz x3_8_s2
  s_add_u32 s57, s30, 8192
  buffer_load_dwordx4 v[152:155], v1, s[4:7], s57 offen offset:3072 sc1
  s_add_u32 s57, s31, 8192
  buffer_load_dwordx4 v[156:159], v1, s[4:7], s57 offen offset:3072 sc1
x3_8_s2:
  v_max3_u32 v250, v160, v161, v162
  v_max3_u32 v251, v163, v164, v165
  v_max3_u32 v250, v250, v166, v167
  v_max_u32 v250, v250, v251
  v_cmp_eq_u32 vcc, -1, v250
  s_cbranch_vccz x3_8_s3
  s_add_u32 s57, s30, 12288
  buffer_load_dwordx4 v[160:163], v1, s[4:7], s57 offen offset:0 sc1
  s_add_u32 s57, s31, 12288
  buffer_load_dwordx4 v[164:167], v1, s[4:7], s57 offen offset:0 sc1
x3_8_s3:
  v_max3_u32 v250, v168, v169, v170
  v_max3_u32 v251, v171, v172, v173
  v_max3_u32 v250, v250, v174, v175
  v_max_u32 v250, v250, v251
  v_cmp_eq_u32 vcc, -1, v250
  s_cbranch_vccz x3_8_s4
  s_add_u32 s57, s30, 12288
  buffer_load_dwordx4 v[168:171], v1, s[4:7], s57 offen offset:1024 sc1
  s_add_u32 s57, s31, 12288
  buffer_load_dwordx4 v[172:175], v1, s[4:7], s57 offen offset:1024 sc1
x3_8_s4:
  v_max3_u32 v250, v176, v177, v178
  v_max3_u32 v251, v179, v180, v181
  v_max3_u32 v250, v250, v182, v183
  v_max_u32 v250, v250, v251
  v_cmp_eq_u32 vcc, -1, v250
  s_cbranch_vccz x3_8_s5
  s_add_u32 s57, s30, 12288
  buffer_load_dwordx4 v[176:179], v1, s[4:7], s57 offen offset:2048 sc1
  s_add_u32 s57, s31, 12288
  buffer_load_dwordx4 v[180:183], v1, s[4:7], s57 offen offset:2048 sc1
x3_8_s5:
  v_max3_u32 v250, v184, v185, v186
  v_max3_u32 v251, v187, v188, v189
  v_max3_u32 v250, v250, v190, v191
  v_max_u32 v250, v250, v251
  v_cmp_eq_u32 vcc, -1, v250
  s_cbranch_vccz x3_8_s6
  s_add_u32 s57, s30, 12288
  buffer_load_dwordx4 v[184:187], v1, s[4:7], s57 offen offset:3072 sc1
  s_add_u32 s57, s31, 12288
  buffer_load_dwordx4 v[188:191], v1, s[4:7], s57 offen offset:3072 sc1
x3_8_s6:
  s_waitcnt vmcnt(0)
  v_max3_u32 v250, v200, v201, v202
  v_max3_u32 v251, v203, v204, v205
  v_max3_u32 v250, v250, v206, v207
  v_max_u32 v250, v250, v251
  v_cmp_eq_u32 vcc, -1, v250
  s_cbranch_vccnz x3_8
  s_branch x3_8_b
x3_9:
  s_waitcnt vmcnt(0)
  s_cmp_eq_u32 s61, 0
  s_cbranch_scc1 x3_9_b
  s_sub_u32 s61, s61, 1
  s_add_u32 s57, s30, 8192
  buffer_load_dwordx4 v[136:139], v1, s[4:7], s57 offen offset:1024 sc1
  s_add_u32 s57, s31, 8192
  buffer_load_dwordx4 v[140:143], v1, s[4:7], s57 offen offset:1024 sc1
  v_max3_u32 v250, v144, v145, v146
  v_max3_u32 v251, v147, v148, v149
  v_max3_u32 v250, v250, v150, v151
  v_max_u32 v250, v250, v251
  v_cmp_eq_u32 vcc, -1, v250
  s_cbranch_vccz x3_9_s0
  s_add_u32 s57, s30, 8192
  buffer_load_dwordx4 v[144:147], v1, s[4:7], s57 offen offset:2048 sc1
  s_add_u32 s57, s31, 8192
  buffer_load_dwordx4 v[148:151], v1, s[4:7], s57 offen offset:2048 sc1
x3_9_s0:
  v_max3_u32 v250, v152, v153, v154
  v_max3_u32 v251, v155, v156, v157
  v_max3_u32 v250, v250, v158, v159
  v_max_u32 v250, v250, v251
  v_cmp_eq_u32 vcc, -1, v250
  s_cbranch_vccz x3_9_s1
  s_add_u32 s57, s30, 8192
  buffer_load_dwordx4 v[152:155], v1, s[4:7], s57 offen offset:3072 sc1
  s_add_u32 s57, s31, 8192
  buffer_load_dwordx4 v[156:159], v1, s[4:7], s57 offen offset:3072 sc1
x3_9_s1:
  v_max3_u32 v250, v160, v161, v162
  v_max3_u32 v251, v163, v164, v165
  v_max3_u32 v250, v250, v166, v167
  v_max_u32 v250, v250, v251
  v_cmp_eq_u32 vcc, -1, v250
  s_cbranch_vccz x3_9_s2
  s_add_u32 s57, s30, 12288
  buffer_load_dwordx4 v[160:163], v1, s[4:7], s57 offen offset:0 sc1
  s_add_u32 s57, s31, 12288
  buffer_load_dwordx4 v[164:167], v1, s[4:7], s57 offen offset:0 sc1
x3_9_s2:
  v_max3_u32 v250, v168, v169, v170
  v_max3_u32 v251, v171, v172, v173
  v_max3_u32 v250, v250, v174, v175
  v_max_u32 v250, v250, v251
  v_cmp_eq_u32 vcc, -1, v250
  s_cbranch_vccz x3_9_s3
  s_add_u32 s57, s30, 12288
  buffer_load_dwordx4 v[168:171], v1, s[4:7], s57 offen offset:1024 sc1
  s_add_u32 s57, s31, 12288
  buffer_load_dwordx4 v[172:175], v1, s[4:7], s57 offen offset:1024 sc1
x3_9_s3:
  v_max3_u32 v250, v176, v177, v178
  v_max3_u32 v251, v179, v180, v181
  v_max3_u32 v250, v250, v182, v183
  v_max_u32 v250, v250, v251
  v_cmp_eq_u32 vcc, -1, v250
  s_cbranch_vccz x3_9_s4
  s_add_u32 s57, s30, 12288
  buffer_load_dwordx4 v[176:179], v1, s[4:7], s57 offen offset:2048 sc1
  s_add_u32 s57, s31, 12288
  buffer_load_dwordx4 v[180:183], v1, s[4:7], s57 offen offset:2048 sc1
x3_9_s4:
  v_max3_u32 v250, v184, v185, v186
  v_max3_u32 v251, v187, v188, v189
  v_max3_u32 v250, v250, v190, v191
  v_max_u32 v250, v250, v251
  v_cmp_eq_u32 vcc, -1, v250
  s_cbranch_vccz x3_9_s5
  s_add_u32 s57, s30, 12288
  buffer_load_dwordx4 v[184:187], v1, s[4:7], s57 offen offset:3072 sc1
  s_add_u32 s57, s31, 12288
  buffer_load_dwordx4 v[188:191], v1, s[4:7], s57 offen offset:3072 sc1
x3_9_s5:
  v_max3_u32 v250, v192, v193, v194
  v_max3_u32 v251, v195, v196, v197
  v_max3_u32 v250, v250, v198, v199
  v_max_u32 v250, v250, v251
  v_cmp_eq_u32 vcc, -1, v250
  s_cbranch_vccz x3_9_s6
  s_add_u32 s57, s30, 16384
  buffer_load_dwordx4 v[192:195], v1, s[4:7], s57 offen offset:0 sc1
  s_add_u32 s57, s31, 16384
  buffer_load_dwordx4 v[196:199], v1, s[4:7], s57 offen offset:0 sc1
x3_9_s6:
  s_waitcnt vmcnt(0)
  v_max3_u32 v250, v136, v137, v138
  v_max3_u32 v251, v139, v140, v141
  v_max3_u32 v250, v250, v142, v143
  v_max_u32 v250, v250, v251
  v_cmp_eq_u32 vcc, -1, v250
  s_cbranch_vccnz x3_9
  s_branch x3_9_b
x3_10:
  s_waitcnt vmcnt(0)
  s_cmp_eq_u32 s61, 0
  s_cbranch_scc1 x3_10_b
  s_sub_u32 s61, s61, 1
  s_add_u32 s57, s30, 8192
  buffer_load_dwordx4 v[144:147], v1, s[4:7], s57 offen offset:2048 sc1
  s_add_u32 s57, s31, 8192
  buffer_load_dwordx4 v[148:151], v1, s[4:7], s57 offen offset:2048 sc1
  v_max3_u32 v250, v152, v153, v154
  v_max3_u32 v251, v155, v156, v157
  v_max3_u32 v250, v250, v158, v159
  v_max_u32 v250, v250, v251
  v_cmp_eq_u32 vcc, -1, v250
  s_cbranch_vccz x3_10_s0
  s_add_u32 s57, s30, 8192
  buffer_load_dwordx4 v[152:155], v1, s[4:7], s57 offen offset:3072 sc1
  s_add_u32 s57, s31, 8192
  buffer_load_dwordx4 v[156:159], v1, s[4:7], s57 offen offset:3072 sc1
x3_10_s0:
  v_max3_u32 v250, v160, v161, v162
  v_max3_u32 v251, v163, v164, v165
  v_max3_u32 v250, v250, v166, v167
  v_max_u32 v250, v250, v251
  v_cmp_eq_u32 vcc, -1, v250
  s_cbranch_vccz x3_10_s1
  s_add_u32 s57, s30, 12288
  buffer_load_dwordx4 v[160:163], v1, s[4:7], s57 offen offset:0 sc1
  s_add_u32 s57, s31, 12288
  buffer_load_dwordx4 v[164:167], v1, s[4:7], s57 offen offset:0 sc1
x3_10_s1:
  v_max3_u32 v250, v168, v169, v170
  v_max3_u32 v251, v171, v172, v173
  v_max3_u32 v250, v250, v174, v175
  v_max_u32 v250, v250, v251
  v_cmp_eq_u32 vcc, -1, v250
  s_cbranch_vccz x3_10_s2
  s_add_u32 s57, s30, 12288
  buffer_load_dwordx4 v[168:171], v1, s[4:7], s57 offen offset:1024 sc1
  s_add_u32 s57, s31, 12288
  buffer_load_dwordx4 v[172:175], v1, s[4:7], s57 offen offset:1024 sc1
x3_10_s2:
  v_max3_u32 v250, v176, v177, v178
  v_max3_u32 v251, v179, v180, v181
  v_max3_u32 v250, v250, v182, v183
  v_max_u32 v250, v250, v251
  v_cmp_eq_u32 vcc, -1, v250
  s_cbranch_vccz x3_10_s3
  s_add_u32 s57, s30, 12288
  buffer_load_dwordx4 v[176:179], v1, s[4:7], s57 offen offset:2048 sc1
  s_add_u32 s57, s31, 12288
  buffer_load_dwordx4 v[180:183], v1, s[4:7], s57 offen offset:2048 sc1
x3_10_s3:
  v_max3_u32 v250, v184, v185, v186
  v_max3_u32 v251, v187, v188, v189
  v_max3_u32 v250, v250, v190, v191
  v_max_u32 v250, v250, v251
  v_cmp_eq_u32 vcc, -1, v250
  s_cbranch_vccz x3_10_s4
  s_add_u32 s57, s30, 12288
  buffer_load_dwordx4 v[184:187], v1, s[4:7], s57 offen offset:3072 sc1
  s_add_u32 s57, s31, 12288
  buffer_load_dwordx4 v[188:191], v1, s[4:7], s57 offen offset:3072 sc1
x3_10_s4:
  v_max3_u32 v250, v192, v193, v194
  v_max3_u32 v251, v195, v196, v197
  v_max3_u32 v250, v250, v198, v199
  v_max_u32 v250, v250, v251
  v_cmp_eq_u32 vcc, -1, v250
  s_cbranch_vccz x3_10_s5
  s_add_u32 s57, s30, 16384
  buffer_load_dwordx4 v[192:195], v1, s[4:7], s57 offen offset:0 sc1
  s_add_u32 s57, s31, 16384
  buffer_load_dwordx4 v[196:199], v1, s[4:7], s57 offen offset:0 sc1
x3_10_s5:
  v_max3_u32 v250, v200, v201, v202
  v_max3_u32 v251, v203, v204, v205
  v_max3_u32 v250, v250, v206, v207
  v_max_u32 v250, v250, v251
  v_cmp_eq_u32 vcc, -1, v250
  s_cbranch_vccz x3_10_s6
  s_add_u32 s57, s30, 16384
  buffer_load_dwordx4 v[200:203], v1, s[4:7], s57 offen offset:1024 sc1
  s_add_u32 s57, s31, 16384
  buffer_load_dwordx4 v[204:207], v1, s[4:7], s57 offen offset:1024 sc1
x3_10_s6:
  s_waitcnt vmcnt(0)
  v_max3_u32 v250, v144, v145, v146
  v_max3_u32 v251, v147, v148, v149
  v_max3_u32 v250, v250, v150, v151
  v_max_u32 v250, v250, v251
  v_cmp_eq_u32 vcc, -1, v250
  s_cbranch_vccnz x3_10
  s_branch x3_10_b
x3_11:
  s_waitcnt vmcnt(0)
  s_cmp_eq_u32 s61, 0
  s_cbranch_scc1 x3_11_b
  s_sub_u32 s61, s61, 1
  s_add_u32 s57, s30, 8192
  buffer_load_dwordx4 v[152:155], v1, s[4:7], s57 offen offset:3072 sc1
  s_add_u32 s57, s31, 8192
  buffer_load_dwordx4 v[156:159], v1, s[4:7], s57 offen offset:3072 sc1
  v_max3_u32 v250, v160, v161, v162
  v_max3_u32 v251, v163, v164, v165
  v_max3_u32 v250, v250, v166, v167
  v_max_u32 v250, v250, v251
  v_cmp_eq_u32 vcc, -1, v250
  s_cbranch_vccz x3_11_s0
  s_add_u32 s57, s30, 12288
  buffer_load_dwordx4 v[160:163], v1, s[4:7], s57 offen offset:0 sc1
  s_add_u32 s57, s31, 12288
  buffer_load_dwordx4 v[164:167], v1, s[4:7], s57 offen offset:0 sc1
x3_11_s0:
  v_max3_u32 v250, v168, v169, v170
  v_max3_u32 v251, v171, v172, v173
  v_max3_u32 v250, v250, v174, v175
  v_max_u32 v250, v250, v251
  v_cmp_eq_u32 vcc, -1, v250
  s_cbranch_vccz x3_11_s1
  s_add_u32 s57, s30, 12288
  buffer_load_dwordx4 v[168:171], v1, s[4:7], s57 offen offset:1024 sc1
  s_add_u32 s57, s31, 12288
  buffer_load_dwordx4 v[172:175], v1, s[4:7], s57 offen offset:1024 sc1
x3_11_s1:
  v_max3_u32 v250, v176, v177, v178
  v_max3_u32 v251, v179, v180, v181
  v_max3_u32 v250, v250, v182, v183
  v_max_u32 v250, v250, v251
  v_cmp_eq_u32 vcc, -1, v250
  s_cbranch_vccz x3_11_s2
  s_add_u32 s57, s30, 12288
  buffer_load_dwordx4 v[176:179], v1, s[4:7], s57 offen offset:2048 sc1
  s_add_u32 s57, s31, 12288
  buffer_load_dwordx4 v[180:183], v1, s[4:7], s57 offen offset:2048 sc1
x3_11_s2:
  v_max3_u32 v250, v184, v185, v186
  v_max3_u32 v251, v187, v188, v189
  v_max3_u32 v250, v250, v190, v191
  v_max_u32 v250, v250, v251
  v_cmp_eq_u32 vcc, -1, v250
  s_cbranch_vccz x3_11_s3
  s_add_u32 s57, s30, 12288
  buffer_load_dwordx4 v[184:187], v1, s[4:7], s57 offen offset:3072 sc1
  s_add_u32 s57, s31, 12288
  buffer_load_dwordx4 v[188:191], v1, s[4:7], s57 offen offset:3072 sc1
x3_11_s3:
  v_max3_u32 v250, v192, v193, v194
  v_max3_u32 v251, v195, v196, v197
  v_max3_u32 v250, v250, v198, v199
  v_max_u32 v250, v250, v251
  v_cmp_eq_u32 vcc, -1, v250
  s_cbranch_vccz x3_11_s4
  s_add_u32 s57, s30, 16384
  buffer_load_dwordx4 v[192:195], v1, s[4:7], s57 offen offset:0 sc1
  s_add_u32 s57, s31, 16384
  buffer_load_dwordx4 v[196:199], v1, s[4:7], s57 offen offset:0 sc1
x3_11_s4:
  v_max3_u32 v250, v200, v201, v202
  v_max3_u32 v251, v203, v204, v205
  v_max3_u32 v250, v250, v206, v207
  v_max_u32 v250, v250, v251
  v_cmp_eq_u32 vcc, -1, v250
  s_cbranch_vccz x3_11_s5
  s_add_u32 s57, s30, 16384
  buffer_load_dwordx4 v[200:203], v1, s[4:7], s57 offen offset:1024 sc1
  s_add_u32 s57, s31, 16384
  buffer_load_dwordx4 v[204:207], v1, s[4:7], s57 offen offset:1024 sc1
x3_11_s5:
  v_max3_u32 v250, v136, v137, v138
  v_max3_u32 v251, v139, v140, v141
  v_max3_u32 v250, v250, v142, v143
  v_max_u32 v250, v250, v251
  v_cmp_eq_u32 vcc, -1, v250
  s_cbranch_vccz x3_11_s6
  s_add_u32 s57, s30, 16384
  buffer_load_dwordx4 v[136:139], v1, s[4:7], s57 offen offset:2048 sc1
  s_add_u32 s57, s31, 16384
  buffer_load_dwordx4 v[140:143], v1, s[4:7], s57 offen offset:2048 sc1
x3_11_s6:
  s_waitcnt vmcnt(0)
  v_max3_u32 v250, v152, v153, v154
  v_max3_u32 v251, v155, v156, v157
  v_max3_u32 v250, v250, v158, v159
  v_max_u32 v250, v250, v251
  v_cmp_eq_u32 vcc, -1, v250
  s_cbranch_vccnz x3_11
  s_branch x3_11_b
x3_12:
  s_waitcnt vmcnt(0)
  s_cmp_eq_u32 s61, 0
  s_cbranch_scc1 x3_12_b
  s_sub_u32 s61, s61, 1
  s_add_u32 s57, s30, 12288
  buffer_load_dwordx4 v[160:163], v1, s[4:7], s57 offen offset:0 sc1
  s_add_u32 s57, s31, 12288
  buffer_load_dwordx4 v[164:167], v1, s[4:7], s57 offen offset:0 sc1
  v_max3_u32 v250, v168, v169, v170
  v_max3_u32 v251, v171, v172, v173
  v_max3_u32 v250, v250, v174, v175
  v_max_u32 v250, v250, v251
  v_cmp_eq_u32 vcc, -1, v250
  s_cbranch_vccz x3_12_s0
  s_add_u32 s57, s30, 12288
  buffer_load_dwordx4 v[168:171], v1, s[4:7], s57 offen offset:1024 sc1
  s_add_u32 s57, s31, 12288
  buffer_load_dwordx4 v[172:175], v1, s[4:7], s57 offen offset:1024 sc1
x3_12_s0:
  v_max3_u32 v250, v176, v177, v178
  v_max3_u32 v251, v179, v180, v181
  v_max3_u32 v250, v250, v182, v183
  v_max_u32 v250, v250, v251
  v_cmp_eq_u32 vcc, -1, v250
  s_cbranch_vccz x3_12_s1
  s_add_u32 s57, s30, 12288
  buffer_load_dwordx4 v[176:179], v1, s[4:7], s57 offen offset:2048 sc1
  s_add_u32 s57, s31, 12288
  buffer_load_dwordx4 v[180:183], v1, s[4:7], s57 offen offset:2048 sc1
x3_12_s1:
  v_max3_u32 v250, v184, v185, v186
  v_max3_u32 v251, v187, v188, v189
  v_max3_u32 v250, v250, v190, v191
  v_max_u32 v250, v250, v251
  v_cmp_eq_u32 vcc, -1, v250
  s_cbranch_vccz x3_12_s2
  s_add_u32 s57, s30, 12288
  buffer_load_dwordx4 v[184:187], v1, s[4:7], s57 offen offset:3072 sc1
  s_add_u32 s57, s31, 12288
  buffer_load_dwordx4 v[188:191], v1, s[4:7], s57 offen offset:3072 sc1
x3_12_s2:
  v_max3_u32 v250, v192, v193, v194
  v_max3_u32 v251, v195, v196, v197
  v_max3_u32 v250, v250, v198, v199
  v_max_u32 v250, v250, v251
  v_cmp_eq_u32 vcc, -1, v250
  s_cbranch_vccz x3_12_s3
  s_add_u32 s57, s30, 16384
  buffer_load_dwordx4 v[192:195], v1, s[4:7], s57 offen offset:0 sc1
  s_add_u32 s57, s31, 16384
  buffer_load_dwordx4 v[196:199], v1, s[4:7], s57 offen offset:0 sc1
x3_12_s3:
  v_max3_u32 v250, v200, v201, v202
  v_max3_u32 v251, v203, v204, v205
  v_max3_u32 v250, v250, v206, v207
  v_max_u32 v250, v250, v251
  v_cmp_eq_u32 vcc, -1, v250
  s_cbranch_vccz x3_12_s4
  s_add_u32 s57, s30, 16384
  buffer_load_dwordx4 v[200:203], v1, s[4:7], s57 offen offset:1024 sc1
  s_add_u32 s57, s31, 16384
  buffer_load_dwordx4 v[204:207], v1, s[4:7], s57 offen offset:1024 sc1
x3_12_s4:
  v_max3_u32 v250, v136, v137, v138
  v_max3_u32 v251, v139, v140, v141
  v_max3_u32 v250, v250, v142, v143
  v_max_u32 v250, v250, v251
  v_cmp_eq_u32 vcc, -1, v250
  s_cbranch_vccz x3_12_s5
  s_add_u32 s57, s30, 16384
  buffer_load_dwordx4 v[136:139], v1, s[4:7], s57 offen offset:2048 sc1
  s_add_u32 s57, s31, 16384
  buffer_load_dwordx4 v[140:143], v1, s[4:7], s57 offen offset:2048 sc1
x3_12_s5:
  v_max3_u32 v250, v144, v145, v146
  v_max3_u32 v251, v147, v148, v149
  v_max3_u32 v250, v250, v150, v151
  v_max_u32 v250, v250, v251
  v_cmp_eq_u32 vcc, -1, v250
  s_cbranch_vccz x3_12_s6
  s_add_u32 s57, s30, 16384
  buffer_load_dwordx4 v[144:147], v1, s[4:7], s57 offen offset:3072 sc1
  s_add_u32 s57, s31, 16384
  buffer_load_dwordx4 v[148:151], v1, s[4:7], s57 offen offset:3072 sc1
x3_12_s6:
  s_waitcnt vmcnt(0)
  v_max3_u32 v250, v160, v161, v162
  v_max3_u32 v251, v163, v164, v165
  v_max3_u32 v250, v250, v166, v167
  v_max_u32 v250, v250, v251
  v_cmp_eq_u32 vcc, -1, v250
  s_cbranch_vccnz x3_12
  s_branch x3_12_b
x3_13:
  s_waitcnt vmcnt(0)
  s_cmp_eq_u32 s61, 0
  s_cbranch_scc1 x3_13_b
  s_sub_u32 s61, s61, 1
  s_add_u32 s57, s30, 12288
  buffer_load_dwordx4 v[168:171], v1, s[4:7], s57 offen offset:1024 sc1
  s_add_u32 s57, s31, 12288
  buffer_load_dwordx4 v[172:175], v1, s[4:7], s57 offen offset:1024 sc1
  v_max3_u32 v250, v176, v177, v178
  v_max3_u32 v251, v179, v180, v181
  v_max3_u32 v250, v250, v182, v183
  v_max_u32 v250, v250, v251
  v_cmp_eq_u32 vcc, -1, v250
  s_cbranch_vccz x3_13_s0
  s_add_u32 s57, s30, 12288
  buffer_load_dwordx4 v[176:179], v1, s[4:7], s57 offen offset:2048 sc1
  s_add_u32 s57, s31, 12288
  buffer_load_dwordx4 v[180:183], v1, s[4:7], s57 offen offset:2048 sc1
x3_13_s0:
  v_max3_u32 v250, v184, v185, v186
  v_max3_u32 v251, v187, v188, v189
  v_max3_u32 v250, v250, v190, v191
  v_max_u32 v250, v250, v251
  v_cmp_eq_u32 vcc, -1, v250
  s_cbranch_vccz x3_13_s1
  s_add_u32 s57, s30, 12288
  buffer_load_dwordx4 v[184:187], v1, s[4:7], s57 offen offset:3072 sc1
  s_add_u32 s57, s31, 12288
  buffer_load_dwordx4 v[188:191], v1, s[4:7], s57 offen offset:3072 sc1
x3_13_s1:
  v_max3_u32 v250, v192, v193, v194
  v_max3_u32 v251, v195, v196, v197
  v_max3_u32 v250, v250, v198, v199
  v_max_u32 v250, v250, v251
  v_cmp_eq_u32 vcc, -1, v250
  s_cbranch_vccz x3_13_s2
  s_add_u32 s57, s30, 16384
  buffer_load_dwordx4 v[192:195], v1, s[4:7], s57 offen offset:0 sc1
  s_add_u32 s57, s31, 16384
  buffer_load_dwordx4 v[196:199], v1, s[4:7], s57 offen offset:0 sc1
x3_13_s2:
  v_max3_u32 v250, v200, v201, v202
  v_max3_u32 v251, v203, v204, v205
  v_max3_u32 v250, v250, v206, v207
  v_max_u32 v250, v250, v251
  v_cmp_eq_u32 vcc, -1, v250
  s_cbranch_vccz x3_13_s3
  s_add_u32 s57, s30, 16384
  buffer_load_dwordx4 v[200:203], v1, s[4:7], s57 offen offset:1024 sc1
  s_add_u32 s57, s31, 16384
  buffer_load_dwordx4 v[204:207], v1, s[4:7], s57 offen offset:1024 sc1
x3_13_s3:
  v_max3_u32 v250, v136, v137, v138
  v_max3_u32 v251, v139, v140, v141
  v_max3_u32 v250, v250, v142, v143
  v_max_u32 v250, v250, v251
  v_cmp_eq_u32 vcc, -1, v250
  s_cbranch_vccz x3_13_s4
  s_add_u32 s57, s30, 16384
  buffer_load_dwordx4 v[136:139], v1, s[4:7], s57 offen offset:2048 sc1
  s_add_u32 s57, s31, 16384
  buffer_load_dwordx4 v[140:143], v1, s[4:7], s57 offen offset:2048 sc1
x3_13_s4:
  v_max3_u32 v250, v144, v145, v146
  v_max3_u32 v251, v147, v148, v149
  v_max3_u32 v250, v250, v150, v151
  v_max_u32 v250, v250, v251
  v_cmp_eq_u32 vcc, -1, v250
  s_cbranch_vccz x3_13_s5
  s_add_u32 s57, s30, 16384
  buffer_load_dwordx4 v[144:147], v1, s[4:7], s57 offen offset:3072 sc1
  s_add_u32 s57, s31, 16384
  buffer_load_dwordx4 v[148:151], v1, s[4:7], s57 offen offset:3072 sc1
x3_13_s5:
  s_waitcnt vmcnt(0)
  v_max3_u32 v250, v168, v169, v170
  v_max3_u32 v251, v171, v172, v173
  v_max3_u32 v250, v250, v174, v175
  v_max_u32 v250, v250, v251
  v_cmp_eq_u32 vcc, -1, v250
  s_cbranch_vccnz x3_13
  s_branch x3_13_b
x3_14:
  s_waitcnt vmcnt(0)
  s_cmp_eq_u32 s61, 0
  s_cbranch_scc1 x3_14_b
  s_sub_u32 s61, s61, 1
  s_add_u32 s57, s30, 12288
  buffer_load_dwordx4 v[176:179], v1, s[4:7], s57 offen offset:2048 sc1
  s_add_u32 s57, s31, 12288
  buffer_load_dwordx4 v[180:183], v1, s[4:7], s57 offen offset:2048 sc1
  v_max3_u32 v250, v184, v185, v186
  v_max3_u32 v251, v187, v188, v189
  v_max3_u32 v250, v250, v190, v191
  v_max_u32 v250, v250, v251
  v_cmp_eq_u32 vcc, -1, v250
  s_cbranch_vccz x3_14_s0
  s_add_u32 s57, s30, 12288
  buffer_load_dwordx4 v[184:187], v1, s[4:7], s57 offen offset:3072 sc1
  s_add_u32 s57, s31, 12288
  buffer_load_dwordx4 v[188:191], v1, s[4:7], s57 offen offset:3072 sc1
x3_14_s0:
  v_max3_u32 v250, v192, v193, v194
  v_max3_u32 v251, v195, v196, v197
  v_max3_u32 v250, v250, v198, v199
  v_max_u32 v250, v250, v251
  v_cmp_eq_u32 vcc, -1, v250
  s_cbranch_vccz x3_14_s1
  s_add_u32 s57, s30, 16384
  buffer_load_dwordx4 v[192:195], v1, s[4:7], s57 offen offset:0 sc1
  s_add_u32 s57, s31, 16384
  buffer_load_dwordx4 v[196:199], v1, s[4:7], s57 offen offset:0 sc1
x3_14_s1:
  v_max3_u32 v250, v200, v201, v202
  v_max3_u32 v251, v203, v204, v205
  v_max3_u32 v250, v250, v206, v207
  v_max_u32 v250, v250, v251
  v_cmp_eq_u32 vcc, -1, v250
  s_cbranch_vccz x3_14_s2
  s_add_u32 s57, s30, 16384
  buffer_load_dwordx4 v[200:203], v1, s[4:7], s57 offen offset:1024 sc1
  s_add_u32 s57, s31, 16384
  buffer_load_dwordx4 v[204:207], v1, s[4:7], s57 offen offset:1024 sc1
x3_14_s2:
  v_max3_u32 v250, v136, v137, v138
  v_max3_u32 v251, v139, v140, v141
  v_max3_u32 v250, v250, v142, v143
  v_max_u32 v250, v250, v251
  v_cmp_eq_u32 vcc, -1, v250
  s_cbranch_vccz x3_14_s3
  s_add_u32 s57, s30, 16384
  buffer_load_dwordx4 v[136:139], v1, s[4:7], s57 offen offset:2048 sc1
  s_add_u32 s57, s31, 16384
  buffer_load_dwordx4 v[140:143], v1, s[4:7], s57 offen offset:2048 sc1
x3_14_s3:
  v_max3_u32 v250, v144, v145, v146
  v_max3_u32 v251, v147, v148, v149
  v_max3_u32 v250, v250, v150, v151
  v_max_u32 v250, v250, v251
  v_cmp_eq_u32 vcc, -1, v250
  s_cbranch_vccz x3_14_s4
  s_add_u32 s57, s30, 16384
  buffer_load_dwordx4 v[144:147], v1, s[4:7], s57 offen offset:3072 sc1
  s_add_u32 s57, s31, 16384
  buffer_load_dwordx4 v[148:151], v1, s[4:7], s57 offen offset:3072 sc1
x3_14_s4:
  s_waitcnt vmcnt(0)
  v_max3_u32 v250, v176, v177, v178
  v_max3_u32 v251, v179, v180, v181
  v_max3_u32 v250, v250, v182, v183
  v_max_u32 v250, v250, v251
  v_cmp_eq_u32 vcc, -1, v250
  s_cbranch_vccnz x3_14
  s_branch x3_14_b
x3_15:
  s_waitcnt vmcnt(0)
  s_cmp_eq_u32 s61, 0
  s_cbranch_scc1 x3_15_b
  s_sub_u32 s61, s61, 1
  s_add_u32 s57, s30, 12288
  buffer_load_dwordx4 v[184:187], v1, s[4:7], s57 offen offset:3072 sc1
  s_add_u32 s57, s31, 12288
  buffer_load_dwordx4 v[188:191], v1, s[4:7], s57 offen offset:3072 sc1
  v_max3_u32 v250, v192, v193, v194
  v_max3_u32 v251, v195, v196, v197
  v_max3_u32 v250, v250, v198, v199
  v_max_u32 v250, v250, v251
  v_cmp_eq_u32 vcc, -1, v250
  s_cbranch_vccz x3_15_s0
  s_add_u32 s57, s30, 16384
  buffer_load_dwordx4 v[192:195], v1, s[4:7], s57 offen offset:0 sc1
  s_add_u32 s57, s31, 16384
  buffer_load_dwordx4 v[196:199], v1, s[4:7], s57 offen offset:0 sc1
x3_15_s0:
  v_max3_u32 v250, v200, v201, v202
  v_max3_u32 v251, v203, v204, v205
  v_max3_u32 v250, v250, v206, v207
  v_max_u32 v250, v250, v251
  v_cmp_eq_u32 vcc, -1, v250
  s_cbranch_vccz x3_15_s1
  s_add_u32 s57, s30, 16384
  buffer_load_dwordx4 v[200:203], v1, s[4:7], s57 offen offset:1024 sc1
  s_add_u32 s57, s31, 16384
  buffer_load_dwordx4 v[204:207], v1, s[4:7], s57 offen offset:1024 sc1
x3_15_s1:
  v_max3_u32 v250, v136, v137, v138
  v_max3_u32 v251, v139, v140, v141
  v_max3_u32 v250, v250, v142, v143
  v_max_u32 v250, v250, v251
  v_cmp_eq_u32 vcc, -1, v250
  s_cbranch_vccz x3_15_s2
  s_add_u32 s57, s30, 16384
  buffer_load_dwordx4 v[136:139], v1, s[4:7], s57 offen offset:2048 sc1
  s_add_u32 s57, s31, 16384
  buffer_load_dwordx4 v[140:143], v1, s[4:7], s57 offen offset:2048 sc1
x3_15_s2:
  v_max3_u32 v250, v144, v145, v146
  v_max3_u32 v251, v147, v148, v149
  v_max3_u32 v250, v250, v150, v151
  v_max_u32 v250, v250, v251
  v_cmp_eq_u32 vcc, -1, v250
  s_cbranch_vccz x3_15_s3
  s_add_u32 s57, s30, 16384
  buffer_load_dwordx4 v[144:147], v1, s[4:7], s57 offen offset:3072 sc1
  s_add_u32 s57, s31, 16384
  buffer_load_dwordx4 v[148:151], v1, s[4:7], s57 offen offset:3072 sc1
x3_15_s3:
  s_waitcnt vmcnt(0)
  v_max3_u32 v250, v184, v185, v186
  v_max3_u32 v251, v187, v188, v189
  v_max3_u32 v250, v250, v190, v191
  v_max_u32 v250, v250, v251
  v_cmp_eq_u32 vcc, -1, v250
  s_cbranch_vccnz x3_15
  s_branch x3_15_b
x3_16:
  s_waitcnt vmcnt(0)
  s_cmp_eq_u32 s61, 0
  s_cbranch_scc1 x3_16_b
  s_sub_u32 s61, s61, 1
  s_add_u32 s57, s30, 16384
  buffer_load_dwordx4 v[192:195], v1, s[4:7], s57 offen offset:0 sc1
  s_add_u32 s57, s31, 16384
  buffer_load_dwordx4 v[196:199], v1, s[4:7], s57 offen offset:0 sc1
  v_max3_u32 v250, v200, v201, v202
  v_max3_u32 v251, v203, v204, v205
  v_max3_u32 v250, v250, v206, v207
  v_max_u32 v250, v250, v251
  v_cmp_eq_u32 vcc, -1, v250
  s_cbranch_vccz x3_16_s0
  s_add_u32 s57, s30, 16384
  buffer_load_dwordx4 v[200:203], v1, s[4:7], s57 offen offset:1024 sc1
  s_add_u32 s57, s31, 16384
  buffer_load_dwordx4 v[204:207], v1, s[4:7], s57 offen offset:1024 sc1
x3_16_s0:
  v_max3_u32 v250, v136, v137, v138
  v_max3_u32 v251, v139, v140, v141
  v_max3_u32 v250, v250, v142, v143
  v_max_u32 v250, v250, v251
  v_cmp_eq_u32 vcc, -1, v250
  s_cbranch_vccz x3_16_s1
  s_add_u32 s57, s30, 16384
  buffer_load_dwordx4 v[136:139], v1, s[4:7], s57 offen offset:2048 sc1
  s_add_u32 s57, s31, 16384
  buffer_load_dwordx4 v[140:143], v1, s[4:7], s57 offen offset:2048 sc1
x3_16_s1:
  v_max3_u32 v250, v144, v145, v146
  v_max3_u32 v251, v147, v148, v149
  v_max3_u32 v250, v250, v150, v151
  v_max_u32 v250, v250, v251
  v_cmp_eq_u32 vcc, -1, v250
  s_cbranch_vccz x3_16_s2
  s_add_u32 s57, s30, 16384
  buffer_load_dwordx4 v[144:147], v1, s[4:7], s57 offen offset:3072 sc1
  s_add_u32 s57, s31, 16384
  buffer_load_dwordx4 v[148:151], v1, s[4:7], s57 offen offset:3072 sc1
x3_16_s2:
  s_waitcnt vmcnt(0)
  v_max3_u32 v250, v192, v193, v194
  v_max3_u32 v251, v195, v196, v197
  v_max3_u32 v250, v250, v198, v199
  v_max_u32 v250, v250, v251
  v_cmp_eq_u32 vcc, -1, v250
  s_cbranch_vccnz x3_16
  s_branch x3_16_b
x3_17:
  s_waitcnt vmcnt(0)
  s_cmp_eq_u32 s61, 0
  s_cbranch_scc1 x3_17_b
  s_sub_u32 s61, s61, 1
  s_add_u32 s57, s30, 16384
  buffer_load_dwordx4 v[200:203], v1, s[4:7], s57 offen offset:1024 sc1
  s_add_u32 s57, s31, 16384
  buffer_load_dwordx4 v[204:207], v1, s[4:7], s57 offen offset:1024 sc1
  v_max3_u32 v250, v136, v137, v138
  v_max3_u32 v251, v139, v140, v141
  v_max3_u32 v250, v250, v142, v143
  v_max_u32 v250, v250, v251
  v_cmp_eq_u32 vcc, -1, v250
  s_cbranch_vccz x3_17_s0
  s_add_u32 s57, s30, 16384
  buffer_load_dwordx4 v[136:139], v1, s[4:7], s57 offen offset:2048 sc1
  s_add_u32 s57, s31, 16384
  buffer_load_dwordx4 v[140:143], v1, s[4:7], s57 offen offset:2048 sc1
x3_17_s0:
  v_max3_u32 v250, v144, v145, v146
  v_max3_u32 v251, v147, v148, v149
  v_max3_u32 v250, v250, v150, v151
  v_max_u32 v250, v250, v251
  v_cmp_eq_u32 vcc, -1, v250
  s_cbranch_vccz x3_17_s1
  s_add_u32 s57, s30, 16384
  buffer_load_dwordx4 v[144:147], v1, s[4:7], s57 offen offset:3072 sc1
  s_add_u32 s57, s31, 16384
  buffer_load_dwordx4 v[148:151], v1, s[4:7], s57 offen offset:3072 sc1
x3_17_s1:
  s_waitcnt vmcnt(0)
  v_max3_u32 v250, v200, v201, v202
  v_max3_u32 v251, v203, v204, v205
  v_max3_u32 v250, v250, v206, v207
  v_max_u32 v250, v250, v251
  v_cmp_eq_u32 vcc, -1, v250
  s_cbranch_vccnz x3_17
  s_branch x3_17_b
x3_18:
  s_waitcnt vmcnt(0)
  s_cmp_eq_u32 s61, 0
  s_cbranch_scc1 x3_18_b
  s_sub_u32 s61, s61, 1
  s_add_u32 s57, s30, 16384
  buffer_load_dwordx4 v[136:139], v1, s[4:7], s57 offen offset:2048 sc1
  s_add_u32 s57, s31, 16384
  buffer_load_dwordx4 v[140:143], v1, s[4:7], s57 offen offset:2048 sc1
  v_max3_u32 v250, v144, v145, v146
  v_max3_u32 v251, v147, v148, v149
  v_max3_u32 v250, v250, v150, v151
  v_max_u32 v250, v250, v251
  v_cmp_eq_u32 vcc, -1, v250
  s_cbranch_vccz x3_18_s0
  s_add_u32 s57, s30, 16384
  buffer_load_dwordx4 v[144:147], v1, s[4:7], s57 offen offset:3072 sc1
  s_add_u32 s57, s31, 16384
  buffer_load_dwordx4 v[148:151], v1, s[4:7], s57 offen offset:3072 sc1
x3_18_s0:
  s_waitcnt vmcnt(0)
  v_max3_u32 v250, v136, v137, v138
  v_max3_u32 v251, v139, v140, v141
  v_max3_u32 v250, v250, v142, v143
  v_max_u32 v250, v250, v251
  v_cmp_eq_u32 vcc, -1, v250
  s_cbranch_vccnz x3_18
  s_branch x3_18_b
x3_19:
  s_waitcnt vmcnt(0)
  s_cmp_eq_u32 s61, 0
  s_cbranch_scc1 x3_19_b
  s_sub_u32 s61, s61, 1
  s_add_u32 s57, s30, 16384
  buffer_load_dwordx4 v[144:147], v1, s[4:7], s57 offen offset:3072 sc1
  s_add_u32 s57, s31, 16384
  buffer_load_dwordx4 v[148:151], v1, s[4:7], s57 offen offset:3072 sc1
  s_waitcnt vmcnt(0)
  v_max3_u32 v250, v144, v145, v146
  v_max3_u32 v251, v147, v148, v149
  v_max3_u32 v250, v250, v150, v151
  v_max_u32 v250, v250, v251
  v_cmp_eq_u32 vcc, -1, v250
  s_cbranch_vccnz x3_19
  s_branch x3_19_b
code_end:
.section .rodata,"a"
.p2align 6
.amdhsa_kernel sequential_preLN__ssm_conv_s4d__mixer_s_mlp__prompt_kernel
  .amdhsa_next_free_vgpr 256
  .amdhsa_next_free_sgpr 98
  .amdhsa_accum_offset 256
  .amdhsa_group_segment_fixed_size 0
  .amdhsa_kernarg_size 120
  .amdhsa_user_sgpr_count 2
  .amdhsa_user_sgpr_kernarg_segment_ptr 1
  .amdhsa_system_sgpr_workgroup_id_x 1
.end_amdhsa_kernel
```
